```python
import torch

def _softmax(x, axis=-1):
    return torch.softmax(x, dim=axis)
def _gelu(x):
    return torch.nn.functional.gelu(x, approximate="tanh")
def _silu(x):
    return torch.nn.functional.silu(x)
def _sigmoid(x):
    return torch.sigmoid(x)
def _layernorm(x, axis=-1, eps=1e-5):
    m = x.mean(dim=axis, keepdim=True)
    v = x.var(dim=axis, keepdim=True, unbiased=False)
    return (x - m) / torch.sqrt(v + eps)
def _scatter_add(tgt, idx, src, axis=0):
    return tgt.clone().index_add_(axis, idx, src)
def _segment_sum(src, seg, n):
    out = torch.zeros((n,) + src.shape[1:], dtype=src.dtype)
    return out.index_add_(0, seg, src)
def _pad(x, pw):
    flat = tuple(v for pair in reversed(pw) for v in pair)
    return torch.nn.functional.pad(x, flat)

kernel_name = 'standalone__gqa_block_cached__near_ridge'

def setup_inputs():

    _w = (lambda a: (lambda t: t.to(torch.bfloat16) if t.is_floating_point() else t)(torch.as_tensor(a)))
    B, Sq, D = 8, 144, 512
    Hq, Hkv, Sk, Dh = 32, 32, 2048, 128
    assert Hq % Hkv == 0, (Hq, Hkv)
    return {
        "x": _w((lambda *s: torch.randn(*s, dtype=torch.bfloat16) * 0.8)(B, Sq, D)),
        "k_cache": _w((lambda *s: torch.randn(*s, dtype=torch.bfloat16) * 0.8)(B, Hkv, Sk, Dh)),
        "v_cache": _w((lambda *s: torch.randn(*s, dtype=torch.bfloat16) * 0.05)(B, Hkv, Sk, Dh)),
        "wq": _w((lambda *s: torch.randn(*s, dtype=torch.bfloat16) * 0.8)(D, Hq * Dh) * (D ** -0.5)),
        "wo": _w((lambda *s: torch.randn(*s, dtype=torch.bfloat16) * 0.05)(Hq * Dh, D) * ((Hq * Dh) ** -0.5)),
    }

def reference(x, k_cache, v_cache, wq, wo):
    B, Sq, D = x.shape
    Hq, Dh = 32, 128
    Hkv = k_cache.shape[1]
    rep = Hq // Hkv
    q = (lambda x, *d: x.permute(*d))((x @ wq).reshape(B, Sq, Hq, Dh), 0, 2, 1, 3)
    k = (lambda x, n, axis: torch.repeat_interleave(x, n, dim=axis))(k_cache, rep, axis=1)
    v = (lambda x, n, axis: torch.repeat_interleave(x, n, dim=axis))(v_cache, rep, axis=1)
    scores = torch.einsum("bhqd,bhkd->bhqk", q, k) * (Dh ** -0.5)
    p = _softmax(scores, axis=-1)
    o = torch.einsum("bhqk,bhkd->bhqd", p, v)
    return (lambda x, *d: x.permute(*d))(o, 0, 2, 1, 3).reshape(B, Sq, Hq * Dh) @ wo
```

```asm
; @launch grid=(256,1,1) block=(256,1,1) lds=163840
.amdgcn_target "amdgcn-amd-amdhsa--gfx950"
.text
.globl standalone__gqa_block_cached__near_ridge_kernel
.p2align 8
.type standalone__gqa_block_cached__near_ridge_kernel,@function
standalone__gqa_block_cached__near_ridge_kernel:
    s_cmp_ge_u32 s2, 256
    s_cbranch_scc1 L_end
    s_load_dwordx8 s[4:11], s[0:1], 0
    s_load_dwordx4 s[12:15], s[0:1], 32
    s_load_dwordx4 s[16:19], s[0:1], 48
    v_lshrrev_b32 v1, 6, v0
    v_and_b32 v0, 63, v0
    s_and_b32 s40, s2, 7
    v_readfirstlane_b32 s36, v1
    s_getpc_b64 s[62:63]
L_pc:
    s_sub_u32 s62, s62, L_pc-standalone__gqa_block_cached__near_ridge_kernel
    s_subb_u32 s63, s63, 0
    s_lshr_b32 s44, s2, 3
    s_and_b32 s44, s44, 31
    s_lshl_b32 s44, s44, 2
    s_add_u32 s44, s44, s36
    s_lshl_b32 s44, s44, 9
    v_lshlrev_b32 v1, 7, v0
    v_add_u32 v1, s44, v1
    v_min_u32 v1, L_codeend-standalone__gqa_block_cached__near_ridge_kernel-4, v1
    s_mov_b64 exec, 15
    global_load_dword v15, v1, s[62:63]
    s_mov_b64 exec, -1
    s_lshr_b32 s39, s2, 3
    s_and_b32 s39, s39, 3
    s_lshr_b32 s37, s2, 5
    s_lshl_b32 s38, s40, 2
    s_add_u32 s38, s38, s39
    s_lshl_b32 s41, s37, 5
    s_add_u32 s41, s41, s38
    s_cmp_eq_u32 s36, 3
    s_cbranch_scc0 L_compute
L_loader:
    s_lshl_b32 s44, s37, 1
    s_lshl_b32 s45, s39, 2
    s_add_u32 s44, s44, s45
    s_and_b32 s44, s44, 15
    s_lshl_b32 s48, s44, 18
    s_lshl_b32 s49, s44, 6
    v_lshrrev_b32 v1, 4, v0
    v_and_b32 v2, 15, v0
    v_lshlrev_b32 v3, 2, v1
    v_xor_b32 v3, v2, v3
    v_lshlrev_b32 v3, 4, v3
    v_lshl_add_u32 v10, v1, 13, v3
    v_sub_u32 v3, 0, v1
    v_and_b32 v3, 3, v3
    v_and_b32 v2, 3, v0
    v_xor_b32 v3, v3, v2
    v_lshlrev_b32 v3, 4, v3
    v_lshrrev_b32 v2, 2, v0
    v_lshl_add_u32 v11, v2, 10, v3
    v_add_u32 v40, 0, v10
    v_add_u32 v41, 31744, v10
    v_add_u32 v42, 63488, v10
    v_add_u32 v43, 95232, v10
    v_add_u32 v44, 131072, v10
    v_add_u32 v45, 162816, v10
    v_add_u32 v46, 194560, v10
    v_add_u32 v47, 226304, v10
    v_add_u32 v48, 0, v11
    v_add_u32 v49, 15360, v11
    v_add_u32 v50, 30720, v11
    v_add_u32 v51, 46080, v11
    v_add_u32 v52, 65536, v11
    v_add_u32 v53, 80896, v11
    v_add_u32 v54, 96256, v11
    v_add_u32 v55, 111616, v11
    v_add_u32 v56, 131072, v11
    v_lshrrev_b32 v1, 4, v0
    v_and_b32 v2, 15, v0
    v_xor_b32 v3, v2, v1
    v_lshlrev_b32 v3, 4, v3
    v_lshl_add_u32 v4, v1, 8, v3
    v_xor_b32 v5, 64, v4
    v_xor_b32 v6, 128, v4
    v_xor_b32 v7, 192, v4
    v_lshlrev_b32 v3, 1, v1
    v_xor_b32 v3, v2, v3
    v_lshlrev_b32 v3, 4, v3
    v_lshl_add_u32 v8, v1, 8, v3
    v_xor_b32 v9, 128, v8
    s_waitcnt lgkmcnt(0)
    s_lshl_b32 s44, s38, 8
    s_sub_u32 s45, 0x400000, s44
    s_add_u32 s32, s10, s44
    s_addc_u32 s33, s11, 0
    s_and_b32 s33, s33, 0xffff
    s_mov_b32 s34, s45
    s_mov_b32 s35, 0x20000
    s_mul_i32 s44, s37, 147456
    s_add_u32 s28, s4, s44
    s_addc_u32 s29, s5, 0
    s_and_b32 s29, s29, 0xffff
    s_mov_b32 s30, 147456
    s_mov_b32 s31, 0x20000
    s_lshl_b32 s44, s41, 19
    s_lshr_b32 s45, s41, 13
    s_add_u32 s20, s6, s44
    s_addc_u32 s21, s7, s45
    s_and_b32 s21, s21, 0xffff
    s_mov_b32 s22, 0x80000
    s_mov_b32 s23, 0x20000
    s_add_u32 s24, s8, s44
    s_addc_u32 s25, s9, s45
    s_and_b32 s25, s25, 0xffff
    s_mov_b32 s26, 0x80000
    s_mov_b32 s27, 0x20000
    s_and_b32 s54, s41, 7
    s_lshl_b32 s54, s54, 13
    s_mov_b32 s52, s54
    s_bitcmp1_b32 s37, 0
    s_cselect_b32 s57, 1, 0
    s_cbranch_scc0 L_ldB0
    s_add_u32 s53, s52, 4096
    s_mov_b32 m0, 81920
    s_nop 0
    buffer_load_dwordx4 v4, s[20:23], s52 offen offset:0 nt lds
    buffer_load_dwordx4 v5, s[20:23], s52 offen offset:1024 nt lds
    buffer_load_dwordx4 v6, s[20:23], s52 offen offset:2048 nt lds
    buffer_load_dwordx4 v7, s[20:23], s52 offen offset:3072 nt lds
    s_mov_b32 m0, 86016
    s_nop 0
    buffer_load_dwordx4 v4, s[20:23], s53 offen offset:0 nt lds
    buffer_load_dwordx4 v5, s[20:23], s53 offen offset:1024 nt lds
    buffer_load_dwordx4 v6, s[20:23], s53 offen offset:2048 nt lds
    buffer_load_dwordx4 v7, s[20:23], s53 offen offset:3072 nt lds
    s_add_u32 s52, s52, 8192
    s_and_b32 s52, s52, 0x7ffff
    s_add_u32 s53, s52, 4096
    s_mov_b32 m0, 0
    s_nop 0
    buffer_load_dwordx4 v4, s[20:23], s52 offen offset:0 nt lds
    buffer_load_dwordx4 v5, s[20:23], s52 offen offset:1024 nt lds
    buffer_load_dwordx4 v6, s[20:23], s52 offen offset:2048 nt lds
    buffer_load_dwordx4 v7, s[20:23], s52 offen offset:3072 nt lds
    s_mov_b32 m0, 4096
    s_nop 0
    buffer_load_dwordx4 v4, s[20:23], s53 offen offset:0 nt lds
    buffer_load_dwordx4 v5, s[20:23], s53 offen offset:1024 nt lds
    buffer_load_dwordx4 v6, s[20:23], s53 offen offset:2048 nt lds
    buffer_load_dwordx4 v7, s[20:23], s53 offen offset:3072 nt lds
    s_add_u32 s52, s52, 8192
    s_and_b32 s52, s52, 0x7ffff
    s_add_u32 s55, s54, 4096
    s_mov_b32 m0, 8192
    s_nop 0
    buffer_load_dwordx4 v8, s[24:27], s54 offen offset:0 nt lds
    buffer_load_dwordx4 v9, s[24:27], s54 offen offset:1024 nt lds
    buffer_load_dwordx4 v8, s[24:27], s54 offen offset:2048 nt lds
    buffer_load_dwordx4 v9, s[24:27], s54 offen offset:3072 nt lds
    s_mov_b32 m0, 12288
    s_nop 0
    buffer_load_dwordx4 v8, s[24:27], s55 offen offset:0 nt lds
    buffer_load_dwordx4 v9, s[24:27], s55 offen offset:1024 nt lds
    buffer_load_dwordx4 v8, s[24:27], s55 offen offset:2048 nt lds
    buffer_load_dwordx4 v9, s[24:27], s55 offen offset:3072 nt lds
    s_add_u32 s54, s54, 8192
    s_and_b32 s54, s54, 0x7ffff
    s_waitcnt vmcnt(12)
L_ldB0:
    s_mov_b32 m0, 94208
    s_nop 0
    buffer_load_dwordx4 v40, s[32:35], s48 offen offset:0  lds
    buffer_load_dwordx4 v41, s[32:35], s48 offen offset:1024  lds
    buffer_load_dwordx4 v42, s[32:35], s48 offen offset:2048  lds
    buffer_load_dwordx4 v43, s[32:35], s48 offen offset:3072  lds
    s_mov_b32 m0, 98304
    s_nop 0
    buffer_load_dwordx4 v44, s[32:35], s48 offen offset:0  lds
    buffer_load_dwordx4 v45, s[32:35], s48 offen offset:1024  lds
    buffer_load_dwordx4 v46, s[32:35], s48 offen offset:2048  lds
    buffer_load_dwordx4 v47, s[32:35], s48 offen offset:3072  lds
    s_add_u32 s48, s48, 262144
    s_and_b32 s48, s48, 0x3fffff
    s_mov_b32 m0, 102400
    s_nop 0
    buffer_load_dwordx4 v48, s[28:31], s49 offen offset:0  lds
    buffer_load_dwordx4 v49, s[28:31], s49 offen offset:1024  lds
    buffer_load_dwordx4 v50, s[28:31], s49 offen offset:2048  lds
    buffer_load_dwordx4 v51, s[28:31], s49 offen offset:3072  lds
    s_mov_b32 m0, 106496
    s_nop 0
    buffer_load_dwordx4 v52, s[28:31], s49 offen offset:0  lds
    buffer_load_dwordx4 v53, s[28:31], s49 offen offset:1024  lds
    buffer_load_dwordx4 v54, s[28:31], s49 offen offset:2048  lds
    buffer_load_dwordx4 v55, s[28:31], s49 offen offset:3072  lds
    s_mov_b32 m0, 110592
    s_nop 0
    buffer_load_dwordx4 v56, s[28:31], s49 offen offset:0  lds
    s_add_u32 s49, s49, 64
    s_and_b32 s49, s49, 1023
    s_mov_b32 m0, 111616
    s_nop 0
    buffer_load_dwordx4 v40, s[32:35], s48 offen offset:0  lds
    buffer_load_dwordx4 v41, s[32:35], s48 offen offset:1024  lds
    buffer_load_dwordx4 v42, s[32:35], s48 offen offset:2048  lds
    buffer_load_dwordx4 v43, s[32:35], s48 offen offset:3072  lds
    s_mov_b32 m0, 115712
    s_nop 0
    buffer_load_dwordx4 v44, s[32:35], s48 offen offset:0  lds
    buffer_load_dwordx4 v45, s[32:35], s48 offen offset:1024  lds
    buffer_load_dwordx4 v46, s[32:35], s48 offen offset:2048  lds
    buffer_load_dwordx4 v47, s[32:35], s48 offen offset:3072  lds
    s_add_u32 s48, s48, 262144
    s_and_b32 s48, s48, 0x3fffff
    s_mov_b32 m0, 119808
    s_nop 0
    buffer_load_dwordx4 v48, s[28:31], s49 offen offset:0  lds
    buffer_load_dwordx4 v49, s[28:31], s49 offen offset:1024  lds
    buffer_load_dwordx4 v50, s[28:31], s49 offen offset:2048  lds
    buffer_load_dwordx4 v51, s[28:31], s49 offen offset:3072  lds
    s_mov_b32 m0, 123904
    s_nop 0
    buffer_load_dwordx4 v52, s[28:31], s49 offen offset:0  lds
    buffer_load_dwordx4 v53, s[28:31], s49 offen offset:1024  lds
    buffer_load_dwordx4 v54, s[28:31], s49 offen offset:2048  lds
    buffer_load_dwordx4 v55, s[28:31], s49 offen offset:3072  lds
    s_mov_b32 m0, 128000
    s_nop 0
    buffer_load_dwordx4 v56, s[28:31], s49 offen offset:0  lds
    s_add_u32 s49, s49, 64
    s_and_b32 s49, s49, 1023
    s_mov_b32 m0, 129024
    s_nop 0
    buffer_load_dwordx4 v40, s[32:35], s48 offen offset:0  lds
    buffer_load_dwordx4 v41, s[32:35], s48 offen offset:1024  lds
    buffer_load_dwordx4 v42, s[32:35], s48 offen offset:2048  lds
    buffer_load_dwordx4 v43, s[32:35], s48 offen offset:3072  lds
    s_mov_b32 m0, 133120
    s_nop 0
    buffer_load_dwordx4 v44, s[32:35], s48 offen offset:0  lds
    buffer_load_dwordx4 v45, s[32:35], s48 offen offset:1024  lds
    buffer_load_dwordx4 v46, s[32:35], s48 offen offset:2048  lds
    buffer_load_dwordx4 v47, s[32:35], s48 offen offset:3072  lds
    s_add_u32 s48, s48, 262144
    s_and_b32 s48, s48, 0x3fffff
    s_mov_b32 m0, 137216
    s_nop 0
    buffer_load_dwordx4 v48, s[28:31], s49 offen offset:0  lds
    buffer_load_dwordx4 v49, s[28:31], s49 offen offset:1024  lds
    buffer_load_dwordx4 v50, s[28:31], s49 offen offset:2048  lds
    buffer_load_dwordx4 v51, s[28:31], s49 offen offset:3072  lds
    s_mov_b32 m0, 141312
    s_nop 0
    buffer_load_dwordx4 v52, s[28:31], s49 offen offset:0  lds
    buffer_load_dwordx4 v53, s[28:31], s49 offen offset:1024  lds
    buffer_load_dwordx4 v54, s[28:31], s49 offen offset:2048  lds
    buffer_load_dwordx4 v55, s[28:31], s49 offen offset:3072  lds
    s_mov_b32 m0, 145408
    s_nop 0
    buffer_load_dwordx4 v56, s[28:31], s49 offen offset:0  lds
    s_add_u32 s49, s49, 64
    s_and_b32 s49, s49, 1023
    s_waitcnt vmcnt(34)
    s_barrier
    s_mov_b32 m0, 146432
    s_nop 0
    buffer_load_dwordx4 v40, s[32:35], s48 offen offset:0  lds
    buffer_load_dwordx4 v41, s[32:35], s48 offen offset:1024  lds
    buffer_load_dwordx4 v42, s[32:35], s48 offen offset:2048  lds
    buffer_load_dwordx4 v43, s[32:35], s48 offen offset:3072  lds
    s_mov_b32 m0, 150528
    s_nop 0
    buffer_load_dwordx4 v44, s[32:35], s48 offen offset:0  lds
    buffer_load_dwordx4 v45, s[32:35], s48 offen offset:1024  lds
    buffer_load_dwordx4 v46, s[32:35], s48 offen offset:2048  lds
    buffer_load_dwordx4 v47, s[32:35], s48 offen offset:3072  lds
    s_add_u32 s48, s48, 262144
    s_and_b32 s48, s48, 0x3fffff
    s_mov_b32 m0, 154624
    s_nop 0
    buffer_load_dwordx4 v48, s[28:31], s49 offen offset:0  lds
    buffer_load_dwordx4 v49, s[28:31], s49 offen offset:1024  lds
    buffer_load_dwordx4 v50, s[28:31], s49 offen offset:2048  lds
    buffer_load_dwordx4 v51, s[28:31], s49 offen offset:3072  lds
    s_mov_b32 m0, 158720
    s_nop 0
    buffer_load_dwordx4 v52, s[28:31], s49 offen offset:0  lds
    buffer_load_dwordx4 v53, s[28:31], s49 offen offset:1024  lds
    buffer_load_dwordx4 v54, s[28:31], s49 offen offset:2048  lds
    buffer_load_dwordx4 v55, s[28:31], s49 offen offset:3072  lds
    s_mov_b32 m0, 162816
    s_nop 0
    buffer_load_dwordx4 v56, s[28:31], s49 offen offset:0  lds
    s_add_u32 s49, s49, 64
    s_and_b32 s49, s49, 1023
    s_cmp_eq_u32 s2, 0
    s_cbranch_scc0 L_notag
    s_memrealtime s[62:63]
    s_waitcnt lgkmcnt(0)
    s_or_b32 s62, s62, 1
    v_mov_b32 v2, s62
    v_mov_b32 v3, s63
    v_mov_b32 v1, 0
    s_mov_b64 exec, 1
    global_store_dwordx2 v1, v[2:3], s[16:17] sc1
    s_mov_b64 exec, -1
L_notag:
    s_waitcnt vmcnt(34)
    s_barrier
    s_mov_b32 m0, 94208
    s_nop 0
    buffer_load_dwordx4 v40, s[32:35], s48 offen offset:0  lds
    buffer_load_dwordx4 v41, s[32:35], s48 offen offset:1024  lds
    buffer_load_dwordx4 v42, s[32:35], s48 offen offset:2048  lds
    buffer_load_dwordx4 v43, s[32:35], s48 offen offset:3072  lds
    s_mov_b32 m0, 98304
    s_nop 0
    buffer_load_dwordx4 v44, s[32:35], s48 offen offset:0  lds
    buffer_load_dwordx4 v45, s[32:35], s48 offen offset:1024  lds
    buffer_load_dwordx4 v46, s[32:35], s48 offen offset:2048  lds
    buffer_load_dwordx4 v47, s[32:35], s48 offen offset:3072  lds
    s_add_u32 s48, s48, 262144
    s_and_b32 s48, s48, 0x3fffff
    s_mov_b32 m0, 102400
    s_nop 0
    buffer_load_dwordx4 v48, s[28:31], s49 offen offset:0  lds
    buffer_load_dwordx4 v49, s[28:31], s49 offen offset:1024  lds
    buffer_load_dwordx4 v50, s[28:31], s49 offen offset:2048  lds
    buffer_load_dwordx4 v51, s[28:31], s49 offen offset:3072  lds
    s_mov_b32 m0, 106496
    s_nop 0
    buffer_load_dwordx4 v52, s[28:31], s49 offen offset:0  lds
    buffer_load_dwordx4 v53, s[28:31], s49 offen offset:1024  lds
    buffer_load_dwordx4 v54, s[28:31], s49 offen offset:2048  lds
    buffer_load_dwordx4 v55, s[28:31], s49 offen offset:3072  lds
    s_mov_b32 m0, 110592
    s_nop 0
    buffer_load_dwordx4 v56, s[28:31], s49 offen offset:0  lds
    s_add_u32 s49, s49, 64
    s_and_b32 s49, s49, 1023
    s_waitcnt vmcnt(34)
    s_barrier
    s_mov_b32 m0, 111616
    s_nop 0
    buffer_load_dwordx4 v40, s[32:35], s48 offen offset:0  lds
    buffer_load_dwordx4 v41, s[32:35], s48 offen offset:1024  lds
    buffer_load_dwordx4 v42, s[32:35], s48 offen offset:2048  lds
    buffer_load_dwordx4 v43, s[32:35], s48 offen offset:3072  lds
    s_mov_b32 m0, 115712
    s_nop 0
    buffer_load_dwordx4 v44, s[32:35], s48 offen offset:0  lds
    buffer_load_dwordx4 v45, s[32:35], s48 offen offset:1024  lds
    buffer_load_dwordx4 v46, s[32:35], s48 offen offset:2048  lds
    buffer_load_dwordx4 v47, s[32:35], s48 offen offset:3072  lds
    s_add_u32 s48, s48, 262144
    s_and_b32 s48, s48, 0x3fffff
    s_mov_b32 m0, 119808
    s_nop 0
    buffer_load_dwordx4 v48, s[28:31], s49 offen offset:0  lds
    buffer_load_dwordx4 v49, s[28:31], s49 offen offset:1024  lds
    buffer_load_dwordx4 v50, s[28:31], s49 offen offset:2048  lds
    buffer_load_dwordx4 v51, s[28:31], s49 offen offset:3072  lds
    s_mov_b32 m0, 123904
    s_nop 0
    buffer_load_dwordx4 v52, s[28:31], s49 offen offset:0  lds
    buffer_load_dwordx4 v53, s[28:31], s49 offen offset:1024  lds
    buffer_load_dwordx4 v54, s[28:31], s49 offen offset:2048  lds
    buffer_load_dwordx4 v55, s[28:31], s49 offen offset:3072  lds
    s_mov_b32 m0, 128000
    s_nop 0
    buffer_load_dwordx4 v56, s[28:31], s49 offen offset:0  lds
    s_add_u32 s49, s49, 64
    s_and_b32 s49, s49, 1023
    s_mov_b32 s59, 0
L_ldq:
    s_waitcnt vmcnt(34)
    s_barrier
    s_mov_b32 m0, 129024
    s_nop 0
    buffer_load_dwordx4 v40, s[32:35], s48 offen offset:0  lds
    buffer_load_dwordx4 v41, s[32:35], s48 offen offset:1024  lds
    buffer_load_dwordx4 v42, s[32:35], s48 offen offset:2048  lds
    buffer_load_dwordx4 v43, s[32:35], s48 offen offset:3072  lds
    s_mov_b32 m0, 133120
    s_nop 0
    buffer_load_dwordx4 v44, s[32:35], s48 offen offset:0  lds
    buffer_load_dwordx4 v45, s[32:35], s48 offen offset:1024  lds
    buffer_load_dwordx4 v46, s[32:35], s48 offen offset:2048  lds
    buffer_load_dwordx4 v47, s[32:35], s48 offen offset:3072  lds
    s_add_u32 s48, s48, 262144
    s_and_b32 s48, s48, 0x3fffff
    s_mov_b32 m0, 137216
    s_nop 0
    buffer_load_dwordx4 v48, s[28:31], s49 offen offset:0  lds
    buffer_load_dwordx4 v49, s[28:31], s49 offen offset:1024  lds
    buffer_load_dwordx4 v50, s[28:31], s49 offen offset:2048  lds
    buffer_load_dwordx4 v51, s[28:31], s49 offen offset:3072  lds
    s_mov_b32 m0, 141312
    s_nop 0
    buffer_load_dwordx4 v52, s[28:31], s49 offen offset:0  lds
    buffer_load_dwordx4 v53, s[28:31], s49 offen offset:1024  lds
    buffer_load_dwordx4 v54, s[28:31], s49 offen offset:2048  lds
    buffer_load_dwordx4 v55, s[28:31], s49 offen offset:3072  lds
    s_mov_b32 m0, 145408
    s_nop 0
    buffer_load_dwordx4 v56, s[28:31], s49 offen offset:0  lds
    s_add_u32 s49, s49, 64
    s_and_b32 s49, s49, 1023
    s_waitcnt vmcnt(34)
    s_barrier
    s_mov_b32 m0, 146432
    s_nop 0
    buffer_load_dwordx4 v40, s[32:35], s48 offen offset:0  lds
    buffer_load_dwordx4 v41, s[32:35], s48 offen offset:1024  lds
    buffer_load_dwordx4 v42, s[32:35], s48 offen offset:2048  lds
    buffer_load_dwordx4 v43, s[32:35], s48 offen offset:3072  lds
    s_mov_b32 m0, 150528
    s_nop 0
    buffer_load_dwordx4 v44, s[32:35], s48 offen offset:0  lds
    buffer_load_dwordx4 v45, s[32:35], s48 offen offset:1024  lds
    buffer_load_dwordx4 v46, s[32:35], s48 offen offset:2048  lds
    buffer_load_dwordx4 v47, s[32:35], s48 offen offset:3072  lds
    s_add_u32 s48, s48, 262144
    s_and_b32 s48, s48, 0x3fffff
    s_mov_b32 m0, 154624
    s_nop 0
    buffer_load_dwordx4 v48, s[28:31], s49 offen offset:0  lds
    buffer_load_dwordx4 v49, s[28:31], s49 offen offset:1024  lds
    buffer_load_dwordx4 v50, s[28:31], s49 offen offset:2048  lds
    buffer_load_dwordx4 v51, s[28:31], s49 offen offset:3072  lds
    s_mov_b32 m0, 158720
    s_nop 0
    buffer_load_dwordx4 v52, s[28:31], s49 offen offset:0  lds
    buffer_load_dwordx4 v53, s[28:31], s49 offen offset:1024  lds
    buffer_load_dwordx4 v54, s[28:31], s49 offen offset:2048  lds
    buffer_load_dwordx4 v55, s[28:31], s49 offen offset:3072  lds
    s_mov_b32 m0, 162816
    s_nop 0
    buffer_load_dwordx4 v56, s[28:31], s49 offen offset:0  lds
    s_add_u32 s49, s49, 64
    s_and_b32 s49, s49, 1023
    s_waitcnt vmcnt(34)
    s_barrier
    s_mov_b32 m0, 94208
    s_nop 0
    buffer_load_dwordx4 v40, s[32:35], s48 offen offset:0  lds
    buffer_load_dwordx4 v41, s[32:35], s48 offen offset:1024  lds
    buffer_load_dwordx4 v42, s[32:35], s48 offen offset:2048  lds
    buffer_load_dwordx4 v43, s[32:35], s48 offen offset:3072  lds
    s_mov_b32 m0, 98304
    s_nop 0
    buffer_load_dwordx4 v44, s[32:35], s48 offen offset:0  lds
    buffer_load_dwordx4 v45, s[32:35], s48 offen offset:1024  lds
    buffer_load_dwordx4 v46, s[32:35], s48 offen offset:2048  lds
    buffer_load_dwordx4 v47, s[32:35], s48 offen offset:3072  lds
    s_add_u32 s48, s48, 262144
    s_and_b32 s48, s48, 0x3fffff
    s_mov_b32 m0, 102400
    s_nop 0
    buffer_load_dwordx4 v48, s[28:31], s49 offen offset:0  lds
    buffer_load_dwordx4 v49, s[28:31], s49 offen offset:1024  lds
    buffer_load_dwordx4 v50, s[28:31], s49 offen offset:2048  lds
    buffer_load_dwordx4 v51, s[28:31], s49 offen offset:3072  lds
    s_mov_b32 m0, 106496
    s_nop 0
    buffer_load_dwordx4 v52, s[28:31], s49 offen offset:0  lds
    buffer_load_dwordx4 v53, s[28:31], s49 offen offset:1024  lds
    buffer_load_dwordx4 v54, s[28:31], s49 offen offset:2048  lds
    buffer_load_dwordx4 v55, s[28:31], s49 offen offset:3072  lds
    s_mov_b32 m0, 110592
    s_nop 0
    buffer_load_dwordx4 v56, s[28:31], s49 offen offset:0  lds
    s_add_u32 s49, s49, 64
    s_and_b32 s49, s49, 1023
    s_waitcnt vmcnt(34)
    s_barrier
    s_mov_b32 m0, 111616
    s_nop 0
    buffer_load_dwordx4 v40, s[32:35], s48 offen offset:0  lds
    buffer_load_dwordx4 v41, s[32:35], s48 offen offset:1024  lds
    buffer_load_dwordx4 v42, s[32:35], s48 offen offset:2048  lds
    buffer_load_dwordx4 v43, s[32:35], s48 offen offset:3072  lds
    s_mov_b32 m0, 115712
    s_nop 0
    buffer_load_dwordx4 v44, s[32:35], s48 offen offset:0  lds
    buffer_load_dwordx4 v45, s[32:35], s48 offen offset:1024  lds
    buffer_load_dwordx4 v46, s[32:35], s48 offen offset:2048  lds
    buffer_load_dwordx4 v47, s[32:35], s48 offen offset:3072  lds
    s_add_u32 s48, s48, 262144
    s_and_b32 s48, s48, 0x3fffff
    s_mov_b32 m0, 119808
    s_nop 0
    buffer_load_dwordx4 v48, s[28:31], s49 offen offset:0  lds
    buffer_load_dwordx4 v49, s[28:31], s49 offen offset:1024  lds
    buffer_load_dwordx4 v50, s[28:31], s49 offen offset:2048  lds
    buffer_load_dwordx4 v51, s[28:31], s49 offen offset:3072  lds
    s_mov_b32 m0, 123904
    s_nop 0
    buffer_load_dwordx4 v52, s[28:31], s49 offen offset:0  lds
    buffer_load_dwordx4 v53, s[28:31], s49 offen offset:1024  lds
    buffer_load_dwordx4 v54, s[28:31], s49 offen offset:2048  lds
    buffer_load_dwordx4 v55, s[28:31], s49 offen offset:3072  lds
    s_mov_b32 m0, 128000
    s_nop 0
    buffer_load_dwordx4 v56, s[28:31], s49 offen offset:0  lds
    s_add_u32 s49, s49, 64
    s_and_b32 s49, s49, 1023
    s_add_u32 s59, s59, 1
    s_cmp_lt_u32 s59, 2
    s_cbranch_scc1 L_ldq
    s_cmp_eq_u32 s57, 0
    s_cbranch_scc1 L_q2B
    s_waitcnt vmcnt(34)
    s_barrier
    s_mov_b32 m0, 129024
    s_nop 0
    buffer_load_dwordx4 v40, s[32:35], s48 offen offset:0  lds
    buffer_load_dwordx4 v41, s[32:35], s48 offen offset:1024  lds
    buffer_load_dwordx4 v42, s[32:35], s48 offen offset:2048  lds
    buffer_load_dwordx4 v43, s[32:35], s48 offen offset:3072  lds
    s_mov_b32 m0, 133120
    s_nop 0
    buffer_load_dwordx4 v44, s[32:35], s48 offen offset:0  lds
    buffer_load_dwordx4 v45, s[32:35], s48 offen offset:1024  lds
    buffer_load_dwordx4 v46, s[32:35], s48 offen offset:2048  lds
    buffer_load_dwordx4 v47, s[32:35], s48 offen offset:3072  lds
    s_add_u32 s48, s48, 262144
    s_and_b32 s48, s48, 0x3fffff
    s_mov_b32 m0, 137216
    s_nop 0
    buffer_load_dwordx4 v48, s[28:31], s49 offen offset:0  lds
    buffer_load_dwordx4 v49, s[28:31], s49 offen offset:1024  lds
    buffer_load_dwordx4 v50, s[28:31], s49 offen offset:2048  lds
    buffer_load_dwordx4 v51, s[28:31], s49 offen offset:3072  lds
    s_mov_b32 m0, 141312
    s_nop 0
    buffer_load_dwordx4 v52, s[28:31], s49 offen offset:0  lds
    buffer_load_dwordx4 v53, s[28:31], s49 offen offset:1024  lds
    buffer_load_dwordx4 v54, s[28:31], s49 offen offset:2048  lds
    buffer_load_dwordx4 v55, s[28:31], s49 offen offset:3072  lds
    s_mov_b32 m0, 145408
    s_nop 0
    buffer_load_dwordx4 v56, s[28:31], s49 offen offset:0  lds
    s_add_u32 s49, s49, 64
    s_and_b32 s49, s49, 1023
    s_waitcnt vmcnt(34)
    s_barrier
    s_mov_b32 m0, 146432
    s_nop 0
    buffer_load_dwordx4 v40, s[32:35], s48 offen offset:0  lds
    buffer_load_dwordx4 v41, s[32:35], s48 offen offset:1024  lds
    buffer_load_dwordx4 v42, s[32:35], s48 offen offset:2048  lds
    buffer_load_dwordx4 v43, s[32:35], s48 offen offset:3072  lds
    s_mov_b32 m0, 150528
    s_nop 0
    buffer_load_dwordx4 v44, s[32:35], s48 offen offset:0  lds
    buffer_load_dwordx4 v45, s[32:35], s48 offen offset:1024  lds
    buffer_load_dwordx4 v46, s[32:35], s48 offen offset:2048  lds
    buffer_load_dwordx4 v47, s[32:35], s48 offen offset:3072  lds
    s_add_u32 s48, s48, 262144
    s_and_b32 s48, s48, 0x3fffff
    s_mov_b32 m0, 154624
    s_nop 0
    buffer_load_dwordx4 v48, s[28:31], s49 offen offset:0  lds
    buffer_load_dwordx4 v49, s[28:31], s49 offen offset:1024  lds
    buffer_load_dwordx4 v50, s[28:31], s49 offen offset:2048  lds
    buffer_load_dwordx4 v51, s[28:31], s49 offen offset:3072  lds
    s_mov_b32 m0, 158720
    s_nop 0
    buffer_load_dwordx4 v52, s[28:31], s49 offen offset:0  lds
    buffer_load_dwordx4 v53, s[28:31], s49 offen offset:1024  lds
    buffer_load_dwordx4 v54, s[28:31], s49 offen offset:2048  lds
    buffer_load_dwordx4 v55, s[28:31], s49 offen offset:3072  lds
    s_mov_b32 m0, 162816
    s_nop 0
    buffer_load_dwordx4 v56, s[28:31], s49 offen offset:0  lds
    s_add_u32 s49, s49, 64
    s_and_b32 s49, s49, 1023
    s_waitcnt vmcnt(34)
    s_barrier
    s_add_u32 s53, s52, 4096
    s_mov_b32 m0, 16384
    s_nop 0
    buffer_load_dwordx4 v4, s[20:23], s52 offen offset:0 nt lds
    buffer_load_dwordx4 v5, s[20:23], s52 offen offset:1024 nt lds
    buffer_load_dwordx4 v6, s[20:23], s52 offen offset:2048 nt lds
    buffer_load_dwordx4 v7, s[20:23], s52 offen offset:3072 nt lds
    s_mov_b32 m0, 20480
    s_nop 0
    buffer_load_dwordx4 v4, s[20:23], s53 offen offset:0 nt lds
    buffer_load_dwordx4 v5, s[20:23], s53 offen offset:1024 nt lds
    buffer_load_dwordx4 v6, s[20:23], s53 offen offset:2048 nt lds
    buffer_load_dwordx4 v7, s[20:23], s53 offen offset:3072 nt lds
    s_add_u32 s52, s52, 8192
    s_and_b32 s52, s52, 0x7ffff
    s_add_u32 s55, s54, 4096
    s_mov_b32 m0, 24576
    s_nop 0
    buffer_load_dwordx4 v8, s[24:27], s54 offen offset:0 nt lds
    buffer_load_dwordx4 v9, s[24:27], s54 offen offset:1024 nt lds
    buffer_load_dwordx4 v8, s[24:27], s54 offen offset:2048 nt lds
    buffer_load_dwordx4 v9, s[24:27], s54 offen offset:3072 nt lds
    s_mov_b32 m0, 28672
    s_nop 0
    buffer_load_dwordx4 v8, s[24:27], s55 offen offset:0 nt lds
    buffer_load_dwordx4 v9, s[24:27], s55 offen offset:1024 nt lds
    buffer_load_dwordx4 v8, s[24:27], s55 offen offset:2048 nt lds
    buffer_load_dwordx4 v9, s[24:27], s55 offen offset:3072 nt lds
    s_add_u32 s54, s54, 8192
    s_and_b32 s54, s54, 0x7ffff
    s_waitcnt vmcnt(33)
    s_barrier
    s_add_u32 s53, s52, 4096
    s_mov_b32 m0, 32768
    s_nop 0
    buffer_load_dwordx4 v4, s[20:23], s52 offen offset:0 nt lds
    buffer_load_dwordx4 v5, s[20:23], s52 offen offset:1024 nt lds
    buffer_load_dwordx4 v6, s[20:23], s52 offen offset:2048 nt lds
    buffer_load_dwordx4 v7, s[20:23], s52 offen offset:3072 nt lds
    s_mov_b32 m0, 36864
    s_nop 0
    buffer_load_dwordx4 v4, s[20:23], s53 offen offset:0 nt lds
    buffer_load_dwordx4 v5, s[20:23], s53 offen offset:1024 nt lds
    buffer_load_dwordx4 v6, s[20:23], s53 offen offset:2048 nt lds
    buffer_load_dwordx4 v7, s[20:23], s53 offen offset:3072 nt lds
    s_add_u32 s52, s52, 8192
    s_and_b32 s52, s52, 0x7ffff
    s_add_u32 s55, s54, 4096
    s_mov_b32 m0, 40960
    s_nop 0
    buffer_load_dwordx4 v8, s[24:27], s54 offen offset:0 nt lds
    buffer_load_dwordx4 v9, s[24:27], s54 offen offset:1024 nt lds
    buffer_load_dwordx4 v8, s[24:27], s54 offen offset:2048 nt lds
    buffer_load_dwordx4 v9, s[24:27], s54 offen offset:3072 nt lds
    s_mov_b32 m0, 45056
    s_nop 0
    buffer_load_dwordx4 v8, s[24:27], s55 offen offset:0 nt lds
    buffer_load_dwordx4 v9, s[24:27], s55 offen offset:1024 nt lds
    buffer_load_dwordx4 v8, s[24:27], s55 offen offset:2048 nt lds
    buffer_load_dwordx4 v9, s[24:27], s55 offen offset:3072 nt lds
    s_add_u32 s54, s54, 8192
    s_and_b32 s54, s54, 0x7ffff
    s_waitcnt vmcnt(32)
    s_barrier
    s_lshl_b32 s44, s40, 19
    s_lshl_b32 s45, s39, 8
    s_add_u32 s44, s44, s45
    s_sub_u32 s45, 0x400000, s44
    s_add_u32 s28, s12, s44
    s_addc_u32 s29, s13, 0
    s_and_b32 s29, s29, 0xffff
    s_mov_b32 s30, s45
    s_mov_b32 s31, 0x20000
    v_lshrrev_b32 v1, 4, v0
    v_and_b32 v2, 15, v0
    v_lshlrev_b32 v3, 1, v1
    v_xor_b32 v3, v2, v3
    v_lshlrev_b32 v3, 4, v3
    v_lshl_add_u32 v12, v1, 10, v3
    v_xor_b32 v13, 128, v12
    v_lshrrev_b32 v1, 1, v0
    v_and_b32 v2, 1, v0
    v_lshlrev_b32 v2, 7, v2
    v_lshl_add_u32 v14, v1, 10, v2
    s_add_u32 s44, s39, 0
    s_and_b32 s44, s44, 3
    s_lshl_b32 s90, s44, 17
    s_add_u32 s44, s39, 1
    s_and_b32 s44, s44, 3
    s_lshl_b32 s91, s44, 17
    s_add_u32 s44, s39, 2
    s_and_b32 s44, s44, 3
    s_lshl_b32 s92, s44, 17
    s_add_u32 s44, s39, 3
    s_and_b32 s44, s44, 3
    s_lshl_b32 s93, s44, 17
    s_barrier
    s_add_u32 s53, s52, 4096
    s_mov_b32 m0, 49152
    s_nop 0
    buffer_load_dwordx4 v4, s[20:23], s52 offen offset:0 nt lds
    buffer_load_dwordx4 v5, s[20:23], s52 offen offset:1024 nt lds
    buffer_load_dwordx4 v6, s[20:23], s52 offen offset:2048 nt lds
    buffer_load_dwordx4 v7, s[20:23], s52 offen offset:3072 nt lds
    s_mov_b32 m0, 53248
    s_nop 0
    buffer_load_dwordx4 v4, s[20:23], s53 offen offset:0 nt lds
    buffer_load_dwordx4 v5, s[20:23], s53 offen offset:1024 nt lds
    buffer_load_dwordx4 v6, s[20:23], s53 offen offset:2048 nt lds
    buffer_load_dwordx4 v7, s[20:23], s53 offen offset:3072 nt lds
    s_add_u32 s52, s52, 8192
    s_and_b32 s52, s52, 0x7ffff
    s_add_u32 s55, s54, 4096
    s_mov_b32 m0, 57344
    s_nop 0
    buffer_load_dwordx4 v8, s[24:27], s54 offen offset:0 nt lds
    buffer_load_dwordx4 v9, s[24:27], s54 offen offset:1024 nt lds
    buffer_load_dwordx4 v8, s[24:27], s54 offen offset:2048 nt lds
    buffer_load_dwordx4 v9, s[24:27], s54 offen offset:3072 nt lds
    s_mov_b32 m0, 61440
    s_nop 0
    buffer_load_dwordx4 v8, s[24:27], s55 offen offset:0 nt lds
    buffer_load_dwordx4 v9, s[24:27], s55 offen offset:1024 nt lds
    buffer_load_dwordx4 v8, s[24:27], s55 offen offset:2048 nt lds
    buffer_load_dwordx4 v9, s[24:27], s55 offen offset:3072 nt lds
    s_add_u32 s54, s54, 8192
    s_and_b32 s54, s54, 0x7ffff
    s_waitcnt vmcnt(32)
    s_add_u32 s53, s52, 4096
    s_mov_b32 m0, 65536
    s_nop 0
    buffer_load_dwordx4 v4, s[20:23], s52 offen offset:0 nt lds
    buffer_load_dwordx4 v5, s[20:23], s52 offen offset:1024 nt lds
    buffer_load_dwordx4 v6, s[20:23], s52 offen offset:2048 nt lds
    buffer_load_dwordx4 v7, s[20:23], s52 offen offset:3072 nt lds
    s_mov_b32 m0, 69632
    s_nop 0
    buffer_load_dwordx4 v4, s[20:23], s53 offen offset:0 nt lds
    buffer_load_dwordx4 v5, s[20:23], s53 offen offset:1024 nt lds
    buffer_load_dwordx4 v6, s[20:23], s53 offen offset:2048 nt lds
    buffer_load_dwordx4 v7, s[20:23], s53 offen offset:3072 nt lds
    s_add_u32 s52, s52, 8192
    s_and_b32 s52, s52, 0x7ffff
    s_add_u32 s55, s54, 4096
    s_mov_b32 m0, 73728
    s_nop 0
    buffer_load_dwordx4 v8, s[24:27], s54 offen offset:0 nt lds
    buffer_load_dwordx4 v9, s[24:27], s54 offen offset:1024 nt lds
    buffer_load_dwordx4 v8, s[24:27], s54 offen offset:2048 nt lds
    buffer_load_dwordx4 v9, s[24:27], s54 offen offset:3072 nt lds
    s_mov_b32 m0, 77824
    s_nop 0
    buffer_load_dwordx4 v8, s[24:27], s55 offen offset:0 nt lds
    buffer_load_dwordx4 v9, s[24:27], s55 offen offset:1024 nt lds
    buffer_load_dwordx4 v8, s[24:27], s55 offen offset:2048 nt lds
    buffer_load_dwordx4 v9, s[24:27], s55 offen offset:3072 nt lds
    s_add_u32 s54, s54, 8192
    s_and_b32 s54, s54, 0x7ffff
    s_barrier
    s_branch L_q2J
L_q2B:
    s_waitcnt vmcnt(34)
    s_barrier
    s_mov_b32 m0, 129024
    s_nop 0
    buffer_load_dwordx4 v40, s[32:35], s48 offen offset:0  lds
    buffer_load_dwordx4 v41, s[32:35], s48 offen offset:1024  lds
    buffer_load_dwordx4 v42, s[32:35], s48 offen offset:2048  lds
    buffer_load_dwordx4 v43, s[32:35], s48 offen offset:3072  lds
    s_mov_b32 m0, 133120
    s_nop 0
    buffer_load_dwordx4 v44, s[32:35], s48 offen offset:0  lds
    buffer_load_dwordx4 v45, s[32:35], s48 offen offset:1024  lds
    buffer_load_dwordx4 v46, s[32:35], s48 offen offset:2048  lds
    buffer_load_dwordx4 v47, s[32:35], s48 offen offset:3072  lds
    s_add_u32 s48, s48, 262144
    s_and_b32 s48, s48, 0x3fffff
    s_mov_b32 m0, 137216
    s_nop 0
    buffer_load_dwordx4 v48, s[28:31], s49 offen offset:0  lds
    buffer_load_dwordx4 v49, s[28:31], s49 offen offset:1024  lds
    buffer_load_dwordx4 v50, s[28:31], s49 offen offset:2048  lds
    buffer_load_dwordx4 v51, s[28:31], s49 offen offset:3072  lds
    s_mov_b32 m0, 141312
    s_nop 0
    buffer_load_dwordx4 v52, s[28:31], s49 offen offset:0  lds
    buffer_load_dwordx4 v53, s[28:31], s49 offen offset:1024  lds
    buffer_load_dwordx4 v54, s[28:31], s49 offen offset:2048  lds
    buffer_load_dwordx4 v55, s[28:31], s49 offen offset:3072  lds
    s_mov_b32 m0, 145408
    s_nop 0
    buffer_load_dwordx4 v56, s[28:31], s49 offen offset:0  lds
    s_add_u32 s49, s49, 64
    s_and_b32 s49, s49, 1023
    s_waitcnt vmcnt(34)
    s_barrier
    s_mov_b32 m0, 146432
    s_nop 0
    buffer_load_dwordx4 v40, s[32:35], s48 offen offset:0  lds
    buffer_load_dwordx4 v41, s[32:35], s48 offen offset:1024  lds
    buffer_load_dwordx4 v42, s[32:35], s48 offen offset:2048  lds
    buffer_load_dwordx4 v43, s[32:35], s48 offen offset:3072  lds
    s_mov_b32 m0, 150528
    s_nop 0
    buffer_load_dwordx4 v44, s[32:35], s48 offen offset:0  lds
    buffer_load_dwordx4 v45, s[32:35], s48 offen offset:1024  lds
    buffer_load_dwordx4 v46, s[32:35], s48 offen offset:2048  lds
    buffer_load_dwordx4 v47, s[32:35], s48 offen offset:3072  lds
    s_add_u32 s48, s48, 262144
    s_and_b32 s48, s48, 0x3fffff
    s_mov_b32 m0, 154624
    s_nop 0
    buffer_load_dwordx4 v48, s[28:31], s49 offen offset:0  lds
    buffer_load_dwordx4 v49, s[28:31], s49 offen offset:1024  lds
    buffer_load_dwordx4 v50, s[28:31], s49 offen offset:2048  lds
    buffer_load_dwordx4 v51, s[28:31], s49 offen offset:3072  lds
    s_mov_b32 m0, 158720
    s_nop 0
    buffer_load_dwordx4 v52, s[28:31], s49 offen offset:0  lds
    buffer_load_dwordx4 v53, s[28:31], s49 offen offset:1024  lds
    buffer_load_dwordx4 v54, s[28:31], s49 offen offset:2048  lds
    buffer_load_dwordx4 v55, s[28:31], s49 offen offset:3072  lds
    s_mov_b32 m0, 162816
    s_nop 0
    buffer_load_dwordx4 v56, s[28:31], s49 offen offset:0  lds
    s_add_u32 s49, s49, 64
    s_and_b32 s49, s49, 1023
    s_add_u32 s53, s52, 4096
    s_mov_b32 m0, 81920
    s_nop 0
    buffer_load_dwordx4 v4, s[20:23], s52 offen offset:0 nt lds
    buffer_load_dwordx4 v5, s[20:23], s52 offen offset:1024 nt lds
    buffer_load_dwordx4 v6, s[20:23], s52 offen offset:2048 nt lds
    buffer_load_dwordx4 v7, s[20:23], s52 offen offset:3072 nt lds
    s_mov_b32 m0, 86016
    s_nop 0
    buffer_load_dwordx4 v4, s[20:23], s53 offen offset:0 nt lds
    buffer_load_dwordx4 v5, s[20:23], s53 offen offset:1024 nt lds
    buffer_load_dwordx4 v6, s[20:23], s53 offen offset:2048 nt lds
    buffer_load_dwordx4 v7, s[20:23], s53 offen offset:3072 nt lds
    s_add_u32 s52, s52, 8192
    s_and_b32 s52, s52, 0x7ffff
    s_waitcnt vmcnt(42)
    s_barrier
    s_add_u32 s53, s52, 4096
    s_mov_b32 m0, 0
    s_nop 0
    buffer_load_dwordx4 v4, s[20:23], s52 offen offset:0 nt lds
    buffer_load_dwordx4 v5, s[20:23], s52 offen offset:1024 nt lds
    buffer_load_dwordx4 v6, s[20:23], s52 offen offset:2048 nt lds
    buffer_load_dwordx4 v7, s[20:23], s52 offen offset:3072 nt lds
    s_mov_b32 m0, 4096
    s_nop 0
    buffer_load_dwordx4 v4, s[20:23], s53 offen offset:0 nt lds
    buffer_load_dwordx4 v5, s[20:23], s53 offen offset:1024 nt lds
    buffer_load_dwordx4 v6, s[20:23], s53 offen offset:2048 nt lds
    buffer_load_dwordx4 v7, s[20:23], s53 offen offset:3072 nt lds
    s_add_u32 s52, s52, 8192
    s_and_b32 s52, s52, 0x7ffff
    s_add_u32 s55, s54, 4096
    s_mov_b32 m0, 8192
    s_nop 0
    buffer_load_dwordx4 v8, s[24:27], s54 offen offset:0 nt lds
    buffer_load_dwordx4 v9, s[24:27], s54 offen offset:1024 nt lds
    buffer_load_dwordx4 v8, s[24:27], s54 offen offset:2048 nt lds
    buffer_load_dwordx4 v9, s[24:27], s54 offen offset:3072 nt lds
    s_mov_b32 m0, 12288
    s_nop 0
    buffer_load_dwordx4 v8, s[24:27], s55 offen offset:0 nt lds
    buffer_load_dwordx4 v9, s[24:27], s55 offen offset:1024 nt lds
    buffer_load_dwordx4 v8, s[24:27], s55 offen offset:2048 nt lds
    buffer_load_dwordx4 v9, s[24:27], s55 offen offset:3072 nt lds
    s_add_u32 s54, s54, 8192
    s_and_b32 s54, s54, 0x7ffff
    s_waitcnt vmcnt(41)
    s_barrier
    s_add_u32 s53, s52, 4096
    s_mov_b32 m0, 16384
    s_nop 0
    buffer_load_dwordx4 v4, s[20:23], s52 offen offset:0 nt lds
    buffer_load_dwordx4 v5, s[20:23], s52 offen offset:1024 nt lds
    buffer_load_dwordx4 v6, s[20:23], s52 offen offset:2048 nt lds
    buffer_load_dwordx4 v7, s[20:23], s52 offen offset:3072 nt lds
    s_mov_b32 m0, 20480
    s_nop 0
    buffer_load_dwordx4 v4, s[20:23], s53 offen offset:0 nt lds
    buffer_load_dwordx4 v5, s[20:23], s53 offen offset:1024 nt lds
    buffer_load_dwordx4 v6, s[20:23], s53 offen offset:2048 nt lds
    buffer_load_dwordx4 v7, s[20:23], s53 offen offset:3072 nt lds
    s_add_u32 s52, s52, 8192
    s_and_b32 s52, s52, 0x7ffff
    s_add_u32 s55, s54, 4096
    s_mov_b32 m0, 24576
    s_nop 0
    buffer_load_dwordx4 v8, s[24:27], s54 offen offset:0 nt lds
    buffer_load_dwordx4 v9, s[24:27], s54 offen offset:1024 nt lds
    buffer_load_dwordx4 v8, s[24:27], s54 offen offset:2048 nt lds
    buffer_load_dwordx4 v9, s[24:27], s54 offen offset:3072 nt lds
    s_mov_b32 m0, 28672
    s_nop 0
    buffer_load_dwordx4 v8, s[24:27], s55 offen offset:0 nt lds
    buffer_load_dwordx4 v9, s[24:27], s55 offen offset:1024 nt lds
    buffer_load_dwordx4 v8, s[24:27], s55 offen offset:2048 nt lds
    buffer_load_dwordx4 v9, s[24:27], s55 offen offset:3072 nt lds
    s_add_u32 s54, s54, 8192
    s_and_b32 s54, s54, 0x7ffff
    s_waitcnt vmcnt(40)
    s_barrier
    s_add_u32 s53, s52, 4096
    s_mov_b32 m0, 32768
    s_nop 0
    buffer_load_dwordx4 v4, s[20:23], s52 offen offset:0 nt lds
    buffer_load_dwordx4 v5, s[20:23], s52 offen offset:1024 nt lds
    buffer_load_dwordx4 v6, s[20:23], s52 offen offset:2048 nt lds
    buffer_load_dwordx4 v7, s[20:23], s52 offen offset:3072 nt lds
    s_mov_b32 m0, 36864
    s_nop 0
    buffer_load_dwordx4 v4, s[20:23], s53 offen offset:0 nt lds
    buffer_load_dwordx4 v5, s[20:23], s53 offen offset:1024 nt lds
    buffer_load_dwordx4 v6, s[20:23], s53 offen offset:2048 nt lds
    buffer_load_dwordx4 v7, s[20:23], s53 offen offset:3072 nt lds
    s_add_u32 s52, s52, 8192
    s_and_b32 s52, s52, 0x7ffff
    s_add_u32 s55, s54, 4096
    s_mov_b32 m0, 40960
    s_nop 0
    buffer_load_dwordx4 v8, s[24:27], s54 offen offset:0 nt lds
    buffer_load_dwordx4 v9, s[24:27], s54 offen offset:1024 nt lds
    buffer_load_dwordx4 v8, s[24:27], s54 offen offset:2048 nt lds
    buffer_load_dwordx4 v9, s[24:27], s54 offen offset:3072 nt lds
    s_mov_b32 m0, 45056
    s_nop 0
    buffer_load_dwordx4 v8, s[24:27], s55 offen offset:0 nt lds
    buffer_load_dwordx4 v9, s[24:27], s55 offen offset:1024 nt lds
    buffer_load_dwordx4 v8, s[24:27], s55 offen offset:2048 nt lds
    buffer_load_dwordx4 v9, s[24:27], s55 offen offset:3072 nt lds
    s_add_u32 s54, s54, 8192
    s_and_b32 s54, s54, 0x7ffff
    s_lshl_b32 s44, s40, 19
    s_lshl_b32 s45, s39, 8
    s_add_u32 s44, s44, s45
    s_sub_u32 s45, 0x400000, s44
    s_add_u32 s28, s12, s44
    s_addc_u32 s29, s13, 0
    s_and_b32 s29, s29, 0xffff
    s_mov_b32 s30, s45
    s_mov_b32 s31, 0x20000
    v_lshrrev_b32 v1, 4, v0
    v_and_b32 v2, 15, v0
    v_lshlrev_b32 v3, 1, v1
    v_xor_b32 v3, v2, v3
    v_lshlrev_b32 v3, 4, v3
    v_lshl_add_u32 v12, v1, 10, v3
    v_xor_b32 v13, 128, v12
    v_lshrrev_b32 v1, 1, v0
    v_and_b32 v2, 1, v0
    v_lshlrev_b32 v2, 7, v2
    v_lshl_add_u32 v14, v1, 10, v2
    s_add_u32 s44, s39, 0
    s_and_b32 s44, s44, 3
    s_lshl_b32 s90, s44, 17
    s_add_u32 s44, s39, 1
    s_and_b32 s44, s44, 3
    s_lshl_b32 s91, s44, 17
    s_add_u32 s44, s39, 2
    s_and_b32 s44, s44, 3
    s_lshl_b32 s92, s44, 17
    s_add_u32 s44, s39, 3
    s_and_b32 s44, s44, 3
    s_lshl_b32 s93, s44, 17
    s_waitcnt vmcnt(32)
    s_barrier
    s_add_u32 s53, s52, 4096
    s_mov_b32 m0, 49152
    s_nop 0
    buffer_load_dwordx4 v4, s[20:23], s52 offen offset:0 nt lds
    buffer_load_dwordx4 v5, s[20:23], s52 offen offset:1024 nt lds
    buffer_load_dwordx4 v6, s[20:23], s52 offen offset:2048 nt lds
    buffer_load_dwordx4 v7, s[20:23], s52 offen offset:3072 nt lds
    s_mov_b32 m0, 53248
    s_nop 0
    buffer_load_dwordx4 v4, s[20:23], s53 offen offset:0 nt lds
    buffer_load_dwordx4 v5, s[20:23], s53 offen offset:1024 nt lds
    buffer_load_dwordx4 v6, s[20:23], s53 offen offset:2048 nt lds
    buffer_load_dwordx4 v7, s[20:23], s53 offen offset:3072 nt lds
    s_add_u32 s52, s52, 8192
    s_and_b32 s52, s52, 0x7ffff
    s_add_u32 s55, s54, 4096
    s_mov_b32 m0, 57344
    s_nop 0
    buffer_load_dwordx4 v8, s[24:27], s54 offen offset:0 nt lds
    buffer_load_dwordx4 v9, s[24:27], s54 offen offset:1024 nt lds
    buffer_load_dwordx4 v8, s[24:27], s54 offen offset:2048 nt lds
    buffer_load_dwordx4 v9, s[24:27], s54 offen offset:3072 nt lds
    s_mov_b32 m0, 61440
    s_nop 0
    buffer_load_dwordx4 v8, s[24:27], s55 offen offset:0 nt lds
    buffer_load_dwordx4 v9, s[24:27], s55 offen offset:1024 nt lds
    buffer_load_dwordx4 v8, s[24:27], s55 offen offset:2048 nt lds
    buffer_load_dwordx4 v9, s[24:27], s55 offen offset:3072 nt lds
    s_add_u32 s54, s54, 8192
    s_and_b32 s54, s54, 0x7ffff
    s_waitcnt vmcnt(32)
    s_add_u32 s53, s52, 4096
    s_mov_b32 m0, 65536
    s_nop 0
    buffer_load_dwordx4 v4, s[20:23], s52 offen offset:0 nt lds
    buffer_load_dwordx4 v5, s[20:23], s52 offen offset:1024 nt lds
    buffer_load_dwordx4 v6, s[20:23], s52 offen offset:2048 nt lds
    buffer_load_dwordx4 v7, s[20:23], s52 offen offset:3072 nt lds
    s_mov_b32 m0, 69632
    s_nop 0
    buffer_load_dwordx4 v4, s[20:23], s53 offen offset:0 nt lds
    buffer_load_dwordx4 v5, s[20:23], s53 offen offset:1024 nt lds
    buffer_load_dwordx4 v6, s[20:23], s53 offen offset:2048 nt lds
    buffer_load_dwordx4 v7, s[20:23], s53 offen offset:3072 nt lds
    s_add_u32 s52, s52, 8192
    s_and_b32 s52, s52, 0x7ffff
    s_add_u32 s55, s54, 4096
    s_mov_b32 m0, 73728
    s_nop 0
    buffer_load_dwordx4 v8, s[24:27], s54 offen offset:0 nt lds
    buffer_load_dwordx4 v9, s[24:27], s54 offen offset:1024 nt lds
    buffer_load_dwordx4 v8, s[24:27], s54 offen offset:2048 nt lds
    buffer_load_dwordx4 v9, s[24:27], s54 offen offset:3072 nt lds
    s_mov_b32 m0, 77824
    s_nop 0
    buffer_load_dwordx4 v8, s[24:27], s55 offen offset:0 nt lds
    buffer_load_dwordx4 v9, s[24:27], s55 offen offset:1024 nt lds
    buffer_load_dwordx4 v8, s[24:27], s55 offen offset:2048 nt lds
    buffer_load_dwordx4 v9, s[24:27], s55 offen offset:3072 nt lds
    s_add_u32 s54, s54, 8192
    s_and_b32 s54, s54, 0x7ffff
    s_barrier
L_q2J:
    s_waitcnt vmcnt(40)
    s_add_u32 s53, s52, 4096
    s_mov_b32 m0, 81920
    s_nop 0
    buffer_load_dwordx4 v4, s[20:23], s52 offen offset:0 nt lds
    buffer_load_dwordx4 v5, s[20:23], s52 offen offset:1024 nt lds
    buffer_load_dwordx4 v6, s[20:23], s52 offen offset:2048 nt lds
    buffer_load_dwordx4 v7, s[20:23], s52 offen offset:3072 nt lds
    s_mov_b32 m0, 86016
    s_nop 0
    buffer_load_dwordx4 v4, s[20:23], s53 offen offset:0 nt lds
    buffer_load_dwordx4 v5, s[20:23], s53 offen offset:1024 nt lds
    buffer_load_dwordx4 v6, s[20:23], s53 offen offset:2048 nt lds
    buffer_load_dwordx4 v7, s[20:23], s53 offen offset:3072 nt lds
    s_add_u32 s52, s52, 8192
    s_and_b32 s52, s52, 0x7ffff
    s_waitcnt vmcnt(40)
    s_add_u32 s55, s54, 4096
    s_mov_b32 m0, 90112
    s_nop 0
    buffer_load_dwordx4 v8, s[24:27], s54 offen offset:0 nt lds
    buffer_load_dwordx4 v9, s[24:27], s54 offen offset:1024 nt lds
    buffer_load_dwordx4 v8, s[24:27], s54 offen offset:2048 nt lds
    buffer_load_dwordx4 v9, s[24:27], s54 offen offset:3072 nt lds
    s_mov_b32 m0, 94208
    s_nop 0
    buffer_load_dwordx4 v8, s[24:27], s55 offen offset:0 nt lds
    buffer_load_dwordx4 v9, s[24:27], s55 offen offset:1024 nt lds
    buffer_load_dwordx4 v8, s[24:27], s55 offen offset:2048 nt lds
    buffer_load_dwordx4 v9, s[24:27], s55 offen offset:3072 nt lds
    s_add_u32 s54, s54, 8192
    s_and_b32 s54, s54, 0x7ffff
    s_barrier
    s_waitcnt vmcnt(40)
    s_add_u32 s53, s52, 4096
    s_mov_b32 m0, 98304
    s_nop 0
    buffer_load_dwordx4 v4, s[20:23], s52 offen offset:0 nt lds
    buffer_load_dwordx4 v5, s[20:23], s52 offen offset:1024 nt lds
    buffer_load_dwordx4 v6, s[20:23], s52 offen offset:2048 nt lds
    buffer_load_dwordx4 v7, s[20:23], s52 offen offset:3072 nt lds
    s_mov_b32 m0, 102400
    s_nop 0
    buffer_load_dwordx4 v4, s[20:23], s53 offen offset:0 nt lds
    buffer_load_dwordx4 v5, s[20:23], s53 offen offset:1024 nt lds
    buffer_load_dwordx4 v6, s[20:23], s53 offen offset:2048 nt lds
    buffer_load_dwordx4 v7, s[20:23], s53 offen offset:3072 nt lds
    s_add_u32 s52, s52, 8192
    s_and_b32 s52, s52, 0x7ffff
    s_waitcnt vmcnt(40)
    s_add_u32 s55, s54, 4096
    s_mov_b32 m0, 106496
    s_nop 0
    buffer_load_dwordx4 v8, s[24:27], s54 offen offset:0 nt lds
    buffer_load_dwordx4 v9, s[24:27], s54 offen offset:1024 nt lds
    buffer_load_dwordx4 v8, s[24:27], s54 offen offset:2048 nt lds
    buffer_load_dwordx4 v9, s[24:27], s54 offen offset:3072 nt lds
    s_mov_b32 m0, 110592
    s_nop 0
    buffer_load_dwordx4 v8, s[24:27], s55 offen offset:0 nt lds
    buffer_load_dwordx4 v9, s[24:27], s55 offen offset:1024 nt lds
    buffer_load_dwordx4 v8, s[24:27], s55 offen offset:2048 nt lds
    buffer_load_dwordx4 v9, s[24:27], s55 offen offset:3072 nt lds
    s_add_u32 s54, s54, 8192
    s_and_b32 s54, s54, 0x7ffff
    s_lshl_b32 s56, s37, 16
    s_add_u32 s56, s56, 0
    buffer_load_dword v20, v14, s[28:31], s56 offen
    s_lshl_b32 s56, s37, 16
    s_add_u32 s56, s56, 32768
    buffer_load_dword v21, v14, s[28:31], s56 offen
    s_barrier
    s_waitcnt vmcnt(42)
    s_add_u32 s53, s52, 4096
    s_mov_b32 m0, 114688
    s_nop 0
    buffer_load_dwordx4 v4, s[20:23], s52 offen offset:0 nt lds
    buffer_load_dwordx4 v5, s[20:23], s52 offen offset:1024 nt lds
    buffer_load_dwordx4 v6, s[20:23], s52 offen offset:2048 nt lds
    buffer_load_dwordx4 v7, s[20:23], s52 offen offset:3072 nt lds
    s_mov_b32 m0, 118784
    s_nop 0
    buffer_load_dwordx4 v4, s[20:23], s53 offen offset:0 nt lds
    buffer_load_dwordx4 v5, s[20:23], s53 offen offset:1024 nt lds
    buffer_load_dwordx4 v6, s[20:23], s53 offen offset:2048 nt lds
    buffer_load_dwordx4 v7, s[20:23], s53 offen offset:3072 nt lds
    s_add_u32 s52, s52, 8192
    s_and_b32 s52, s52, 0x7ffff
    s_waitcnt vmcnt(42)
    s_add_u32 s55, s54, 4096
    s_mov_b32 m0, 122880
    s_nop 0
    buffer_load_dwordx4 v8, s[24:27], s54 offen offset:0 nt lds
    buffer_load_dwordx4 v9, s[24:27], s54 offen offset:1024 nt lds
    buffer_load_dwordx4 v8, s[24:27], s54 offen offset:2048 nt lds
    buffer_load_dwordx4 v9, s[24:27], s54 offen offset:3072 nt lds
    s_mov_b32 m0, 126976
    s_nop 0
    buffer_load_dwordx4 v8, s[24:27], s55 offen offset:0 nt lds
    buffer_load_dwordx4 v9, s[24:27], s55 offen offset:1024 nt lds
    buffer_load_dwordx4 v8, s[24:27], s55 offen offset:2048 nt lds
    buffer_load_dwordx4 v9, s[24:27], s55 offen offset:3072 nt lds
    s_add_u32 s54, s54, 8192
    s_and_b32 s54, s54, 0x7ffff
    s_mov_b32 m0, 131072
    s_add_u32 s56, s90, 0
    buffer_load_dwordx4 v12, s[28:31], s56 offen  lds
    s_mov_b32 m0, 132096
    s_add_u32 s56, s90, 4096
    buffer_load_dwordx4 v13, s[28:31], s56 offen  lds
    s_mov_b32 m0, 133120
    s_add_u32 s56, s90, 8192
    buffer_load_dwordx4 v12, s[28:31], s56 offen  lds
    s_mov_b32 m0, 134144
    s_add_u32 s56, s90, 12288
    buffer_load_dwordx4 v13, s[28:31], s56 offen  lds
    s_mov_b32 m0, 135168
    s_add_u32 s56, s90, 16384
    buffer_load_dwordx4 v12, s[28:31], s56 offen  lds
    s_mov_b32 m0, 136192
    s_add_u32 s56, s90, 20480
    buffer_load_dwordx4 v13, s[28:31], s56 offen  lds
    s_mov_b32 m0, 137216
    s_add_u32 s56, s90, 24576
    buffer_load_dwordx4 v12, s[28:31], s56 offen  lds
    s_mov_b32 m0, 138240
    s_add_u32 s56, s90, 28672
    buffer_load_dwordx4 v13, s[28:31], s56 offen  lds
    s_barrier
    s_waitcnt vmcnt(50)
    s_add_u32 s53, s52, 4096
    s_mov_b32 m0, 0
    s_nop 0
    buffer_load_dwordx4 v4, s[20:23], s52 offen offset:0 nt lds
    buffer_load_dwordx4 v5, s[20:23], s52 offen offset:1024 nt lds
    buffer_load_dwordx4 v6, s[20:23], s52 offen offset:2048 nt lds
    buffer_load_dwordx4 v7, s[20:23], s52 offen offset:3072 nt lds
    s_mov_b32 m0, 4096
    s_nop 0
    buffer_load_dwordx4 v4, s[20:23], s53 offen offset:0 nt lds
    buffer_load_dwordx4 v5, s[20:23], s53 offen offset:1024 nt lds
    buffer_load_dwordx4 v6, s[20:23], s53 offen offset:2048 nt lds
    buffer_load_dwordx4 v7, s[20:23], s53 offen offset:3072 nt lds
    s_add_u32 s52, s52, 8192
    s_and_b32 s52, s52, 0x7ffff
    s_waitcnt vmcnt(50)
    s_add_u32 s55, s54, 4096
    s_mov_b32 m0, 8192
    s_nop 0
    buffer_load_dwordx4 v8, s[24:27], s54 offen offset:0 nt lds
    buffer_load_dwordx4 v9, s[24:27], s54 offen offset:1024 nt lds
    buffer_load_dwordx4 v8, s[24:27], s54 offen offset:2048 nt lds
    buffer_load_dwordx4 v9, s[24:27], s54 offen offset:3072 nt lds
    s_mov_b32 m0, 12288
    s_nop 0
    buffer_load_dwordx4 v8, s[24:27], s55 offen offset:0 nt lds
    buffer_load_dwordx4 v9, s[24:27], s55 offen offset:1024 nt lds
    buffer_load_dwordx4 v8, s[24:27], s55 offen offset:2048 nt lds
    buffer_load_dwordx4 v9, s[24:27], s55 offen offset:3072 nt lds
    s_add_u32 s54, s54, 8192
    s_and_b32 s54, s54, 0x7ffff
    s_waitcnt vmcnt(55)
    s_mov_b32 m0, 139264
    s_add_u32 s56, s90, 32768
    buffer_load_dwordx4 v12, s[28:31], s56 offen  lds
    s_mov_b32 m0, 140288
    s_add_u32 s56, s90, 36864
    buffer_load_dwordx4 v13, s[28:31], s56 offen  lds
    s_mov_b32 m0, 141312
    s_add_u32 s56, s90, 40960
    buffer_load_dwordx4 v12, s[28:31], s56 offen  lds
    s_mov_b32 m0, 142336
    s_add_u32 s56, s90, 45056
    buffer_load_dwordx4 v13, s[28:31], s56 offen  lds
    s_mov_b32 m0, 143360
    s_add_u32 s56, s90, 49152
    buffer_load_dwordx4 v12, s[28:31], s56 offen  lds
    s_mov_b32 m0, 144384
    s_add_u32 s56, s90, 53248
    buffer_load_dwordx4 v13, s[28:31], s56 offen  lds
    s_mov_b32 m0, 145408
    s_add_u32 s56, s90, 57344
    buffer_load_dwordx4 v12, s[28:31], s56 offen  lds
    s_mov_b32 m0, 146432
    s_add_u32 s56, s90, 61440
    buffer_load_dwordx4 v13, s[28:31], s56 offen  lds
    s_barrier
    s_waitcnt vmcnt(58)
    s_waitcnt vmcnt(55)
    s_add_u32 s53, s52, 4096
    s_mov_b32 m0, 16384
    s_nop 0
    buffer_load_dwordx4 v4, s[20:23], s52 offen offset:0 nt lds
    buffer_load_dwordx4 v5, s[20:23], s52 offen offset:1024 nt lds
    buffer_load_dwordx4 v6, s[20:23], s52 offen offset:2048 nt lds
    buffer_load_dwordx4 v7, s[20:23], s52 offen offset:3072 nt lds
    s_mov_b32 m0, 20480
    s_nop 0
    buffer_load_dwordx4 v4, s[20:23], s53 offen offset:0 nt lds
    buffer_load_dwordx4 v5, s[20:23], s53 offen offset:1024 nt lds
    buffer_load_dwordx4 v6, s[20:23], s53 offen offset:2048 nt lds
    buffer_load_dwordx4 v7, s[20:23], s53 offen offset:3072 nt lds
    s_add_u32 s52, s52, 8192
    s_and_b32 s52, s52, 0x7ffff
    s_waitcnt vmcnt(58)
    s_waitcnt vmcnt(55)
    s_add_u32 s55, s54, 4096
    s_mov_b32 m0, 24576
    s_nop 0
    buffer_load_dwordx4 v8, s[24:27], s54 offen offset:0 nt lds
    buffer_load_dwordx4 v9, s[24:27], s54 offen offset:1024 nt lds
    buffer_load_dwordx4 v8, s[24:27], s54 offen offset:2048 nt lds
    buffer_load_dwordx4 v9, s[24:27], s54 offen offset:3072 nt lds
    s_mov_b32 m0, 28672
    s_nop 0
    buffer_load_dwordx4 v8, s[24:27], s55 offen offset:0 nt lds
    buffer_load_dwordx4 v9, s[24:27], s55 offen offset:1024 nt lds
    buffer_load_dwordx4 v8, s[24:27], s55 offen offset:2048 nt lds
    buffer_load_dwordx4 v9, s[24:27], s55 offen offset:3072 nt lds
    s_add_u32 s54, s54, 8192
    s_and_b32 s54, s54, 0x7ffff
    s_waitcnt vmcnt(55)
    s_mov_b32 m0, 147456
    s_add_u32 s56, s90, 65536
    buffer_load_dwordx4 v12, s[28:31], s56 offen  lds
    s_mov_b32 m0, 148480
    s_add_u32 s56, s90, 69632
    buffer_load_dwordx4 v13, s[28:31], s56 offen  lds
    s_mov_b32 m0, 149504
    s_add_u32 s56, s90, 73728
    buffer_load_dwordx4 v12, s[28:31], s56 offen  lds
    s_mov_b32 m0, 150528
    s_add_u32 s56, s90, 77824
    buffer_load_dwordx4 v13, s[28:31], s56 offen  lds
    s_mov_b32 m0, 151552
    s_add_u32 s56, s90, 81920
    buffer_load_dwordx4 v12, s[28:31], s56 offen  lds
    s_mov_b32 m0, 152576
    s_add_u32 s56, s90, 86016
    buffer_load_dwordx4 v13, s[28:31], s56 offen  lds
    s_mov_b32 m0, 153600
    s_add_u32 s56, s90, 90112
    buffer_load_dwordx4 v12, s[28:31], s56 offen  lds
    s_mov_b32 m0, 154624
    s_add_u32 s56, s90, 94208
    buffer_load_dwordx4 v13, s[28:31], s56 offen  lds
    s_barrier
    s_waitcnt vmcnt(55)
    s_add_u32 s53, s52, 4096
    s_mov_b32 m0, 32768
    s_nop 0
    buffer_load_dwordx4 v4, s[20:23], s52 offen offset:0 nt lds
    buffer_load_dwordx4 v5, s[20:23], s52 offen offset:1024 nt lds
    buffer_load_dwordx4 v6, s[20:23], s52 offen offset:2048 nt lds
    buffer_load_dwordx4 v7, s[20:23], s52 offen offset:3072 nt lds
    s_mov_b32 m0, 36864
    s_nop 0
    buffer_load_dwordx4 v4, s[20:23], s53 offen offset:0 nt lds
    buffer_load_dwordx4 v5, s[20:23], s53 offen offset:1024 nt lds
    buffer_load_dwordx4 v6, s[20:23], s53 offen offset:2048 nt lds
    buffer_load_dwordx4 v7, s[20:23], s53 offen offset:3072 nt lds
    s_add_u32 s52, s52, 8192
    s_and_b32 s52, s52, 0x7ffff
    s_waitcnt vmcnt(55)
    s_add_u32 s55, s54, 4096
    s_mov_b32 m0, 40960
    s_nop 0
    buffer_load_dwordx4 v8, s[24:27], s54 offen offset:0 nt lds
    buffer_load_dwordx4 v9, s[24:27], s54 offen offset:1024 nt lds
    buffer_load_dwordx4 v8, s[24:27], s54 offen offset:2048 nt lds
    buffer_load_dwordx4 v9, s[24:27], s54 offen offset:3072 nt lds
    s_mov_b32 m0, 45056
    s_nop 0
    buffer_load_dwordx4 v8, s[24:27], s55 offen offset:0 nt lds
    buffer_load_dwordx4 v9, s[24:27], s55 offen offset:1024 nt lds
    buffer_load_dwordx4 v8, s[24:27], s55 offen offset:2048 nt lds
    buffer_load_dwordx4 v9, s[24:27], s55 offen offset:3072 nt lds
    s_add_u32 s54, s54, 8192
    s_and_b32 s54, s54, 0x7ffff
    s_waitcnt vmcnt(55)
    s_mov_b32 m0, 155648
    s_add_u32 s56, s90, 98304
    buffer_load_dwordx4 v12, s[28:31], s56 offen  lds
    s_mov_b32 m0, 156672
    s_add_u32 s56, s90, 102400
    buffer_load_dwordx4 v13, s[28:31], s56 offen  lds
    s_mov_b32 m0, 157696
    s_add_u32 s56, s90, 106496
    buffer_load_dwordx4 v12, s[28:31], s56 offen  lds
    s_mov_b32 m0, 158720
    s_add_u32 s56, s90, 110592
    buffer_load_dwordx4 v13, s[28:31], s56 offen  lds
    s_mov_b32 m0, 159744
    s_add_u32 s56, s90, 114688
    buffer_load_dwordx4 v12, s[28:31], s56 offen  lds
    s_mov_b32 m0, 160768
    s_add_u32 s56, s90, 118784
    buffer_load_dwordx4 v13, s[28:31], s56 offen  lds
    s_mov_b32 m0, 161792
    s_add_u32 s56, s90, 122880
    buffer_load_dwordx4 v12, s[28:31], s56 offen  lds
    s_mov_b32 m0, 162816
    s_add_u32 s56, s90, 126976
    buffer_load_dwordx4 v13, s[28:31], s56 offen  lds
    s_barrier
    s_waitcnt vmcnt(55)
    s_add_u32 s53, s52, 4096
    s_mov_b32 m0, 49152
    s_nop 0
    buffer_load_dwordx4 v4, s[20:23], s52 offen offset:0 nt lds
    buffer_load_dwordx4 v5, s[20:23], s52 offen offset:1024 nt lds
    buffer_load_dwordx4 v6, s[20:23], s52 offen offset:2048 nt lds
    buffer_load_dwordx4 v7, s[20:23], s52 offen offset:3072 nt lds
    s_mov_b32 m0, 53248
    s_nop 0
    buffer_load_dwordx4 v4, s[20:23], s53 offen offset:0 nt lds
    buffer_load_dwordx4 v5, s[20:23], s53 offen offset:1024 nt lds
    buffer_load_dwordx4 v6, s[20:23], s53 offen offset:2048 nt lds
    buffer_load_dwordx4 v7, s[20:23], s53 offen offset:3072 nt lds
    s_add_u32 s52, s52, 8192
    s_and_b32 s52, s52, 0x7ffff
    s_waitcnt vmcnt(55)
    s_add_u32 s55, s54, 4096
    s_mov_b32 m0, 57344
    s_nop 0
    buffer_load_dwordx4 v8, s[24:27], s54 offen offset:0 nt lds
    buffer_load_dwordx4 v9, s[24:27], s54 offen offset:1024 nt lds
    buffer_load_dwordx4 v8, s[24:27], s54 offen offset:2048 nt lds
    buffer_load_dwordx4 v9, s[24:27], s54 offen offset:3072 nt lds
    s_mov_b32 m0, 61440
    s_nop 0
    buffer_load_dwordx4 v8, s[24:27], s55 offen offset:0 nt lds
    buffer_load_dwordx4 v9, s[24:27], s55 offen offset:1024 nt lds
    buffer_load_dwordx4 v8, s[24:27], s55 offen offset:2048 nt lds
    buffer_load_dwordx4 v9, s[24:27], s55 offen offset:3072 nt lds
    s_add_u32 s54, s54, 8192
    s_and_b32 s54, s54, 0x7ffff
    s_barrier
    s_waitcnt vmcnt(56)
    s_waitcnt vmcnt(55)
    s_add_u32 s53, s52, 4096
    s_mov_b32 m0, 65536
    s_nop 0
    buffer_load_dwordx4 v4, s[20:23], s52 offen offset:0 nt lds
    buffer_load_dwordx4 v5, s[20:23], s52 offen offset:1024 nt lds
    buffer_load_dwordx4 v6, s[20:23], s52 offen offset:2048 nt lds
    buffer_load_dwordx4 v7, s[20:23], s52 offen offset:3072 nt lds
    s_mov_b32 m0, 69632
    s_nop 0
    buffer_load_dwordx4 v4, s[20:23], s53 offen offset:0 nt lds
    buffer_load_dwordx4 v5, s[20:23], s53 offen offset:1024 nt lds
    buffer_load_dwordx4 v6, s[20:23], s53 offen offset:2048 nt lds
    buffer_load_dwordx4 v7, s[20:23], s53 offen offset:3072 nt lds
    s_add_u32 s52, s52, 8192
    s_and_b32 s52, s52, 0x7ffff
    s_waitcnt vmcnt(56)
    s_waitcnt vmcnt(55)
    s_add_u32 s55, s54, 4096
    s_mov_b32 m0, 73728
    s_nop 0
    buffer_load_dwordx4 v8, s[24:27], s54 offen offset:0 nt lds
    buffer_load_dwordx4 v9, s[24:27], s54 offen offset:1024 nt lds
    buffer_load_dwordx4 v8, s[24:27], s54 offen offset:2048 nt lds
    buffer_load_dwordx4 v9, s[24:27], s54 offen offset:3072 nt lds
    s_mov_b32 m0, 77824
    s_nop 0
    buffer_load_dwordx4 v8, s[24:27], s55 offen offset:0 nt lds
    buffer_load_dwordx4 v9, s[24:27], s55 offen offset:1024 nt lds
    buffer_load_dwordx4 v8, s[24:27], s55 offen offset:2048 nt lds
    buffer_load_dwordx4 v9, s[24:27], s55 offen offset:3072 nt lds
    s_add_u32 s54, s54, 8192
    s_and_b32 s54, s54, 0x7ffff
    s_barrier
    s_waitcnt vmcnt(48)
    s_add_u32 s53, s52, 4096
    s_mov_b32 m0, 81920
    s_nop 0
    buffer_load_dwordx4 v4, s[20:23], s52 offen offset:0 nt lds
    buffer_load_dwordx4 v5, s[20:23], s52 offen offset:1024 nt lds
    buffer_load_dwordx4 v6, s[20:23], s52 offen offset:2048 nt lds
    buffer_load_dwordx4 v7, s[20:23], s52 offen offset:3072 nt lds
    s_mov_b32 m0, 86016
    s_nop 0
    buffer_load_dwordx4 v4, s[20:23], s53 offen offset:0 nt lds
    buffer_load_dwordx4 v5, s[20:23], s53 offen offset:1024 nt lds
    buffer_load_dwordx4 v6, s[20:23], s53 offen offset:2048 nt lds
    buffer_load_dwordx4 v7, s[20:23], s53 offen offset:3072 nt lds
    s_add_u32 s52, s52, 8192
    s_and_b32 s52, s52, 0x7ffff
    s_waitcnt vmcnt(48)
    s_add_u32 s55, s54, 4096
    s_mov_b32 m0, 90112
    s_nop 0
    buffer_load_dwordx4 v8, s[24:27], s54 offen offset:0 nt lds
    buffer_load_dwordx4 v9, s[24:27], s54 offen offset:1024 nt lds
    buffer_load_dwordx4 v8, s[24:27], s54 offen offset:2048 nt lds
    buffer_load_dwordx4 v9, s[24:27], s54 offen offset:3072 nt lds
    s_mov_b32 m0, 94208
    s_nop 0
    buffer_load_dwordx4 v8, s[24:27], s55 offen offset:0 nt lds
    buffer_load_dwordx4 v9, s[24:27], s55 offen offset:1024 nt lds
    buffer_load_dwordx4 v8, s[24:27], s55 offen offset:2048 nt lds
    buffer_load_dwordx4 v9, s[24:27], s55 offen offset:3072 nt lds
    s_add_u32 s54, s54, 8192
    s_and_b32 s54, s54, 0x7ffff
    s_barrier
    s_waitcnt vmcnt(40)
    s_add_u32 s53, s52, 4096
    s_mov_b32 m0, 98304
    s_nop 0
    buffer_load_dwordx4 v4, s[20:23], s52 offen offset:0 nt lds
    buffer_load_dwordx4 v5, s[20:23], s52 offen offset:1024 nt lds
    buffer_load_dwordx4 v6, s[20:23], s52 offen offset:2048 nt lds
    buffer_load_dwordx4 v7, s[20:23], s52 offen offset:3072 nt lds
    s_mov_b32 m0, 102400
    s_nop 0
    buffer_load_dwordx4 v4, s[20:23], s53 offen offset:0 nt lds
    buffer_load_dwordx4 v5, s[20:23], s53 offen offset:1024 nt lds
    buffer_load_dwordx4 v6, s[20:23], s53 offen offset:2048 nt lds
    buffer_load_dwordx4 v7, s[20:23], s53 offen offset:3072 nt lds
    s_add_u32 s52, s52, 8192
    s_and_b32 s52, s52, 0x7ffff
    s_waitcnt vmcnt(40)
    s_add_u32 s55, s54, 4096
    s_mov_b32 m0, 106496
    s_nop 0
    buffer_load_dwordx4 v8, s[24:27], s54 offen offset:0 nt lds
    buffer_load_dwordx4 v9, s[24:27], s54 offen offset:1024 nt lds
    buffer_load_dwordx4 v8, s[24:27], s54 offen offset:2048 nt lds
    buffer_load_dwordx4 v9, s[24:27], s54 offen offset:3072 nt lds
    s_mov_b32 m0, 110592
    s_nop 0
    buffer_load_dwordx4 v8, s[24:27], s55 offen offset:0 nt lds
    buffer_load_dwordx4 v9, s[24:27], s55 offen offset:1024 nt lds
    buffer_load_dwordx4 v8, s[24:27], s55 offen offset:2048 nt lds
    buffer_load_dwordx4 v9, s[24:27], s55 offen offset:3072 nt lds
    s_add_u32 s54, s54, 8192
    s_and_b32 s54, s54, 0x7ffff
    s_barrier
    s_mov_b32 s59, 0
L_ldloop:
    s_waitcnt vmcnt(40)
    s_add_u32 s53, s52, 4096
    s_mov_b32 m0, 114688
    s_nop 0
    buffer_load_dwordx4 v4, s[20:23], s52 offen offset:0 nt lds
    buffer_load_dwordx4 v5, s[20:23], s52 offen offset:1024 nt lds
    buffer_load_dwordx4 v6, s[20:23], s52 offen offset:2048 nt lds
    buffer_load_dwordx4 v7, s[20:23], s52 offen offset:3072 nt lds
    s_mov_b32 m0, 118784
    s_nop 0
    buffer_load_dwordx4 v4, s[20:23], s53 offen offset:0 nt lds
    buffer_load_dwordx4 v5, s[20:23], s53 offen offset:1024 nt lds
    buffer_load_dwordx4 v6, s[20:23], s53 offen offset:2048 nt lds
    buffer_load_dwordx4 v7, s[20:23], s53 offen offset:3072 nt lds
    s_add_u32 s52, s52, 8192
    s_and_b32 s52, s52, 0x7ffff
    s_waitcnt vmcnt(40)
    s_add_u32 s55, s54, 4096
    s_mov_b32 m0, 122880
    s_nop 0
    buffer_load_dwordx4 v8, s[24:27], s54 offen offset:0 nt lds
    buffer_load_dwordx4 v9, s[24:27], s54 offen offset:1024 nt lds
    buffer_load_dwordx4 v8, s[24:27], s54 offen offset:2048 nt lds
    buffer_load_dwordx4 v9, s[24:27], s54 offen offset:3072 nt lds
    s_mov_b32 m0, 126976
    s_nop 0
    buffer_load_dwordx4 v8, s[24:27], s55 offen offset:0 nt lds
    buffer_load_dwordx4 v9, s[24:27], s55 offen offset:1024 nt lds
    buffer_load_dwordx4 v8, s[24:27], s55 offen offset:2048 nt lds
    buffer_load_dwordx4 v9, s[24:27], s55 offen offset:3072 nt lds
    s_add_u32 s54, s54, 8192
    s_and_b32 s54, s54, 0x7ffff
    s_barrier
    s_waitcnt vmcnt(40)
    s_add_u32 s53, s52, 4096
    s_mov_b32 m0, 0
    s_nop 0
    buffer_load_dwordx4 v4, s[20:23], s52 offen offset:0 nt lds
    buffer_load_dwordx4 v5, s[20:23], s52 offen offset:1024 nt lds
    buffer_load_dwordx4 v6, s[20:23], s52 offen offset:2048 nt lds
    buffer_load_dwordx4 v7, s[20:23], s52 offen offset:3072 nt lds
    s_mov_b32 m0, 4096
    s_nop 0
    buffer_load_dwordx4 v4, s[20:23], s53 offen offset:0 nt lds
    buffer_load_dwordx4 v5, s[20:23], s53 offen offset:1024 nt lds
    buffer_load_dwordx4 v6, s[20:23], s53 offen offset:2048 nt lds
    buffer_load_dwordx4 v7, s[20:23], s53 offen offset:3072 nt lds
    s_add_u32 s52, s52, 8192
    s_and_b32 s52, s52, 0x7ffff
    s_waitcnt vmcnt(40)
    s_add_u32 s55, s54, 4096
    s_mov_b32 m0, 8192
    s_nop 0
    buffer_load_dwordx4 v8, s[24:27], s54 offen offset:0 nt lds
    buffer_load_dwordx4 v9, s[24:27], s54 offen offset:1024 nt lds
    buffer_load_dwordx4 v8, s[24:27], s54 offen offset:2048 nt lds
    buffer_load_dwordx4 v9, s[24:27], s54 offen offset:3072 nt lds
    s_mov_b32 m0, 12288
    s_nop 0
    buffer_load_dwordx4 v8, s[24:27], s55 offen offset:0 nt lds
    buffer_load_dwordx4 v9, s[24:27], s55 offen offset:1024 nt lds
    buffer_load_dwordx4 v8, s[24:27], s55 offen offset:2048 nt lds
    buffer_load_dwordx4 v9, s[24:27], s55 offen offset:3072 nt lds
    s_add_u32 s54, s54, 8192
    s_and_b32 s54, s54, 0x7ffff
    s_barrier
    s_waitcnt vmcnt(40)
    s_add_u32 s53, s52, 4096
    s_mov_b32 m0, 16384
    s_nop 0
    buffer_load_dwordx4 v4, s[20:23], s52 offen offset:0 nt lds
    buffer_load_dwordx4 v5, s[20:23], s52 offen offset:1024 nt lds
    buffer_load_dwordx4 v6, s[20:23], s52 offen offset:2048 nt lds
    buffer_load_dwordx4 v7, s[20:23], s52 offen offset:3072 nt lds
    s_mov_b32 m0, 20480
    s_nop 0
    buffer_load_dwordx4 v4, s[20:23], s53 offen offset:0 nt lds
    buffer_load_dwordx4 v5, s[20:23], s53 offen offset:1024 nt lds
    buffer_load_dwordx4 v6, s[20:23], s53 offen offset:2048 nt lds
    buffer_load_dwordx4 v7, s[20:23], s53 offen offset:3072 nt lds
    s_add_u32 s52, s52, 8192
    s_and_b32 s52, s52, 0x7ffff
    s_waitcnt vmcnt(40)
    s_add_u32 s55, s54, 4096
    s_mov_b32 m0, 24576
    s_nop 0
    buffer_load_dwordx4 v8, s[24:27], s54 offen offset:0 nt lds
    buffer_load_dwordx4 v9, s[24:27], s54 offen offset:1024 nt lds
    buffer_load_dwordx4 v8, s[24:27], s54 offen offset:2048 nt lds
    buffer_load_dwordx4 v9, s[24:27], s54 offen offset:3072 nt lds
    s_mov_b32 m0, 28672
    s_nop 0
    buffer_load_dwordx4 v8, s[24:27], s55 offen offset:0 nt lds
    buffer_load_dwordx4 v9, s[24:27], s55 offen offset:1024 nt lds
    buffer_load_dwordx4 v8, s[24:27], s55 offen offset:2048 nt lds
    buffer_load_dwordx4 v9, s[24:27], s55 offen offset:3072 nt lds
    s_add_u32 s54, s54, 8192
    s_and_b32 s54, s54, 0x7ffff
    s_barrier
    s_waitcnt vmcnt(40)
    s_add_u32 s53, s52, 4096
    s_mov_b32 m0, 32768
    s_nop 0
    buffer_load_dwordx4 v4, s[20:23], s52 offen offset:0 nt lds
    buffer_load_dwordx4 v5, s[20:23], s52 offen offset:1024 nt lds
    buffer_load_dwordx4 v6, s[20:23], s52 offen offset:2048 nt lds
    buffer_load_dwordx4 v7, s[20:23], s52 offen offset:3072 nt lds
    s_mov_b32 m0, 36864
    s_nop 0
    buffer_load_dwordx4 v4, s[20:23], s53 offen offset:0 nt lds
    buffer_load_dwordx4 v5, s[20:23], s53 offen offset:1024 nt lds
    buffer_load_dwordx4 v6, s[20:23], s53 offen offset:2048 nt lds
    buffer_load_dwordx4 v7, s[20:23], s53 offen offset:3072 nt lds
    s_add_u32 s52, s52, 8192
    s_and_b32 s52, s52, 0x7ffff
    s_waitcnt vmcnt(40)
    s_add_u32 s55, s54, 4096
    s_mov_b32 m0, 40960
    s_nop 0
    buffer_load_dwordx4 v8, s[24:27], s54 offen offset:0 nt lds
    buffer_load_dwordx4 v9, s[24:27], s54 offen offset:1024 nt lds
    buffer_load_dwordx4 v8, s[24:27], s54 offen offset:2048 nt lds
    buffer_load_dwordx4 v9, s[24:27], s54 offen offset:3072 nt lds
    s_mov_b32 m0, 45056
    s_nop 0
    buffer_load_dwordx4 v8, s[24:27], s55 offen offset:0 nt lds
    buffer_load_dwordx4 v9, s[24:27], s55 offen offset:1024 nt lds
    buffer_load_dwordx4 v8, s[24:27], s55 offen offset:2048 nt lds
    buffer_load_dwordx4 v9, s[24:27], s55 offen offset:3072 nt lds
    s_add_u32 s54, s54, 8192
    s_and_b32 s54, s54, 0x7ffff
    s_barrier
    s_waitcnt vmcnt(40)
    s_add_u32 s53, s52, 4096
    s_mov_b32 m0, 49152
    s_nop 0
    buffer_load_dwordx4 v4, s[20:23], s52 offen offset:0 nt lds
    buffer_load_dwordx4 v5, s[20:23], s52 offen offset:1024 nt lds
    buffer_load_dwordx4 v6, s[20:23], s52 offen offset:2048 nt lds
    buffer_load_dwordx4 v7, s[20:23], s52 offen offset:3072 nt lds
    s_mov_b32 m0, 53248
    s_nop 0
    buffer_load_dwordx4 v4, s[20:23], s53 offen offset:0 nt lds
    buffer_load_dwordx4 v5, s[20:23], s53 offen offset:1024 nt lds
    buffer_load_dwordx4 v6, s[20:23], s53 offen offset:2048 nt lds
    buffer_load_dwordx4 v7, s[20:23], s53 offen offset:3072 nt lds
    s_add_u32 s52, s52, 8192
    s_and_b32 s52, s52, 0x7ffff
    s_waitcnt vmcnt(40)
    s_add_u32 s55, s54, 4096
    s_mov_b32 m0, 57344
    s_nop 0
    buffer_load_dwordx4 v8, s[24:27], s54 offen offset:0 nt lds
    buffer_load_dwordx4 v9, s[24:27], s54 offen offset:1024 nt lds
    buffer_load_dwordx4 v8, s[24:27], s54 offen offset:2048 nt lds
    buffer_load_dwordx4 v9, s[24:27], s54 offen offset:3072 nt lds
    s_mov_b32 m0, 61440
    s_nop 0
    buffer_load_dwordx4 v8, s[24:27], s55 offen offset:0 nt lds
    buffer_load_dwordx4 v9, s[24:27], s55 offen offset:1024 nt lds
    buffer_load_dwordx4 v8, s[24:27], s55 offen offset:2048 nt lds
    buffer_load_dwordx4 v9, s[24:27], s55 offen offset:3072 nt lds
    s_add_u32 s54, s54, 8192
    s_and_b32 s54, s54, 0x7ffff
    s_barrier
    s_waitcnt vmcnt(40)
    s_add_u32 s53, s52, 4096
    s_mov_b32 m0, 65536
    s_nop 0
    buffer_load_dwordx4 v4, s[20:23], s52 offen offset:0 nt lds
    buffer_load_dwordx4 v5, s[20:23], s52 offen offset:1024 nt lds
    buffer_load_dwordx4 v6, s[20:23], s52 offen offset:2048 nt lds
    buffer_load_dwordx4 v7, s[20:23], s52 offen offset:3072 nt lds
    s_mov_b32 m0, 69632
    s_nop 0
    buffer_load_dwordx4 v4, s[20:23], s53 offen offset:0 nt lds
    buffer_load_dwordx4 v5, s[20:23], s53 offen offset:1024 nt lds
    buffer_load_dwordx4 v6, s[20:23], s53 offen offset:2048 nt lds
    buffer_load_dwordx4 v7, s[20:23], s53 offen offset:3072 nt lds
    s_add_u32 s52, s52, 8192
    s_and_b32 s52, s52, 0x7ffff
    s_waitcnt vmcnt(40)
    s_add_u32 s55, s54, 4096
    s_mov_b32 m0, 73728
    s_nop 0
    buffer_load_dwordx4 v8, s[24:27], s54 offen offset:0 nt lds
    buffer_load_dwordx4 v9, s[24:27], s54 offen offset:1024 nt lds
    buffer_load_dwordx4 v8, s[24:27], s54 offen offset:2048 nt lds
    buffer_load_dwordx4 v9, s[24:27], s54 offen offset:3072 nt lds
    s_mov_b32 m0, 77824
    s_nop 0
    buffer_load_dwordx4 v8, s[24:27], s55 offen offset:0 nt lds
    buffer_load_dwordx4 v9, s[24:27], s55 offen offset:1024 nt lds
    buffer_load_dwordx4 v8, s[24:27], s55 offen offset:2048 nt lds
    buffer_load_dwordx4 v9, s[24:27], s55 offen offset:3072 nt lds
    s_add_u32 s54, s54, 8192
    s_and_b32 s54, s54, 0x7ffff
    s_barrier
    s_waitcnt vmcnt(40)
    s_add_u32 s53, s52, 4096
    s_mov_b32 m0, 81920
    s_nop 0
    buffer_load_dwordx4 v4, s[20:23], s52 offen offset:0 nt lds
    buffer_load_dwordx4 v5, s[20:23], s52 offen offset:1024 nt lds
    buffer_load_dwordx4 v6, s[20:23], s52 offen offset:2048 nt lds
    buffer_load_dwordx4 v7, s[20:23], s52 offen offset:3072 nt lds
    s_mov_b32 m0, 86016
    s_nop 0
    buffer_load_dwordx4 v4, s[20:23], s53 offen offset:0 nt lds
    buffer_load_dwordx4 v5, s[20:23], s53 offen offset:1024 nt lds
    buffer_load_dwordx4 v6, s[20:23], s53 offen offset:2048 nt lds
    buffer_load_dwordx4 v7, s[20:23], s53 offen offset:3072 nt lds
    s_add_u32 s52, s52, 8192
    s_and_b32 s52, s52, 0x7ffff
    s_waitcnt vmcnt(40)
    s_add_u32 s55, s54, 4096
    s_mov_b32 m0, 90112
    s_nop 0
    buffer_load_dwordx4 v8, s[24:27], s54 offen offset:0 nt lds
    buffer_load_dwordx4 v9, s[24:27], s54 offen offset:1024 nt lds
    buffer_load_dwordx4 v8, s[24:27], s54 offen offset:2048 nt lds
    buffer_load_dwordx4 v9, s[24:27], s54 offen offset:3072 nt lds
    s_mov_b32 m0, 94208
    s_nop 0
    buffer_load_dwordx4 v8, s[24:27], s55 offen offset:0 nt lds
    buffer_load_dwordx4 v9, s[24:27], s55 offen offset:1024 nt lds
    buffer_load_dwordx4 v8, s[24:27], s55 offen offset:2048 nt lds
    buffer_load_dwordx4 v9, s[24:27], s55 offen offset:3072 nt lds
    s_add_u32 s54, s54, 8192
    s_and_b32 s54, s54, 0x7ffff
    s_barrier
    s_waitcnt vmcnt(40)
    s_add_u32 s53, s52, 4096
    s_mov_b32 m0, 98304
    s_nop 0
    buffer_load_dwordx4 v4, s[20:23], s52 offen offset:0 nt lds
    buffer_load_dwordx4 v5, s[20:23], s52 offen offset:1024 nt lds
    buffer_load_dwordx4 v6, s[20:23], s52 offen offset:2048 nt lds
    buffer_load_dwordx4 v7, s[20:23], s52 offen offset:3072 nt lds
    s_mov_b32 m0, 102400
    s_nop 0
    buffer_load_dwordx4 v4, s[20:23], s53 offen offset:0 nt lds
    buffer_load_dwordx4 v5, s[20:23], s53 offen offset:1024 nt lds
    buffer_load_dwordx4 v6, s[20:23], s53 offen offset:2048 nt lds
    buffer_load_dwordx4 v7, s[20:23], s53 offen offset:3072 nt lds
    s_add_u32 s52, s52, 8192
    s_and_b32 s52, s52, 0x7ffff
    s_waitcnt vmcnt(40)
    s_add_u32 s55, s54, 4096
    s_mov_b32 m0, 106496
    s_nop 0
    buffer_load_dwordx4 v8, s[24:27], s54 offen offset:0 nt lds
    buffer_load_dwordx4 v9, s[24:27], s54 offen offset:1024 nt lds
    buffer_load_dwordx4 v8, s[24:27], s54 offen offset:2048 nt lds
    buffer_load_dwordx4 v9, s[24:27], s54 offen offset:3072 nt lds
    s_mov_b32 m0, 110592
    s_nop 0
    buffer_load_dwordx4 v8, s[24:27], s55 offen offset:0 nt lds
    buffer_load_dwordx4 v9, s[24:27], s55 offen offset:1024 nt lds
    buffer_load_dwordx4 v8, s[24:27], s55 offen offset:2048 nt lds
    buffer_load_dwordx4 v9, s[24:27], s55 offen offset:3072 nt lds
    s_add_u32 s54, s54, 8192
    s_and_b32 s54, s54, 0x7ffff
    s_barrier
    s_add_u32 s59, s59, 1
    s_cmp_lt_u32 s59, 6
    s_cbranch_scc1 L_ldloop
    s_waitcnt vmcnt(32)
    s_add_u32 s55, s54, 4096
    s_mov_b32 m0, 122880
    s_nop 0
    buffer_load_dwordx4 v8, s[24:27], s54 offen offset:0 nt lds
    buffer_load_dwordx4 v9, s[24:27], s54 offen offset:1024 nt lds
    buffer_load_dwordx4 v8, s[24:27], s54 offen offset:2048 nt lds
    buffer_load_dwordx4 v9, s[24:27], s54 offen offset:3072 nt lds
    s_mov_b32 m0, 126976
    s_nop 0
    buffer_load_dwordx4 v8, s[24:27], s55 offen offset:0 nt lds
    buffer_load_dwordx4 v9, s[24:27], s55 offen offset:1024 nt lds
    buffer_load_dwordx4 v8, s[24:27], s55 offen offset:2048 nt lds
    buffer_load_dwordx4 v9, s[24:27], s55 offen offset:3072 nt lds
    s_add_u32 s54, s54, 8192
    s_and_b32 s54, s54, 0x7ffff
    s_barrier
    s_mov_b32 m0, 0
    s_add_u32 s56, s91, 0
    buffer_load_dwordx4 v12, s[28:31], s56 offen  lds
    s_mov_b32 m0, 1024
    s_add_u32 s56, s91, 4096
    buffer_load_dwordx4 v13, s[28:31], s56 offen  lds
    s_mov_b32 m0, 2048
    s_add_u32 s56, s91, 8192
    buffer_load_dwordx4 v12, s[28:31], s56 offen  lds
    s_mov_b32 m0, 3072
    s_add_u32 s56, s91, 12288
    buffer_load_dwordx4 v13, s[28:31], s56 offen  lds
    s_mov_b32 m0, 4096
    s_add_u32 s56, s91, 16384
    buffer_load_dwordx4 v12, s[28:31], s56 offen  lds
    s_mov_b32 m0, 5120
    s_add_u32 s56, s91, 20480
    buffer_load_dwordx4 v13, s[28:31], s56 offen  lds
    s_mov_b32 m0, 6144
    s_add_u32 s56, s91, 24576
    buffer_load_dwordx4 v12, s[28:31], s56 offen  lds
    s_mov_b32 m0, 7168
    s_add_u32 s56, s91, 28672
    buffer_load_dwordx4 v13, s[28:31], s56 offen  lds
    s_mov_b32 m0, 8192
    s_add_u32 s56, s91, 32768
    buffer_load_dwordx4 v12, s[28:31], s56 offen  lds
    s_mov_b32 m0, 9216
    s_add_u32 s56, s91, 36864
    buffer_load_dwordx4 v13, s[28:31], s56 offen  lds
    s_mov_b32 m0, 10240
    s_add_u32 s56, s91, 40960
    buffer_load_dwordx4 v12, s[28:31], s56 offen  lds
    s_mov_b32 m0, 11264
    s_add_u32 s56, s91, 45056
    buffer_load_dwordx4 v13, s[28:31], s56 offen  lds
    s_mov_b32 m0, 12288
    s_add_u32 s56, s91, 49152
    buffer_load_dwordx4 v12, s[28:31], s56 offen  lds
    s_mov_b32 m0, 13312
    s_add_u32 s56, s91, 53248
    buffer_load_dwordx4 v13, s[28:31], s56 offen  lds
    s_mov_b32 m0, 14336
    s_add_u32 s56, s91, 57344
    buffer_load_dwordx4 v12, s[28:31], s56 offen  lds
    s_mov_b32 m0, 15360
    s_add_u32 s56, s91, 61440
    buffer_load_dwordx4 v13, s[28:31], s56 offen  lds
    s_waitcnt vmcnt(55)
    s_mov_b32 m0, 16384
    s_add_u32 s56, s91, 65536
    buffer_load_dwordx4 v12, s[28:31], s56 offen  lds
    s_mov_b32 m0, 17408
    s_add_u32 s56, s91, 69632
    buffer_load_dwordx4 v13, s[28:31], s56 offen  lds
    s_mov_b32 m0, 18432
    s_add_u32 s56, s91, 73728
    buffer_load_dwordx4 v12, s[28:31], s56 offen  lds
    s_mov_b32 m0, 19456
    s_add_u32 s56, s91, 77824
    buffer_load_dwordx4 v13, s[28:31], s56 offen  lds
    s_mov_b32 m0, 20480
    s_add_u32 s56, s91, 81920
    buffer_load_dwordx4 v12, s[28:31], s56 offen  lds
    s_mov_b32 m0, 21504
    s_add_u32 s56, s91, 86016
    buffer_load_dwordx4 v13, s[28:31], s56 offen  lds
    s_mov_b32 m0, 22528
    s_add_u32 s56, s91, 90112
    buffer_load_dwordx4 v12, s[28:31], s56 offen  lds
    s_mov_b32 m0, 23552
    s_add_u32 s56, s91, 94208
    buffer_load_dwordx4 v13, s[28:31], s56 offen  lds
    s_waitcnt vmcnt(55)
    s_mov_b32 m0, 24576
    s_add_u32 s56, s91, 98304
    buffer_load_dwordx4 v12, s[28:31], s56 offen  lds
    s_mov_b32 m0, 25600
    s_add_u32 s56, s91, 102400
    buffer_load_dwordx4 v13, s[28:31], s56 offen  lds
    s_mov_b32 m0, 26624
    s_add_u32 s56, s91, 106496
    buffer_load_dwordx4 v12, s[28:31], s56 offen  lds
    s_mov_b32 m0, 27648
    s_add_u32 s56, s91, 110592
    buffer_load_dwordx4 v13, s[28:31], s56 offen  lds
    s_mov_b32 m0, 28672
    s_add_u32 s56, s91, 114688
    buffer_load_dwordx4 v12, s[28:31], s56 offen  lds
    s_mov_b32 m0, 29696
    s_add_u32 s56, s91, 118784
    buffer_load_dwordx4 v13, s[28:31], s56 offen  lds
    s_mov_b32 m0, 30720
    s_add_u32 s56, s91, 122880
    buffer_load_dwordx4 v12, s[28:31], s56 offen  lds
    s_mov_b32 m0, 31744
    s_add_u32 s56, s91, 126976
    buffer_load_dwordx4 v13, s[28:31], s56 offen  lds
    s_waitcnt vmcnt(56)
    s_barrier
    s_waitcnt vmcnt(55)
    s_mov_b32 m0, 32768
    s_add_u32 s56, s92, 0
    buffer_load_dwordx4 v12, s[28:31], s56 offen  lds
    s_mov_b32 m0, 33792
    s_add_u32 s56, s92, 4096
    buffer_load_dwordx4 v13, s[28:31], s56 offen  lds
    s_mov_b32 m0, 34816
    s_add_u32 s56, s92, 8192
    buffer_load_dwordx4 v12, s[28:31], s56 offen  lds
    s_mov_b32 m0, 35840
    s_add_u32 s56, s92, 12288
    buffer_load_dwordx4 v13, s[28:31], s56 offen  lds
    s_mov_b32 m0, 36864
    s_add_u32 s56, s92, 16384
    buffer_load_dwordx4 v12, s[28:31], s56 offen  lds
    s_mov_b32 m0, 37888
    s_add_u32 s56, s92, 20480
    buffer_load_dwordx4 v13, s[28:31], s56 offen  lds
    s_mov_b32 m0, 38912
    s_add_u32 s56, s92, 24576
    buffer_load_dwordx4 v12, s[28:31], s56 offen  lds
    s_mov_b32 m0, 39936
    s_add_u32 s56, s92, 28672
    buffer_load_dwordx4 v13, s[28:31], s56 offen  lds
    s_waitcnt vmcnt(55)
    s_mov_b32 m0, 40960
    s_add_u32 s56, s92, 32768
    buffer_load_dwordx4 v12, s[28:31], s56 offen  lds
    s_mov_b32 m0, 41984
    s_add_u32 s56, s92, 36864
    buffer_load_dwordx4 v13, s[28:31], s56 offen  lds
    s_mov_b32 m0, 43008
    s_add_u32 s56, s92, 40960
    buffer_load_dwordx4 v12, s[28:31], s56 offen  lds
    s_mov_b32 m0, 44032
    s_add_u32 s56, s92, 45056
    buffer_load_dwordx4 v13, s[28:31], s56 offen  lds
    s_mov_b32 m0, 45056
    s_add_u32 s56, s92, 49152
    buffer_load_dwordx4 v12, s[28:31], s56 offen  lds
    s_mov_b32 m0, 46080
    s_add_u32 s56, s92, 53248
    buffer_load_dwordx4 v13, s[28:31], s56 offen  lds
    s_mov_b32 m0, 47104
    s_add_u32 s56, s92, 57344
    buffer_load_dwordx4 v12, s[28:31], s56 offen  lds
    s_mov_b32 m0, 48128
    s_add_u32 s56, s92, 61440
    buffer_load_dwordx4 v13, s[28:31], s56 offen  lds
    s_waitcnt vmcnt(55)
    s_mov_b32 m0, 49152
    s_add_u32 s56, s92, 65536
    buffer_load_dwordx4 v12, s[28:31], s56 offen  lds
    s_mov_b32 m0, 50176
    s_add_u32 s56, s92, 69632
    buffer_load_dwordx4 v13, s[28:31], s56 offen  lds
    s_mov_b32 m0, 51200
    s_add_u32 s56, s92, 73728
    buffer_load_dwordx4 v12, s[28:31], s56 offen  lds
    s_mov_b32 m0, 52224
    s_add_u32 s56, s92, 77824
    buffer_load_dwordx4 v13, s[28:31], s56 offen  lds
    s_mov_b32 m0, 53248
    s_add_u32 s56, s92, 81920
    buffer_load_dwordx4 v12, s[28:31], s56 offen  lds
    s_mov_b32 m0, 54272
    s_add_u32 s56, s92, 86016
    buffer_load_dwordx4 v13, s[28:31], s56 offen  lds
    s_mov_b32 m0, 55296
    s_add_u32 s56, s92, 90112
    buffer_load_dwordx4 v12, s[28:31], s56 offen  lds
    s_mov_b32 m0, 56320
    s_add_u32 s56, s92, 94208
    buffer_load_dwordx4 v13, s[28:31], s56 offen  lds
    s_waitcnt vmcnt(55)
    s_mov_b32 m0, 57344
    s_add_u32 s56, s92, 98304
    buffer_load_dwordx4 v12, s[28:31], s56 offen  lds
    s_mov_b32 m0, 58368
    s_add_u32 s56, s92, 102400
    buffer_load_dwordx4 v13, s[28:31], s56 offen  lds
    s_mov_b32 m0, 59392
    s_add_u32 s56, s92, 106496
    buffer_load_dwordx4 v12, s[28:31], s56 offen  lds
    s_mov_b32 m0, 60416
    s_add_u32 s56, s92, 110592
    buffer_load_dwordx4 v13, s[28:31], s56 offen  lds
    s_mov_b32 m0, 61440
    s_add_u32 s56, s92, 114688
    buffer_load_dwordx4 v12, s[28:31], s56 offen  lds
    s_mov_b32 m0, 62464
    s_add_u32 s56, s92, 118784
    buffer_load_dwordx4 v13, s[28:31], s56 offen  lds
    s_mov_b32 m0, 63488
    s_add_u32 s56, s92, 122880
    buffer_load_dwordx4 v12, s[28:31], s56 offen  lds
    s_mov_b32 m0, 64512
    s_add_u32 s56, s92, 126976
    buffer_load_dwordx4 v13, s[28:31], s56 offen  lds
    s_barrier
    s_waitcnt vmcnt(55)
    s_mov_b32 m0, 65536
    s_add_u32 s56, s93, 0
    buffer_load_dwordx4 v12, s[28:31], s56 offen  lds
    s_mov_b32 m0, 66560
    s_add_u32 s56, s93, 4096
    buffer_load_dwordx4 v13, s[28:31], s56 offen  lds
    s_mov_b32 m0, 67584
    s_add_u32 s56, s93, 8192
    buffer_load_dwordx4 v12, s[28:31], s56 offen  lds
    s_mov_b32 m0, 68608
    s_add_u32 s56, s93, 12288
    buffer_load_dwordx4 v13, s[28:31], s56 offen  lds
    s_mov_b32 m0, 69632
    s_add_u32 s56, s93, 16384
    buffer_load_dwordx4 v12, s[28:31], s56 offen  lds
    s_mov_b32 m0, 70656
    s_add_u32 s56, s93, 20480
    buffer_load_dwordx4 v13, s[28:31], s56 offen  lds
    s_mov_b32 m0, 71680
    s_add_u32 s56, s93, 24576
    buffer_load_dwordx4 v12, s[28:31], s56 offen  lds
    s_mov_b32 m0, 72704
    s_add_u32 s56, s93, 28672
    buffer_load_dwordx4 v13, s[28:31], s56 offen  lds
    s_waitcnt vmcnt(55)
    s_mov_b32 m0, 73728
    s_add_u32 s56, s93, 32768
    buffer_load_dwordx4 v12, s[28:31], s56 offen  lds
    s_mov_b32 m0, 74752
    s_add_u32 s56, s93, 36864
    buffer_load_dwordx4 v13, s[28:31], s56 offen  lds
    s_mov_b32 m0, 75776
    s_add_u32 s56, s93, 40960
    buffer_load_dwordx4 v12, s[28:31], s56 offen  lds
    s_mov_b32 m0, 76800
    s_add_u32 s56, s93, 45056
    buffer_load_dwordx4 v13, s[28:31], s56 offen  lds
    s_mov_b32 m0, 77824
    s_add_u32 s56, s93, 49152
    buffer_load_dwordx4 v12, s[28:31], s56 offen  lds
    s_mov_b32 m0, 78848
    s_add_u32 s56, s93, 53248
    buffer_load_dwordx4 v13, s[28:31], s56 offen  lds
    s_mov_b32 m0, 79872
    s_add_u32 s56, s93, 57344
    buffer_load_dwordx4 v12, s[28:31], s56 offen  lds
    s_mov_b32 m0, 80896
    s_add_u32 s56, s93, 61440
    buffer_load_dwordx4 v13, s[28:31], s56 offen  lds
    s_waitcnt vmcnt(55)
    s_mov_b32 m0, 81920
    s_add_u32 s56, s93, 65536
    buffer_load_dwordx4 v12, s[28:31], s56 offen  lds
    s_mov_b32 m0, 82944
    s_add_u32 s56, s93, 69632
    buffer_load_dwordx4 v13, s[28:31], s56 offen  lds
    s_mov_b32 m0, 83968
    s_add_u32 s56, s93, 73728
    buffer_load_dwordx4 v12, s[28:31], s56 offen  lds
    s_mov_b32 m0, 84992
    s_add_u32 s56, s93, 77824
    buffer_load_dwordx4 v13, s[28:31], s56 offen  lds
    s_mov_b32 m0, 86016
    s_add_u32 s56, s93, 81920
    buffer_load_dwordx4 v12, s[28:31], s56 offen  lds
    s_mov_b32 m0, 87040
    s_add_u32 s56, s93, 86016
    buffer_load_dwordx4 v13, s[28:31], s56 offen  lds
    s_mov_b32 m0, 88064
    s_add_u32 s56, s93, 90112
    buffer_load_dwordx4 v12, s[28:31], s56 offen  lds
    s_mov_b32 m0, 89088
    s_add_u32 s56, s93, 94208
    buffer_load_dwordx4 v13, s[28:31], s56 offen  lds
    s_waitcnt vmcnt(55)
    s_mov_b32 m0, 90112
    s_add_u32 s56, s93, 98304
    buffer_load_dwordx4 v12, s[28:31], s56 offen  lds
    s_mov_b32 m0, 91136
    s_add_u32 s56, s93, 102400
    buffer_load_dwordx4 v13, s[28:31], s56 offen  lds
    s_mov_b32 m0, 92160
    s_add_u32 s56, s93, 106496
    buffer_load_dwordx4 v12, s[28:31], s56 offen  lds
    s_mov_b32 m0, 93184
    s_add_u32 s56, s93, 110592
    buffer_load_dwordx4 v13, s[28:31], s56 offen  lds
    s_mov_b32 m0, 94208
    s_add_u32 s56, s93, 114688
    buffer_load_dwordx4 v12, s[28:31], s56 offen  lds
    s_mov_b32 m0, 95232
    s_add_u32 s56, s93, 118784
    buffer_load_dwordx4 v13, s[28:31], s56 offen  lds
    s_mov_b32 m0, 96256
    s_add_u32 s56, s93, 122880
    buffer_load_dwordx4 v12, s[28:31], s56 offen  lds
    s_mov_b32 m0, 97280
    s_add_u32 s56, s93, 126976
    buffer_load_dwordx4 v13, s[28:31], s56 offen  lds
    s_barrier
    s_waitcnt vmcnt(0)
    s_barrier
    s_endpgm
L_compute:
    s_waitcnt lgkmcnt(0)
    s_lshl_b32 s44, s41, 19
    s_lshr_b32 s45, s41, 13
    s_add_u32 s20, s6, s44
    s_addc_u32 s21, s7, s45
    s_and_b32 s21, s21, 0xffff
    s_mov_b32 s22, 0x80000
    s_mov_b32 s23, 0x20000
    s_add_u32 s24, s8, s44
    s_addc_u32 s25, s9, s45
    s_and_b32 s25, s25, 0xffff
    s_mov_b32 s26, 0x80000
    s_mov_b32 s27, 0x20000
    s_mov_b32 s60, 0
    v_lshrrev_b32 v1, 4, v0
    v_bfe_u32 v2, v0, 2, 2
    v_and_b32 v3, 3, v0
    v_lshl_add_u32 v5, v1, 3, v2
    v_lshlrev_b32 v5, 8, v5
    v_add_u32 v5, 94208, v5
    v_xor_b32 v6, 0, v2
    v_lshl_add_u32 v6, v6, 2, v3
    v_lshl_add_u32 v208, v6, 4, v5
    v_xor_b32 v6, 1, v2
    v_lshl_add_u32 v6, v6, 2, v3
    v_lshl_add_u32 v209, v6, 4, v5
    v_xor_b32 v6, 2, v2
    v_lshl_add_u32 v6, v6, 2, v3
    v_lshl_add_u32 v210, v6, 4, v5
    v_xor_b32 v6, 3, v2
    v_lshl_add_u32 v6, v6, 2, v3
    v_lshl_add_u32 v211, v6, 4, v5
    v_and_b32 v2, 15, v0
    v_lshrrev_b32 v3, 2, v2
    v_sub_u32 v3, 0, v3
    v_and_b32 v3, 3, v3
    v_xor_b32 v3, v3, v1
    s_mul_i32 s46, s36, 3072
    s_add_u32 s46, s46, 94208
    v_lshlrev_b32 v3, 4, v3
    v_lshl_add_u32 v3, v2, 6, v3
    v_add_u32 v212, s46, v3
    v_lshrrev_b32 v1, 4, v0
    v_and_b32 v2, 15, v0
    v_xor_b32 v3, v1, v2
    v_xor_b32 v4, 0, v3
    v_lshlrev_b32 v4, 4, v4
    v_lshl_add_u32 v184, v2, 8, v4
    v_add_u32 v188, 0x10000, v184
    v_xor_b32 v4, 4, v3
    v_lshlrev_b32 v4, 4, v4
    v_lshl_add_u32 v185, v2, 8, v4
    v_add_u32 v189, 0x10000, v185
    v_xor_b32 v4, 8, v3
    v_lshlrev_b32 v4, 4, v4
    v_lshl_add_u32 v186, v2, 8, v4
    v_add_u32 v190, 0x10000, v186
    v_xor_b32 v4, 12, v3
    v_lshlrev_b32 v4, 4, v4
    v_lshl_add_u32 v187, v2, 8, v4
    v_add_u32 v191, 0x10000, v187
    v_lshrrev_b32 v5, 2, v0
    v_and_b32 v6, 3, v0
    v_and_b32 v7, 7, v5
    v_lshlrev_b32 v7, 1, v7
    v_lshrrev_b32 v8, 1, v6
    v_xor_b32 v7, v7, v8
    v_and_b32 v8, 1, v6
    v_lshlrev_b32 v8, 3, v8
    v_lshl_add_u32 v8, v5, 8, v8
    v_xor_b32 v9, 0, v7
    v_lshl_add_u32 v192, v9, 4, v8
    v_add_u32 v200, 65536, v192
    v_xor_b32 v9, 2, v7
    v_lshl_add_u32 v193, v9, 4, v8
    v_add_u32 v201, 65536, v193
    v_xor_b32 v9, 4, v7
    v_lshl_add_u32 v194, v9, 4, v8
    v_add_u32 v202, 65536, v194
    v_xor_b32 v9, 6, v7
    v_lshl_add_u32 v195, v9, 4, v8
    v_add_u32 v203, 65536, v195
    v_xor_b32 v9, 8, v7
    v_lshl_add_u32 v196, v9, 4, v8
    v_add_u32 v204, 65536, v196
    v_xor_b32 v9, 10, v7
    v_lshl_add_u32 v197, v9, 4, v8
    v_add_u32 v205, 65536, v197
    v_xor_b32 v9, 12, v7
    v_lshl_add_u32 v198, v9, 4, v8
    v_add_u32 v206, 65536, v198
    v_xor_b32 v9, 14, v7
    v_lshl_add_u32 v199, v9, 4, v8
    v_add_u32 v207, 65536, v199
    s_mov_b32 s44, 0x3f803f80
    v_accvgpr_write_b32 a124, s44
    v_accvgpr_write_b32 a125, s44
    v_accvgpr_write_b32 a126, s44
    v_accvgpr_write_b32 a127, s44
    v_accvgpr_write_b32 a112, 0
    v_accvgpr_write_b32 a113, 0
    v_accvgpr_write_b32 a114, 0
    v_accvgpr_write_b32 a115, 0
    v_accvgpr_write_b32 a116, 0
    v_accvgpr_write_b32 a117, 0
    v_accvgpr_write_b32 a118, 0
    v_accvgpr_write_b32 a119, 0
    v_accvgpr_write_b32 a120, 0
    v_accvgpr_write_b32 a121, 0
    v_accvgpr_write_b32 a122, 0
    v_accvgpr_write_b32 a123, 0
    v_mov_b32 v16, 0
    v_mov_b32 v17, 0
    v_mov_b32 v18, 0
    v_mov_b32 v19, 0
    v_mov_b32 v20, 0
    v_mov_b32 v21, 0
    v_mov_b32 v22, 0
    v_mov_b32 v23, 0
    v_mov_b32 v24, 0
    v_mov_b32 v25, 0
    v_mov_b32 v26, 0
    v_mov_b32 v27, 0
    v_mov_b32 v28, 0
    v_mov_b32 v29, 0
    v_mov_b32 v30, 0
    v_mov_b32 v31, 0
    v_mov_b32 v32, 0
    v_mov_b32 v33, 0
    v_mov_b32 v34, 0
    v_mov_b32 v35, 0
    v_mov_b32 v36, 0
    v_mov_b32 v37, 0
    v_mov_b32 v38, 0
    v_mov_b32 v39, 0
    v_mov_b32 v40, 0
    v_mov_b32 v41, 0
    v_mov_b32 v42, 0
    v_mov_b32 v43, 0
    v_mov_b32 v44, 0
    v_mov_b32 v45, 0
    v_mov_b32 v46, 0
    v_mov_b32 v47, 0
    v_mov_b32 v48, 0
    v_mov_b32 v49, 0
    v_mov_b32 v50, 0
    v_mov_b32 v51, 0
    v_mov_b32 v52, 0
    v_mov_b32 v53, 0
    v_mov_b32 v54, 0
    v_mov_b32 v55, 0
    v_mov_b32 v56, 0
    v_mov_b32 v57, 0
    v_mov_b32 v58, 0
    v_mov_b32 v59, 0
    v_mov_b32 v60, 0
    v_mov_b32 v61, 0
    v_mov_b32 v62, 0
    v_mov_b32 v63, 0
    v_mov_b32 v64, 0
    v_mov_b32 v65, 0
    v_mov_b32 v66, 0
    v_mov_b32 v67, 0
    v_mov_b32 v68, 0
    v_mov_b32 v69, 0
    v_mov_b32 v70, 0
    v_mov_b32 v71, 0
    v_mov_b32 v72, 0
    v_mov_b32 v73, 0
    v_mov_b32 v74, 0
    v_mov_b32 v75, 0
    v_mov_b32 v76, 0
    v_mov_b32 v77, 0
    v_mov_b32 v78, 0
    v_mov_b32 v79, 0
    v_mov_b32 v80, 0
    v_mov_b32 v81, 0
    v_mov_b32 v82, 0
    v_mov_b32 v83, 0
    v_mov_b32 v84, 0
    v_mov_b32 v85, 0
    v_mov_b32 v86, 0
    v_mov_b32 v87, 0
    v_mov_b32 v88, 0
    v_mov_b32 v89, 0
    v_mov_b32 v90, 0
    v_mov_b32 v91, 0
    v_mov_b32 v92, 0
    v_mov_b32 v93, 0
    v_mov_b32 v94, 0
    v_mov_b32 v95, 0
    v_mov_b32 v96, 0
    v_mov_b32 v97, 0
    v_mov_b32 v98, 0
    v_mov_b32 v99, 0
    v_mov_b32 v100, 0
    v_mov_b32 v101, 0
    v_mov_b32 v102, 0
    v_mov_b32 v103, 0
    v_mov_b32 v104, 0
    v_mov_b32 v105, 0
    v_mov_b32 v106, 0
    v_mov_b32 v107, 0
    v_mov_b32 v108, 0
    v_mov_b32 v109, 0
    v_mov_b32 v110, 0
    v_mov_b32 v111, 0
    v_mov_b32 v248, 0
    s_mul_i32 s44, s2, 3
    s_add_u32 s44, s44, s36
    s_lshl_b32 s44, s44, 8
    s_add_u32 s44, s44, 33554432
    s_add_u32 s88, s18, s44
    s_addc_u32 s89, s19, 0
    v_and_b32 v14, 3, v0
    v_lshlrev_b32 v247, 3, v14
    s_lshl_b32 s44, s37, 5
    s_lshl_b32 s45, s40, 2
    s_add_u32 s44, s44, s45
    s_mul_i32 s44, s44, 36864
    s_add_u32 s28, s18, s44
    s_addc_u32 s29, s19, 0
    s_and_b32 s29, s29, 0xffff
    s_mov_b32 s30, 147456
    s_mov_b32 s31, 0x20000
    s_mul_i32 s44, s36, 12288
    v_lshlrev_b32 v244, 4, v0
    v_add_u32 v244, s44, v244
    v_add_u32 v245, 4096, v244
    v_add_u32 v246, 8192, v244
    s_mov_b32 s53, 0
    s_mov_b32 s54, 0
    s_mov_b32 s55, 0
    s_lshl_b32 s44, s37, 5
    s_add_u32 s44, s44, s40
    s_mul_i32 s44, s44, 768
    s_lshl_b32 s45, s36, 8
    s_add_u32 s44, s44, s45
    s_lshl_b32 s45, s39, 3
    s_add_u32 s44, s44, s45
    s_add_u32 s44, s44, 33554432
    s_mov_b32 s45, 6144
    v_mul_lo_u32 v249, s45, v0
    v_add_u32 v249, s44, v249
    s_mul_i32 s44, s41, 36864
    s_mul_i32 s45, s36, 12288
    s_add_u32 s44, s44, s45
    s_add_u32 s94, s18, s44
    s_addc_u32 s95, s19, 0
    s_barrier
    ds_read_b128 a[0:3], v212 offset:8192
    ds_read_b128 a[4:7], v212 offset:9216
    ds_read_b128 a[8:11], v212 offset:10240
    ds_read_b64_tr_b16 a[80:81], v208 offset:0
    ds_read_b64_tr_b16 a[82:83], v208 offset:1024
    ds_read_b64_tr_b16 a[84:85], v208 offset:8
    ds_read_b64_tr_b16 a[86:87], v208 offset:1032
    ds_read_b64_tr_b16 a[88:89], v209 offset:0
    ds_read_b64_tr_b16 a[90:91], v209 offset:1024
    ds_read_b64_tr_b16 a[92:93], v209 offset:8
    ds_read_b64_tr_b16 a[94:95], v209 offset:1032
    ds_read_b64_tr_b16 a[96:97], v210 offset:0
    ds_read_b64_tr_b16 a[98:99], v210 offset:1024
    ds_read_b64_tr_b16 a[100:101], v210 offset:8
    ds_read_b64_tr_b16 a[102:103], v210 offset:1032
    ds_read_b64_tr_b16 a[104:105], v211 offset:0
    ds_read_b64_tr_b16 a[106:107], v211 offset:1024
    s_waitcnt lgkmcnt(14)
    s_waitcnt lgkmcnt(12)
    v_mfma_f32_16x16x32_bf16 v[16:19], a[80:83], a[0:3], v[16:19]
    ds_read_b64_tr_b16 a[108:109], v211 offset:8
    ds_read_b64_tr_b16 a[110:111], v211 offset:1032
    v_mfma_f32_16x16x32_bf16 v[48:51], a[80:83], a[4:7], v[48:51]
    v_mfma_f32_16x16x32_bf16 v[80:83], a[80:83], a[8:11], v[80:83]
    s_waitcnt lgkmcnt(12)
    v_mfma_f32_16x16x32_bf16 v[20:23], a[84:87], a[0:3], v[20:23]
    v_mfma_f32_16x16x32_bf16 v[52:55], a[84:87], a[4:7], v[52:55]
    v_mfma_f32_16x16x32_bf16 v[84:87], a[84:87], a[8:11], v[84:87]
    s_waitcnt lgkmcnt(0)
    s_barrier
    ds_read_b64_tr_b16 a[80:81], v208 offset:17408
    ds_read_b64_tr_b16 a[82:83], v208 offset:18432
    ds_read_b64_tr_b16 a[84:85], v208 offset:17416
    ds_read_b64_tr_b16 a[86:87], v208 offset:18440
    v_mfma_f32_16x16x32_bf16 v[24:27], a[88:91], a[0:3], v[24:27]
    ds_read_b128 a[12:15], v212 offset:25600
    v_mfma_f32_16x16x32_bf16 v[56:59], a[88:91], a[4:7], v[56:59]
    v_mfma_f32_16x16x32_bf16 v[88:91], a[88:91], a[8:11], v[88:91]
    ds_read_b64_tr_b16 a[88:89], v209 offset:17408
    ds_read_b64_tr_b16 a[90:91], v209 offset:18432
    v_mfma_f32_16x16x32_bf16 v[28:31], a[92:95], a[0:3], v[28:31]
    ds_read_b128 a[16:19], v212 offset:26624
    v_mfma_f32_16x16x32_bf16 v[60:63], a[92:95], a[4:7], v[60:63]
    v_mfma_f32_16x16x32_bf16 v[92:95], a[92:95], a[8:11], v[92:95]
    ds_read_b64_tr_b16 a[92:93], v209 offset:17416
    ds_read_b64_tr_b16 a[94:95], v209 offset:18440
    v_mfma_f32_16x16x32_bf16 v[32:35], a[96:99], a[0:3], v[32:35]
    ds_read_b128 a[20:23], v212 offset:27648
    v_mfma_f32_16x16x32_bf16 v[64:67], a[96:99], a[4:7], v[64:67]
    v_mfma_f32_16x16x32_bf16 v[96:99], a[96:99], a[8:11], v[96:99]
    ds_read_b64_tr_b16 a[96:97], v210 offset:17408
    ds_read_b64_tr_b16 a[98:99], v210 offset:18432
    v_mfma_f32_16x16x32_bf16 v[36:39], a[100:103], a[0:3], v[36:39]
    v_mfma_f32_16x16x32_bf16 v[68:71], a[100:103], a[4:7], v[68:71]
    v_mfma_f32_16x16x32_bf16 v[100:103], a[100:103], a[8:11], v[100:103]
    ds_read_b64_tr_b16 a[100:101], v210 offset:17416
    ds_read_b64_tr_b16 a[102:103], v210 offset:18440
    v_mfma_f32_16x16x32_bf16 v[40:43], a[104:107], a[0:3], v[40:43]
    v_mfma_f32_16x16x32_bf16 v[72:75], a[104:107], a[4:7], v[72:75]
    v_mfma_f32_16x16x32_bf16 v[104:107], a[104:107], a[8:11], v[104:107]
    ds_read_b64_tr_b16 a[104:105], v211 offset:17408
    ds_read_b64_tr_b16 a[106:107], v211 offset:18432
    v_mfma_f32_16x16x32_bf16 v[44:47], a[108:111], a[0:3], v[44:47]
    v_mfma_f32_16x16x32_bf16 v[76:79], a[108:111], a[4:7], v[76:79]
    v_mfma_f32_16x16x32_bf16 v[108:111], a[108:111], a[8:11], v[108:111]
    s_mov_b32 s44, 0
L_qloop:
    s_waitcnt lgkmcnt(6)
    v_mfma_f32_16x16x32_bf16 v[16:19], a[80:83], a[12:15], v[16:19]
    ds_read_b64_tr_b16 a[108:109], v211 offset:17416
    ds_read_b64_tr_b16 a[110:111], v211 offset:18440
    v_mfma_f32_16x16x32_bf16 v[48:51], a[80:83], a[16:19], v[48:51]
    v_mfma_f32_16x16x32_bf16 v[80:83], a[80:83], a[20:23], v[80:83]
    v_mfma_f32_16x16x32_bf16 v[20:23], a[84:87], a[12:15], v[20:23]
    v_mfma_f32_16x16x32_bf16 v[52:55], a[84:87], a[16:19], v[52:55]
    v_mfma_f32_16x16x32_bf16 v[84:87], a[84:87], a[20:23], v[84:87]
    s_waitcnt lgkmcnt(0)
    s_barrier
    ds_read_b64_tr_b16 a[80:81], v208 offset:34816
    ds_read_b64_tr_b16 a[82:83], v208 offset:35840
    ds_read_b64_tr_b16 a[84:85], v208 offset:34824
    ds_read_b64_tr_b16 a[86:87], v208 offset:35848
    v_mfma_f32_16x16x32_bf16 v[24:27], a[88:91], a[12:15], v[24:27]
    ds_read_b128 a[0:3], v212 offset:43008
    v_mfma_f32_16x16x32_bf16 v[56:59], a[88:91], a[16:19], v[56:59]
    v_mfma_f32_16x16x32_bf16 v[88:91], a[88:91], a[20:23], v[88:91]
    ds_read_b64_tr_b16 a[88:89], v209 offset:34816
    ds_read_b64_tr_b16 a[90:91], v209 offset:35840
    v_mfma_f32_16x16x32_bf16 v[28:31], a[92:95], a[12:15], v[28:31]
    ds_read_b128 a[4:7], v212 offset:44032
    v_mfma_f32_16x16x32_bf16 v[60:63], a[92:95], a[16:19], v[60:63]
    v_mfma_f32_16x16x32_bf16 v[92:95], a[92:95], a[20:23], v[92:95]
    ds_read_b64_tr_b16 a[92:93], v209 offset:34824
    ds_read_b64_tr_b16 a[94:95], v209 offset:35848
    v_mfma_f32_16x16x32_bf16 v[32:35], a[96:99], a[12:15], v[32:35]
    ds_read_b128 a[8:11], v212 offset:45056
    v_mfma_f32_16x16x32_bf16 v[64:67], a[96:99], a[16:19], v[64:67]
    v_mfma_f32_16x16x32_bf16 v[96:99], a[96:99], a[20:23], v[96:99]
    ds_read_b64_tr_b16 a[96:97], v210 offset:34816
    ds_read_b64_tr_b16 a[98:99], v210 offset:35840
    v_mfma_f32_16x16x32_bf16 v[36:39], a[100:103], a[12:15], v[36:39]
    v_mfma_f32_16x16x32_bf16 v[68:71], a[100:103], a[16:19], v[68:71]
    v_mfma_f32_16x16x32_bf16 v[100:103], a[100:103], a[20:23], v[100:103]
    ds_read_b64_tr_b16 a[100:101], v210 offset:34824
    ds_read_b64_tr_b16 a[102:103], v210 offset:35848
    v_mfma_f32_16x16x32_bf16 v[40:43], a[104:107], a[12:15], v[40:43]
    v_mfma_f32_16x16x32_bf16 v[72:75], a[104:107], a[16:19], v[72:75]
    v_mfma_f32_16x16x32_bf16 v[104:107], a[104:107], a[20:23], v[104:107]
    ds_read_b64_tr_b16 a[104:105], v211 offset:34816
    ds_read_b64_tr_b16 a[106:107], v211 offset:35840
    v_mfma_f32_16x16x32_bf16 v[44:47], a[108:111], a[12:15], v[44:47]
    v_mfma_f32_16x16x32_bf16 v[76:79], a[108:111], a[16:19], v[76:79]
    v_mfma_f32_16x16x32_bf16 v[108:111], a[108:111], a[20:23], v[108:111]
    s_waitcnt lgkmcnt(6)
    v_mfma_f32_16x16x32_bf16 v[16:19], a[80:83], a[0:3], v[16:19]
    ds_read_b64_tr_b16 a[108:109], v211 offset:34824
    ds_read_b64_tr_b16 a[110:111], v211 offset:35848
    v_mfma_f32_16x16x32_bf16 v[48:51], a[80:83], a[4:7], v[48:51]
    v_mfma_f32_16x16x32_bf16 v[80:83], a[80:83], a[8:11], v[80:83]
    v_mfma_f32_16x16x32_bf16 v[20:23], a[84:87], a[0:3], v[20:23]
    v_mfma_f32_16x16x32_bf16 v[52:55], a[84:87], a[4:7], v[52:55]
    v_mfma_f32_16x16x32_bf16 v[84:87], a[84:87], a[8:11], v[84:87]
    s_waitcnt lgkmcnt(0)
    s_barrier
    ds_read_b64_tr_b16 a[80:81], v208 offset:52224
    ds_read_b64_tr_b16 a[82:83], v208 offset:53248
    ds_read_b64_tr_b16 a[84:85], v208 offset:52232
    ds_read_b64_tr_b16 a[86:87], v208 offset:53256
    v_mfma_f32_16x16x32_bf16 v[24:27], a[88:91], a[0:3], v[24:27]
    ds_read_b128 a[12:15], v212 offset:60416
    v_mfma_f32_16x16x32_bf16 v[56:59], a[88:91], a[4:7], v[56:59]
    v_mfma_f32_16x16x32_bf16 v[88:91], a[88:91], a[8:11], v[88:91]
    ds_read_b64_tr_b16 a[88:89], v209 offset:52224
    ds_read_b64_tr_b16 a[90:91], v209 offset:53248
    v_mfma_f32_16x16x32_bf16 v[28:31], a[92:95], a[0:3], v[28:31]
    ds_read_b128 a[16:19], v212 offset:61440
    v_mfma_f32_16x16x32_bf16 v[60:63], a[92:95], a[4:7], v[60:63]
    v_mfma_f32_16x16x32_bf16 v[92:95], a[92:95], a[8:11], v[92:95]
    ds_read_b64_tr_b16 a[92:93], v209 offset:52232
    ds_read_b64_tr_b16 a[94:95], v209 offset:53256
    v_mfma_f32_16x16x32_bf16 v[32:35], a[96:99], a[0:3], v[32:35]
    ds_read_b128 a[20:23], v212 offset:62464
    v_mfma_f32_16x16x32_bf16 v[64:67], a[96:99], a[4:7], v[64:67]
    v_mfma_f32_16x16x32_bf16 v[96:99], a[96:99], a[8:11], v[96:99]
    ds_read_b64_tr_b16 a[96:97], v210 offset:52224
    ds_read_b64_tr_b16 a[98:99], v210 offset:53248
    v_mfma_f32_16x16x32_bf16 v[36:39], a[100:103], a[0:3], v[36:39]
    v_mfma_f32_16x16x32_bf16 v[68:71], a[100:103], a[4:7], v[68:71]
    v_mfma_f32_16x16x32_bf16 v[100:103], a[100:103], a[8:11], v[100:103]
    ds_read_b64_tr_b16 a[100:101], v210 offset:52232
    ds_read_b64_tr_b16 a[102:103], v210 offset:53256
    v_mfma_f32_16x16x32_bf16 v[40:43], a[104:107], a[0:3], v[40:43]
    v_mfma_f32_16x16x32_bf16 v[72:75], a[104:107], a[4:7], v[72:75]
    v_mfma_f32_16x16x32_bf16 v[104:107], a[104:107], a[8:11], v[104:107]
    ds_read_b64_tr_b16 a[104:105], v211 offset:52224
    ds_read_b64_tr_b16 a[106:107], v211 offset:53248
    v_mfma_f32_16x16x32_bf16 v[44:47], a[108:111], a[0:3], v[44:47]
    v_mfma_f32_16x16x32_bf16 v[76:79], a[108:111], a[4:7], v[76:79]
    v_mfma_f32_16x16x32_bf16 v[108:111], a[108:111], a[8:11], v[108:111]
    s_waitcnt lgkmcnt(6)
    v_mfma_f32_16x16x32_bf16 v[16:19], a[80:83], a[12:15], v[16:19]
    ds_read_b64_tr_b16 a[108:109], v211 offset:52232
    ds_read_b64_tr_b16 a[110:111], v211 offset:53256
    v_mfma_f32_16x16x32_bf16 v[48:51], a[80:83], a[16:19], v[48:51]
    v_mfma_f32_16x16x32_bf16 v[80:83], a[80:83], a[20:23], v[80:83]
    v_mfma_f32_16x16x32_bf16 v[20:23], a[84:87], a[12:15], v[20:23]
    v_mfma_f32_16x16x32_bf16 v[52:55], a[84:87], a[16:19], v[52:55]
    v_mfma_f32_16x16x32_bf16 v[84:87], a[84:87], a[20:23], v[84:87]
    s_waitcnt lgkmcnt(0)
    s_barrier
    ds_read_b64_tr_b16 a[80:81], v208 offset:0
    ds_read_b64_tr_b16 a[82:83], v208 offset:1024
    ds_read_b64_tr_b16 a[84:85], v208 offset:8
    ds_read_b64_tr_b16 a[86:87], v208 offset:1032
    v_mfma_f32_16x16x32_bf16 v[24:27], a[88:91], a[12:15], v[24:27]
    ds_read_b128 a[0:3], v212 offset:8192
    v_mfma_f32_16x16x32_bf16 v[56:59], a[88:91], a[16:19], v[56:59]
    v_mfma_f32_16x16x32_bf16 v[88:91], a[88:91], a[20:23], v[88:91]
    ds_read_b64_tr_b16 a[88:89], v209 offset:0
    ds_read_b64_tr_b16 a[90:91], v209 offset:1024
    v_mfma_f32_16x16x32_bf16 v[28:31], a[92:95], a[12:15], v[28:31]
    ds_read_b128 a[4:7], v212 offset:9216
    v_mfma_f32_16x16x32_bf16 v[60:63], a[92:95], a[16:19], v[60:63]
    v_mfma_f32_16x16x32_bf16 v[92:95], a[92:95], a[20:23], v[92:95]
    ds_read_b64_tr_b16 a[92:93], v209 offset:8
    ds_read_b64_tr_b16 a[94:95], v209 offset:1032
    v_mfma_f32_16x16x32_bf16 v[32:35], a[96:99], a[12:15], v[32:35]
    ds_read_b128 a[8:11], v212 offset:10240
    v_mfma_f32_16x16x32_bf16 v[64:67], a[96:99], a[16:19], v[64:67]
    v_mfma_f32_16x16x32_bf16 v[96:99], a[96:99], a[20:23], v[96:99]
    ds_read_b64_tr_b16 a[96:97], v210 offset:0
    ds_read_b64_tr_b16 a[98:99], v210 offset:1024
    v_mfma_f32_16x16x32_bf16 v[36:39], a[100:103], a[12:15], v[36:39]
    v_mfma_f32_16x16x32_bf16 v[68:71], a[100:103], a[16:19], v[68:71]
    v_mfma_f32_16x16x32_bf16 v[100:103], a[100:103], a[20:23], v[100:103]
    ds_read_b64_tr_b16 a[100:101], v210 offset:8
    ds_read_b64_tr_b16 a[102:103], v210 offset:1032
    v_mfma_f32_16x16x32_bf16 v[40:43], a[104:107], a[12:15], v[40:43]
    v_mfma_f32_16x16x32_bf16 v[72:75], a[104:107], a[16:19], v[72:75]
    v_mfma_f32_16x16x32_bf16 v[104:107], a[104:107], a[20:23], v[104:107]
    ds_read_b64_tr_b16 a[104:105], v211 offset:0
    ds_read_b64_tr_b16 a[106:107], v211 offset:1024
    v_mfma_f32_16x16x32_bf16 v[44:47], a[108:111], a[12:15], v[44:47]
    v_mfma_f32_16x16x32_bf16 v[76:79], a[108:111], a[16:19], v[76:79]
    v_mfma_f32_16x16x32_bf16 v[108:111], a[108:111], a[20:23], v[108:111]
    s_waitcnt lgkmcnt(6)
    v_mfma_f32_16x16x32_bf16 v[16:19], a[80:83], a[0:3], v[16:19]
    ds_read_b64_tr_b16 a[108:109], v211 offset:8
    ds_read_b64_tr_b16 a[110:111], v211 offset:1032
    v_mfma_f32_16x16x32_bf16 v[48:51], a[80:83], a[4:7], v[48:51]
    v_mfma_f32_16x16x32_bf16 v[80:83], a[80:83], a[8:11], v[80:83]
    v_mfma_f32_16x16x32_bf16 v[20:23], a[84:87], a[0:3], v[20:23]
    v_mfma_f32_16x16x32_bf16 v[52:55], a[84:87], a[4:7], v[52:55]
    v_mfma_f32_16x16x32_bf16 v[84:87], a[84:87], a[8:11], v[84:87]
    s_waitcnt lgkmcnt(0)
    s_barrier
    ds_read_b64_tr_b16 a[80:81], v208 offset:17408
    ds_read_b64_tr_b16 a[82:83], v208 offset:18432
    ds_read_b64_tr_b16 a[84:85], v208 offset:17416
    ds_read_b64_tr_b16 a[86:87], v208 offset:18440
    v_mfma_f32_16x16x32_bf16 v[24:27], a[88:91], a[0:3], v[24:27]
    ds_read_b128 a[12:15], v212 offset:25600
    v_mfma_f32_16x16x32_bf16 v[56:59], a[88:91], a[4:7], v[56:59]
    v_mfma_f32_16x16x32_bf16 v[88:91], a[88:91], a[8:11], v[88:91]
    ds_read_b64_tr_b16 a[88:89], v209 offset:17408
    ds_read_b64_tr_b16 a[90:91], v209 offset:18432
    v_mfma_f32_16x16x32_bf16 v[28:31], a[92:95], a[0:3], v[28:31]
    ds_read_b128 a[16:19], v212 offset:26624
    v_mfma_f32_16x16x32_bf16 v[60:63], a[92:95], a[4:7], v[60:63]
    v_mfma_f32_16x16x32_bf16 v[92:95], a[92:95], a[8:11], v[92:95]
    ds_read_b64_tr_b16 a[92:93], v209 offset:17416
    ds_read_b64_tr_b16 a[94:95], v209 offset:18440
    v_mfma_f32_16x16x32_bf16 v[32:35], a[96:99], a[0:3], v[32:35]
    ds_read_b128 a[20:23], v212 offset:27648
    v_mfma_f32_16x16x32_bf16 v[64:67], a[96:99], a[4:7], v[64:67]
    v_mfma_f32_16x16x32_bf16 v[96:99], a[96:99], a[8:11], v[96:99]
    ds_read_b64_tr_b16 a[96:97], v210 offset:17408
    ds_read_b64_tr_b16 a[98:99], v210 offset:18432
    v_mfma_f32_16x16x32_bf16 v[36:39], a[100:103], a[0:3], v[36:39]
    v_mfma_f32_16x16x32_bf16 v[68:71], a[100:103], a[4:7], v[68:71]
    v_mfma_f32_16x16x32_bf16 v[100:103], a[100:103], a[8:11], v[100:103]
    ds_read_b64_tr_b16 a[100:101], v210 offset:17416
    ds_read_b64_tr_b16 a[102:103], v210 offset:18440
    v_mfma_f32_16x16x32_bf16 v[40:43], a[104:107], a[0:3], v[40:43]
    v_mfma_f32_16x16x32_bf16 v[72:75], a[104:107], a[4:7], v[72:75]
    v_mfma_f32_16x16x32_bf16 v[104:107], a[104:107], a[8:11], v[104:107]
    ds_read_b64_tr_b16 a[104:105], v211 offset:17408
    ds_read_b64_tr_b16 a[106:107], v211 offset:18432
    v_mfma_f32_16x16x32_bf16 v[44:47], a[108:111], a[0:3], v[44:47]
    v_mfma_f32_16x16x32_bf16 v[76:79], a[108:111], a[4:7], v[76:79]
    v_mfma_f32_16x16x32_bf16 v[108:111], a[108:111], a[8:11], v[108:111]
    s_add_u32 s44, s44, 1
    s_cmp_lt_u32 s44, 3
    s_cbranch_scc1 L_qloop
    s_waitcnt lgkmcnt(6)
    v_mfma_f32_16x16x32_bf16 v[16:19], a[80:83], a[12:15], v[16:19]
    ds_read_b64_tr_b16 a[108:109], v211 offset:17416
    ds_read_b64_tr_b16 a[110:111], v211 offset:18440
    v_mfma_f32_16x16x32_bf16 v[48:51], a[80:83], a[16:19], v[48:51]
    v_mfma_f32_16x16x32_bf16 v[80:83], a[80:83], a[20:23], v[80:83]
    v_mfma_f32_16x16x32_bf16 v[20:23], a[84:87], a[12:15], v[20:23]
    v_mfma_f32_16x16x32_bf16 v[52:55], a[84:87], a[16:19], v[52:55]
    v_mfma_f32_16x16x32_bf16 v[84:87], a[84:87], a[20:23], v[84:87]
    s_waitcnt lgkmcnt(0)
    s_barrier
    ds_read_b64_tr_b16 a[80:81], v208 offset:34816
    ds_read_b64_tr_b16 a[82:83], v208 offset:35840
    ds_read_b64_tr_b16 a[84:85], v208 offset:34824
    ds_read_b64_tr_b16 a[86:87], v208 offset:35848
    v_mfma_f32_16x16x32_bf16 v[24:27], a[88:91], a[12:15], v[24:27]
    ds_read_b128 a[0:3], v212 offset:43008
    v_mfma_f32_16x16x32_bf16 v[56:59], a[88:91], a[16:19], v[56:59]
    v_mfma_f32_16x16x32_bf16 v[88:91], a[88:91], a[20:23], v[88:91]
    ds_read_b64_tr_b16 a[88:89], v209 offset:34816
    ds_read_b64_tr_b16 a[90:91], v209 offset:35840
    v_mfma_f32_16x16x32_bf16 v[28:31], a[92:95], a[12:15], v[28:31]
    ds_read_b128 a[4:7], v212 offset:44032
    v_mfma_f32_16x16x32_bf16 v[60:63], a[92:95], a[16:19], v[60:63]
    v_mfma_f32_16x16x32_bf16 v[92:95], a[92:95], a[20:23], v[92:95]
    ds_read_b64_tr_b16 a[92:93], v209 offset:34824
    ds_read_b64_tr_b16 a[94:95], v209 offset:35848
    v_mfma_f32_16x16x32_bf16 v[32:35], a[96:99], a[12:15], v[32:35]
    ds_read_b128 a[8:11], v212 offset:45056
    v_mfma_f32_16x16x32_bf16 v[64:67], a[96:99], a[16:19], v[64:67]
    v_mfma_f32_16x16x32_bf16 v[96:99], a[96:99], a[20:23], v[96:99]
    ds_read_b64_tr_b16 a[96:97], v210 offset:34816
    ds_read_b64_tr_b16 a[98:99], v210 offset:35840
    v_mfma_f32_16x16x32_bf16 v[36:39], a[100:103], a[12:15], v[36:39]
    v_mfma_f32_16x16x32_bf16 v[68:71], a[100:103], a[16:19], v[68:71]
    v_mfma_f32_16x16x32_bf16 v[100:103], a[100:103], a[20:23], v[100:103]
    ds_read_b64_tr_b16 a[100:101], v210 offset:34824
    ds_read_b64_tr_b16 a[102:103], v210 offset:35848
    v_mfma_f32_16x16x32_bf16 v[40:43], a[104:107], a[12:15], v[40:43]
    v_mfma_f32_16x16x32_bf16 v[72:75], a[104:107], a[16:19], v[72:75]
    v_mfma_f32_16x16x32_bf16 v[104:107], a[104:107], a[20:23], v[104:107]
    ds_read_b64_tr_b16 a[104:105], v211 offset:34816
    ds_read_b64_tr_b16 a[106:107], v211 offset:35840
    v_mfma_f32_16x16x32_bf16 v[44:47], a[108:111], a[12:15], v[44:47]
    v_mfma_f32_16x16x32_bf16 v[76:79], a[108:111], a[16:19], v[76:79]
    v_mfma_f32_16x16x32_bf16 v[108:111], a[108:111], a[20:23], v[108:111]
    s_waitcnt lgkmcnt(6)
    v_mfma_f32_16x16x32_bf16 v[16:19], a[80:83], a[0:3], v[16:19]
    ds_read_b64_tr_b16 a[108:109], v211 offset:34824
    ds_read_b64_tr_b16 a[110:111], v211 offset:35848
    v_mfma_f32_16x16x32_bf16 v[48:51], a[80:83], a[4:7], v[48:51]
    v_mfma_f32_16x16x32_bf16 v[80:83], a[80:83], a[8:11], v[80:83]
    v_mfma_f32_16x16x32_bf16 v[20:23], a[84:87], a[0:3], v[20:23]
    v_mfma_f32_16x16x32_bf16 v[52:55], a[84:87], a[4:7], v[52:55]
    v_mfma_f32_16x16x32_bf16 v[84:87], a[84:87], a[8:11], v[84:87]
    s_waitcnt lgkmcnt(0)
    s_barrier
    ds_read_b64_tr_b16 a[80:81], v208 offset:52224
    ds_read_b64_tr_b16 a[82:83], v208 offset:53248
    ds_read_b64_tr_b16 a[84:85], v208 offset:52232
    ds_read_b64_tr_b16 a[86:87], v208 offset:53256
    v_mfma_f32_16x16x32_bf16 v[24:27], a[88:91], a[0:3], v[24:27]
    ds_read_b128 a[12:15], v212 offset:60416
    v_mfma_f32_16x16x32_bf16 v[56:59], a[88:91], a[4:7], v[56:59]
    v_mfma_f32_16x16x32_bf16 v[88:91], a[88:91], a[8:11], v[88:91]
    ds_read_b64_tr_b16 a[88:89], v209 offset:52224
    ds_read_b64_tr_b16 a[90:91], v209 offset:53248
    v_mfma_f32_16x16x32_bf16 v[28:31], a[92:95], a[0:3], v[28:31]
    ds_read_b128 a[16:19], v212 offset:61440
    v_mfma_f32_16x16x32_bf16 v[60:63], a[92:95], a[4:7], v[60:63]
    v_mfma_f32_16x16x32_bf16 v[92:95], a[92:95], a[8:11], v[92:95]
    ds_read_b64_tr_b16 a[92:93], v209 offset:52232
    ds_read_b64_tr_b16 a[94:95], v209 offset:53256
    v_mfma_f32_16x16x32_bf16 v[32:35], a[96:99], a[0:3], v[32:35]
    ds_read_b128 a[20:23], v212 offset:62464
    v_mfma_f32_16x16x32_bf16 v[64:67], a[96:99], a[4:7], v[64:67]
    v_mfma_f32_16x16x32_bf16 v[96:99], a[96:99], a[8:11], v[96:99]
    ds_read_b64_tr_b16 a[96:97], v210 offset:52224
    ds_read_b64_tr_b16 a[98:99], v210 offset:53248
    v_mfma_f32_16x16x32_bf16 v[36:39], a[100:103], a[0:3], v[36:39]
    v_mfma_f32_16x16x32_bf16 v[68:71], a[100:103], a[4:7], v[68:71]
    v_mfma_f32_16x16x32_bf16 v[100:103], a[100:103], a[8:11], v[100:103]
    ds_read_b64_tr_b16 a[100:101], v210 offset:52232
    ds_read_b64_tr_b16 a[102:103], v210 offset:53256
    v_mfma_f32_16x16x32_bf16 v[40:43], a[104:107], a[0:3], v[40:43]
    v_mfma_f32_16x16x32_bf16 v[72:75], a[104:107], a[4:7], v[72:75]
    v_mfma_f32_16x16x32_bf16 v[104:107], a[104:107], a[8:11], v[104:107]
    ds_read_b64_tr_b16 a[104:105], v211 offset:52224
    ds_read_b64_tr_b16 a[106:107], v211 offset:53248
    v_mfma_f32_16x16x32_bf16 v[44:47], a[108:111], a[0:3], v[44:47]
    v_mfma_f32_16x16x32_bf16 v[76:79], a[108:111], a[4:7], v[76:79]
    v_mfma_f32_16x16x32_bf16 v[108:111], a[108:111], a[8:11], v[108:111]
    s_waitcnt lgkmcnt(6)
    v_mfma_f32_16x16x32_bf16 v[16:19], a[80:83], a[12:15], v[16:19]
    ds_read_b64_tr_b16 a[108:109], v211 offset:52232
    ds_read_b64_tr_b16 a[110:111], v211 offset:53256
    v_mfma_f32_16x16x32_bf16 v[48:51], a[80:83], a[16:19], v[48:51]
    v_mfma_f32_16x16x32_bf16 v[80:83], a[80:83], a[20:23], v[80:83]
    v_mfma_f32_16x16x32_bf16 v[20:23], a[84:87], a[12:15], v[20:23]
    v_mfma_f32_16x16x32_bf16 v[52:55], a[84:87], a[16:19], v[52:55]
    v_mfma_f32_16x16x32_bf16 v[84:87], a[84:87], a[20:23], v[84:87]
    v_mfma_f32_16x16x32_bf16 v[24:27], a[88:91], a[12:15], v[24:27]
    v_mfma_f32_16x16x32_bf16 v[56:59], a[88:91], a[16:19], v[56:59]
    v_mfma_f32_16x16x32_bf16 v[88:91], a[88:91], a[20:23], v[88:91]
    v_mfma_f32_16x16x32_bf16 v[28:31], a[92:95], a[12:15], v[28:31]
    v_mfma_f32_16x16x32_bf16 v[60:63], a[92:95], a[16:19], v[60:63]
    v_mfma_f32_16x16x32_bf16 v[92:95], a[92:95], a[20:23], v[92:95]
    s_waitcnt lgkmcnt(6)
    v_mfma_f32_16x16x32_bf16 v[32:35], a[96:99], a[12:15], v[32:35]
    v_mfma_f32_16x16x32_bf16 v[64:67], a[96:99], a[16:19], v[64:67]
    v_mfma_f32_16x16x32_bf16 v[96:99], a[96:99], a[20:23], v[96:99]
    s_waitcnt lgkmcnt(4)
    v_mfma_f32_16x16x32_bf16 v[36:39], a[100:103], a[12:15], v[36:39]
    v_mfma_f32_16x16x32_bf16 v[68:71], a[100:103], a[16:19], v[68:71]
    v_mfma_f32_16x16x32_bf16 v[100:103], a[100:103], a[20:23], v[100:103]
    s_waitcnt lgkmcnt(2)
    v_mfma_f32_16x16x32_bf16 v[40:43], a[104:107], a[12:15], v[40:43]
    v_mfma_f32_16x16x32_bf16 v[72:75], a[104:107], a[16:19], v[72:75]
    v_mfma_f32_16x16x32_bf16 v[104:107], a[104:107], a[20:23], v[104:107]
    s_waitcnt lgkmcnt(0)
    v_mfma_f32_16x16x32_bf16 v[44:47], a[108:111], a[12:15], v[44:47]
    v_mfma_f32_16x16x32_bf16 v[76:79], a[108:111], a[16:19], v[76:79]
    v_mfma_f32_16x16x32_bf16 v[108:111], a[108:111], a[20:23], v[108:111]
    s_nop 7
    s_mov_b32 s44, 0x3e0293ee
    v_mul_f32 v16, s44, v16
    v_mul_f32 v17, s44, v17
    v_mul_f32 v18, s44, v18
    v_mul_f32 v19, s44, v19
    v_mul_f32 v20, s44, v20
    v_mul_f32 v21, s44, v21
    v_mul_f32 v22, s44, v22
    v_mul_f32 v23, s44, v23
    v_cvt_pk_bf16_f32 v220, v16, v17
    v_cvt_pk_bf16_f32 v221, v18, v19
    v_cvt_pk_bf16_f32 v222, v20, v21
    v_cvt_pk_bf16_f32 v223, v22, v23
    v_accvgpr_write_b32 a0, v220
    v_accvgpr_write_b32 a1, v221
    v_accvgpr_write_b32 a2, v222
    v_accvgpr_write_b32 a3, v223
    v_mul_f32 v24, s44, v24
    v_mul_f32 v25, s44, v25
    v_mul_f32 v26, s44, v26
    v_mul_f32 v27, s44, v27
    v_mul_f32 v28, s44, v28
    v_mul_f32 v29, s44, v29
    v_mul_f32 v30, s44, v30
    v_mul_f32 v31, s44, v31
    v_cvt_pk_bf16_f32 v220, v24, v25
    v_cvt_pk_bf16_f32 v221, v26, v27
    v_cvt_pk_bf16_f32 v222, v28, v29
    v_cvt_pk_bf16_f32 v223, v30, v31
    v_accvgpr_write_b32 a4, v220
    v_accvgpr_write_b32 a5, v221
    v_accvgpr_write_b32 a6, v222
    v_accvgpr_write_b32 a7, v223
    v_mul_f32 v32, s44, v32
    v_mul_f32 v33, s44, v33
    v_mul_f32 v34, s44, v34
    v_mul_f32 v35, s44, v35
    v_mul_f32 v36, s44, v36
    v_mul_f32 v37, s44, v37
    v_mul_f32 v38, s44, v38
    v_mul_f32 v39, s44, v39
    v_cvt_pk_bf16_f32 v220, v32, v33
    v_cvt_pk_bf16_f32 v221, v34, v35
    v_cvt_pk_bf16_f32 v222, v36, v37
    v_cvt_pk_bf16_f32 v223, v38, v39
    v_accvgpr_write_b32 a8, v220
    v_accvgpr_write_b32 a9, v221
    v_accvgpr_write_b32 a10, v222
    v_accvgpr_write_b32 a11, v223
    v_mul_f32 v40, s44, v40
    v_mul_f32 v41, s44, v41
    v_mul_f32 v42, s44, v42
    v_mul_f32 v43, s44, v43
    v_mul_f32 v44, s44, v44
    v_mul_f32 v45, s44, v45
    v_mul_f32 v46, s44, v46
    v_mul_f32 v47, s44, v47
    v_cvt_pk_bf16_f32 v220, v40, v41
    v_cvt_pk_bf16_f32 v221, v42, v43
    v_cvt_pk_bf16_f32 v222, v44, v45
    v_cvt_pk_bf16_f32 v223, v46, v47
    v_accvgpr_write_b32 a12, v220
    v_accvgpr_write_b32 a13, v221
    v_accvgpr_write_b32 a14, v222
    v_accvgpr_write_b32 a15, v223
    v_mul_f32 v48, s44, v48
    v_mul_f32 v49, s44, v49
    v_mul_f32 v50, s44, v50
    v_mul_f32 v51, s44, v51
    v_mul_f32 v52, s44, v52
    v_mul_f32 v53, s44, v53
    v_mul_f32 v54, s44, v54
    v_mul_f32 v55, s44, v55
    v_cvt_pk_bf16_f32 v220, v48, v49
    v_cvt_pk_bf16_f32 v221, v50, v51
    v_cvt_pk_bf16_f32 v222, v52, v53
    v_cvt_pk_bf16_f32 v223, v54, v55
    v_accvgpr_write_b32 a16, v220
    v_accvgpr_write_b32 a17, v221
    v_accvgpr_write_b32 a18, v222
    v_accvgpr_write_b32 a19, v223
    v_mul_f32 v56, s44, v56
    v_mul_f32 v57, s44, v57
    v_mul_f32 v58, s44, v58
    v_mul_f32 v59, s44, v59
    v_mul_f32 v60, s44, v60
    v_mul_f32 v61, s44, v61
    v_mul_f32 v62, s44, v62
    v_mul_f32 v63, s44, v63
    v_cvt_pk_bf16_f32 v220, v56, v57
    v_cvt_pk_bf16_f32 v221, v58, v59
    v_cvt_pk_bf16_f32 v222, v60, v61
    v_cvt_pk_bf16_f32 v223, v62, v63
    v_accvgpr_write_b32 a20, v220
    v_accvgpr_write_b32 a21, v221
    v_accvgpr_write_b32 a22, v222
    v_accvgpr_write_b32 a23, v223
    v_mul_f32 v64, s44, v64
    v_mul_f32 v65, s44, v65
    v_mul_f32 v66, s44, v66
    v_mul_f32 v67, s44, v67
    v_mul_f32 v68, s44, v68
    v_mul_f32 v69, s44, v69
    v_mul_f32 v70, s44, v70
    v_mul_f32 v71, s44, v71
    v_cvt_pk_bf16_f32 v220, v64, v65
    v_cvt_pk_bf16_f32 v221, v66, v67
    v_cvt_pk_bf16_f32 v222, v68, v69
    v_cvt_pk_bf16_f32 v223, v70, v71
    v_accvgpr_write_b32 a24, v220
    v_accvgpr_write_b32 a25, v221
    v_accvgpr_write_b32 a26, v222
    v_accvgpr_write_b32 a27, v223
    v_mul_f32 v72, s44, v72
    v_mul_f32 v73, s44, v73
    v_mul_f32 v74, s44, v74
    v_mul_f32 v75, s44, v75
    v_mul_f32 v76, s44, v76
    v_mul_f32 v77, s44, v77
    v_mul_f32 v78, s44, v78
    v_mul_f32 v79, s44, v79
    v_cvt_pk_bf16_f32 v220, v72, v73
    v_cvt_pk_bf16_f32 v221, v74, v75
    v_cvt_pk_bf16_f32 v222, v76, v77
    v_cvt_pk_bf16_f32 v223, v78, v79
    v_accvgpr_write_b32 a28, v220
    v_accvgpr_write_b32 a29, v221
    v_accvgpr_write_b32 a30, v222
    v_accvgpr_write_b32 a31, v223
    v_mul_f32 v80, s44, v80
    v_mul_f32 v81, s44, v81
    v_mul_f32 v82, s44, v82
    v_mul_f32 v83, s44, v83
    v_mul_f32 v84, s44, v84
    v_mul_f32 v85, s44, v85
    v_mul_f32 v86, s44, v86
    v_mul_f32 v87, s44, v87
    v_cvt_pk_bf16_f32 v220, v80, v81
    v_cvt_pk_bf16_f32 v221, v82, v83
    v_cvt_pk_bf16_f32 v222, v84, v85
    v_cvt_pk_bf16_f32 v223, v86, v87
    v_accvgpr_write_b32 a32, v220
    v_accvgpr_write_b32 a33, v221
    v_accvgpr_write_b32 a34, v222
    v_accvgpr_write_b32 a35, v223
    v_mul_f32 v88, s44, v88
    v_mul_f32 v89, s44, v89
    v_mul_f32 v90, s44, v90
    v_mul_f32 v91, s44, v91
    v_mul_f32 v92, s44, v92
    v_mul_f32 v93, s44, v93
    v_mul_f32 v94, s44, v94
    v_mul_f32 v95, s44, v95
    v_cvt_pk_bf16_f32 v220, v88, v89
    v_cvt_pk_bf16_f32 v221, v90, v91
    v_cvt_pk_bf16_f32 v222, v92, v93
    v_cvt_pk_bf16_f32 v223, v94, v95
    v_accvgpr_write_b32 a36, v220
    v_accvgpr_write_b32 a37, v221
    v_accvgpr_write_b32 a38, v222
    v_accvgpr_write_b32 a39, v223
    v_mul_f32 v96, s44, v96
    v_mul_f32 v97, s44, v97
    v_mul_f32 v98, s44, v98
    v_mul_f32 v99, s44, v99
    v_mul_f32 v100, s44, v100
    v_mul_f32 v101, s44, v101
    v_mul_f32 v102, s44, v102
    v_mul_f32 v103, s44, v103
    v_cvt_pk_bf16_f32 v220, v96, v97
    v_cvt_pk_bf16_f32 v221, v98, v99
    v_cvt_pk_bf16_f32 v222, v100, v101
    v_cvt_pk_bf16_f32 v223, v102, v103
    v_accvgpr_write_b32 a40, v220
    v_accvgpr_write_b32 a41, v221
    v_accvgpr_write_b32 a42, v222
    v_accvgpr_write_b32 a43, v223
    v_mul_f32 v104, s44, v104
    v_mul_f32 v105, s44, v105
    v_mul_f32 v106, s44, v106
    v_mul_f32 v107, s44, v107
    v_mul_f32 v108, s44, v108
    v_mul_f32 v109, s44, v109
    v_mul_f32 v110, s44, v110
    v_mul_f32 v111, s44, v111
    v_cvt_pk_bf16_f32 v220, v104, v105
    v_cvt_pk_bf16_f32 v221, v106, v107
    v_cvt_pk_bf16_f32 v222, v108, v109
    v_cvt_pk_bf16_f32 v223, v110, v111
    v_accvgpr_write_b32 a44, v220
    v_accvgpr_write_b32 a45, v221
    v_accvgpr_write_b32 a46, v222
    v_accvgpr_write_b32 a47, v223
    s_barrier
    ds_read_b128 a[48:51], v188 offset:16384
    ds_read_b128 a[52:55], v188 offset:20480
    ds_read_b128 a[56:59], v189 offset:16384
    ds_read_b128 a[60:63], v189 offset:20480
    ds_read_b128 a[64:67], v190 offset:16384
    ds_read_b128 a[68:71], v190 offset:20480
    ds_read_b128 a[72:75], v191 offset:16384
    ds_read_b128 a[76:79], v191 offset:20480
    v_mov_b32 v16, 0
    v_mov_b32 v17, 0
    v_mov_b32 v18, 0
    v_mov_b32 v19, 0
    v_mov_b32 v20, 0
    v_mov_b32 v21, 0
    v_mov_b32 v22, 0
    v_mov_b32 v23, 0
    v_mov_b32 v24, 0
    v_mov_b32 v25, 0
    v_mov_b32 v26, 0
    v_mov_b32 v27, 0
    v_mov_b32 v28, 0
    v_mov_b32 v29, 0
    v_mov_b32 v30, 0
    v_mov_b32 v31, 0
    v_mov_b32 v32, 0
    v_mov_b32 v33, 0
    v_mov_b32 v34, 0
    v_mov_b32 v35, 0
    v_mov_b32 v36, 0
    v_mov_b32 v37, 0
    v_mov_b32 v38, 0
    v_mov_b32 v39, 0
    v_mov_b32 v40, 0
    v_mov_b32 v41, 0
    v_mov_b32 v42, 0
    v_mov_b32 v43, 0
    v_mov_b32 v44, 0
    v_mov_b32 v45, 0
    v_mov_b32 v46, 0
    v_mov_b32 v47, 0
    v_mov_b32 v48, 0
    v_mov_b32 v49, 0
    v_mov_b32 v50, 0
    v_mov_b32 v51, 0
    v_mov_b32 v52, 0
    v_mov_b32 v53, 0
    v_mov_b32 v54, 0
    v_mov_b32 v55, 0
    v_mov_b32 v56, 0
    v_mov_b32 v57, 0
    v_mov_b32 v58, 0
    v_mov_b32 v59, 0
    v_mov_b32 v60, 0
    v_mov_b32 v61, 0
    v_mov_b32 v62, 0
    v_mov_b32 v63, 0
    v_mov_b32 v64, 0
    v_mov_b32 v65, 0
    v_mov_b32 v66, 0
    v_mov_b32 v67, 0
    v_mov_b32 v68, 0
    v_mov_b32 v69, 0
    v_mov_b32 v70, 0
    v_mov_b32 v71, 0
    v_mov_b32 v72, 0
    v_mov_b32 v73, 0
    v_mov_b32 v74, 0
    v_mov_b32 v75, 0
    v_mov_b32 v76, 0
    v_mov_b32 v77, 0
    v_mov_b32 v78, 0
    v_mov_b32 v79, 0
    v_mov_b32 v80, 0
    v_mov_b32 v81, 0
    v_mov_b32 v82, 0
    v_mov_b32 v83, 0
    v_mov_b32 v84, 0
    v_mov_b32 v85, 0
    v_mov_b32 v86, 0
    v_mov_b32 v87, 0
    v_mov_b32 v88, 0
    v_mov_b32 v89, 0
    v_mov_b32 v90, 0
    v_mov_b32 v91, 0
    v_mov_b32 v92, 0
    v_mov_b32 v93, 0
    v_mov_b32 v94, 0
    v_mov_b32 v95, 0
    v_mov_b32 v96, 0
    v_mov_b32 v97, 0
    v_mov_b32 v98, 0
    v_mov_b32 v99, 0
    v_mov_b32 v100, 0
    v_mov_b32 v101, 0
    v_mov_b32 v102, 0
    v_mov_b32 v103, 0
    v_mov_b32 v104, 0
    v_mov_b32 v105, 0
    v_mov_b32 v106, 0
    v_mov_b32 v107, 0
    v_mov_b32 v108, 0
    v_mov_b32 v109, 0
    v_mov_b32 v110, 0
    v_mov_b32 v111, 0
    s_waitcnt lgkmcnt(0)
    v_mfma_f32_16x16x32_bf16 v[112:115], a[48:51], a[0:3], 0
    v_mfma_f32_16x16x32_bf16 v[116:119], a[52:55], a[0:3], 0
    v_mfma_f32_16x16x32_bf16 v[112:115], a[56:59], a[4:7], v[112:115]
    v_mfma_f32_16x16x32_bf16 v[116:119], a[60:63], a[4:7], v[116:119]
    v_mfma_f32_16x16x32_bf16 v[112:115], a[64:67], a[8:11], v[112:115]
    v_mfma_f32_16x16x32_bf16 v[116:119], a[68:71], a[8:11], v[116:119]
    v_mfma_f32_16x16x32_bf16 v[112:115], a[72:75], a[12:15], v[112:115]
    v_mfma_f32_16x16x32_bf16 v[116:119], a[76:79], a[12:15], v[116:119]
    v_mfma_f32_16x16x32_bf16 v[120:123], a[48:51], a[16:19], 0
    v_mfma_f32_16x16x32_bf16 v[124:127], a[52:55], a[16:19], 0
    v_mfma_f32_16x16x32_bf16 v[120:123], a[56:59], a[20:23], v[120:123]
    v_mfma_f32_16x16x32_bf16 v[124:127], a[60:63], a[20:23], v[124:127]
    v_mfma_f32_16x16x32_bf16 v[120:123], a[64:67], a[24:27], v[120:123]
    v_mfma_f32_16x16x32_bf16 v[124:127], a[68:71], a[24:27], v[124:127]
    v_mfma_f32_16x16x32_bf16 v[120:123], a[72:75], a[28:31], v[120:123]
    v_mfma_f32_16x16x32_bf16 v[124:127], a[76:79], a[28:31], v[124:127]
    v_mfma_f32_16x16x32_bf16 v[128:131], a[48:51], a[32:35], 0
    v_mfma_f32_16x16x32_bf16 v[132:135], a[52:55], a[32:35], 0
    v_mfma_f32_16x16x32_bf16 v[128:131], a[56:59], a[36:39], v[128:131]
    v_mfma_f32_16x16x32_bf16 v[132:135], a[60:63], a[36:39], v[132:135]
    v_mfma_f32_16x16x32_bf16 v[128:131], a[64:67], a[40:43], v[128:131]
    v_mfma_f32_16x16x32_bf16 v[132:135], a[68:71], a[40:43], v[132:135]
    v_mfma_f32_16x16x32_bf16 v[128:131], a[72:75], a[44:47], v[128:131]
    v_mfma_f32_16x16x32_bf16 v[132:135], a[76:79], a[44:47], v[132:135]
    s_nop 7
    v_max3_f32 v4, v112, v113, v114
    v_max3_f32 v4, v4, v115, v116
    v_max3_f32 v4, v4, v117, v118
    v_max_f32 v4, v4, v119
    v_max3_f32 v5, v120, v121, v122
    v_max3_f32 v5, v5, v123, v124
    v_max3_f32 v5, v5, v125, v126
    v_max_f32 v5, v5, v127
    v_max3_f32 v6, v128, v129, v130
    v_max3_f32 v6, v6, v131, v132
    v_max3_f32 v6, v6, v133, v134
    v_max_f32 v6, v6, v135
    v_lshlrev_b32 v1, 2, v0
    v_xor_b32 v2, 64, v1
    v_xor_b32 v3, 128, v1
    ds_bpermute_b32 v8, v2, v4
    ds_bpermute_b32 v9, v2, v5
    ds_bpermute_b32 v10, v2, v6
    s_waitcnt lgkmcnt(0)
    v_max_f32 v4, v4, v8
    v_max_f32 v5, v5, v9
    v_max_f32 v6, v6, v10
    ds_bpermute_b32 v8, v3, v4
    ds_bpermute_b32 v9, v3, v5
    ds_bpermute_b32 v10, v3, v6
    s_waitcnt lgkmcnt(0)
    v_max_f32 v4, v4, v8
    v_max_f32 v5, v5, v9
    v_max_f32 v6, v6, v10
    v_sub_f32 v172, 0, v4
    v_sub_f32 v173, 0, v4
    v_sub_f32 v174, 0, v4
    v_sub_f32 v175, 0, v4
    v_sub_f32 v176, 0, v5
    v_sub_f32 v177, 0, v5
    v_sub_f32 v178, 0, v5
    v_sub_f32 v179, 0, v5
    v_sub_f32 v180, 0, v6
    v_sub_f32 v181, 0, v6
    v_sub_f32 v182, 0, v6
    v_sub_f32 v183, 0, v6
    ds_read_b128 a[48:51], v184 offset:0
    ds_read_b128 a[52:55], v184 offset:4096
    ds_read_b128 a[56:59], v185 offset:0
    ds_read_b128 a[60:63], v185 offset:4096
    ds_read_b128 a[64:67], v186 offset:0
    ds_read_b128 a[68:71], v186 offset:4096
    ds_read_b128 a[72:75], v187 offset:0
    ds_read_b128 a[76:79], v187 offset:4096
    ds_read_b64_tr_b16 a[80:81], v192 offset:8192
    ds_read_b64_tr_b16 a[82:83], v192 offset:12288
    ds_read_b64_tr_b16 a[84:85], v193 offset:8192
    ds_read_b64_tr_b16 a[86:87], v193 offset:12288
    ds_read_b64_tr_b16 a[88:89], v194 offset:8192
    ds_read_b64_tr_b16 a[90:91], v194 offset:12288
    ds_read_b64_tr_b16 a[92:93], v195 offset:8192
    ds_read_b64_tr_b16 a[94:95], v195 offset:12288
    ds_read_b64_tr_b16 a[96:97], v196 offset:8192
    ds_read_b64_tr_b16 a[98:99], v196 offset:12288
    ds_read_b64_tr_b16 a[100:101], v197 offset:8192
    ds_read_b64_tr_b16 a[102:103], v197 offset:12288
    ds_read_b64_tr_b16 a[104:105], v198 offset:8192
    ds_read_b64_tr_b16 a[106:107], v198 offset:12288
    ds_read_b64_tr_b16 a[108:109], v199 offset:8192
    ds_read_b64_tr_b16 a[110:111], v199 offset:12288
    v_sub_f32 v112, v112, v4
    v_sub_f32 v113, v113, v4
    v_sub_f32 v114, v114, v4
    v_sub_f32 v115, v115, v4
    v_sub_f32 v116, v116, v4
    v_sub_f32 v117, v117, v4
    v_sub_f32 v118, v118, v4
    v_sub_f32 v119, v119, v4
    v_sub_f32 v120, v120, v5
    v_sub_f32 v121, v121, v5
    v_sub_f32 v122, v122, v5
    v_sub_f32 v123, v123, v5
    v_sub_f32 v124, v124, v5
    v_sub_f32 v125, v125, v5
    v_sub_f32 v126, v126, v5
    v_sub_f32 v127, v127, v5
    v_sub_f32 v128, v128, v6
    v_sub_f32 v129, v129, v6
    v_sub_f32 v130, v130, v6
    v_sub_f32 v131, v131, v6
    v_sub_f32 v132, v132, v6
    v_sub_f32 v133, v133, v6
    v_sub_f32 v134, v134, v6
    v_sub_f32 v135, v135, v6
    s_waitcnt lgkmcnt(15)
    v_mfma_f32_16x16x32_bf16 v[136:139], a[48:51], a[0:3], v[172:175]
    v_exp_f32 v112, v112
    v_mfma_f32_16x16x32_bf16 v[140:143], a[52:55], a[0:3], v[172:175]
    v_exp_f32 v113, v113
    v_mfma_f32_16x16x32_bf16 v[136:139], a[56:59], a[4:7], v[136:139]
    v_exp_f32 v114, v114
    v_mfma_f32_16x16x32_bf16 v[140:143], a[60:63], a[4:7], v[140:143]
    v_exp_f32 v115, v115
    v_mfma_f32_16x16x32_bf16 v[136:139], a[64:67], a[8:11], v[136:139]
    v_exp_f32 v116, v116
    v_mfma_f32_16x16x32_bf16 v[140:143], a[68:71], a[8:11], v[140:143]
    v_exp_f32 v117, v117
    v_mfma_f32_16x16x32_bf16 v[136:139], a[72:75], a[12:15], v[136:139]
    v_exp_f32 v118, v118
    v_mfma_f32_16x16x32_bf16 v[140:143], a[76:79], a[12:15], v[140:143]
    v_exp_f32 v119, v119
    v_mfma_f32_16x16x32_bf16 v[144:147], a[48:51], a[16:19], v[176:179]
    v_cvt_pk_bf16_f32 v160, v112, v113
    v_cvt_pk_bf16_f32 v161, v114, v115
    v_mfma_f32_16x16x32_bf16 v[148:151], a[52:55], a[16:19], v[176:179]
    v_cvt_pk_bf16_f32 v162, v116, v117
    v_cvt_pk_bf16_f32 v163, v118, v119
    v_mfma_f32_16x16x32_bf16 v[144:147], a[56:59], a[20:23], v[144:147]
    v_exp_f32 v120, v120
    v_mfma_f32_16x16x32_bf16 v[148:151], a[60:63], a[20:23], v[148:151]
    v_exp_f32 v121, v121
    v_mfma_f32_16x16x32_bf16 v[144:147], a[64:67], a[24:27], v[144:147]
    v_exp_f32 v122, v122
    v_mfma_f32_16x16x32_bf16 v[148:151], a[68:71], a[24:27], v[148:151]
    v_exp_f32 v123, v123
    v_mfma_f32_16x16x32_bf16 v[144:147], a[72:75], a[28:31], v[144:147]
    v_exp_f32 v124, v124
    v_mfma_f32_16x16x32_bf16 v[148:151], a[76:79], a[28:31], v[148:151]
    v_exp_f32 v125, v125
    v_mfma_f32_16x16x32_bf16 v[152:155], a[48:51], a[32:35], v[180:183]
    v_exp_f32 v126, v126
    v_mfma_f32_16x16x32_bf16 v[156:159], a[52:55], a[32:35], v[180:183]
    v_exp_f32 v127, v127
    v_mfma_f32_16x16x32_bf16 v[152:155], a[56:59], a[36:39], v[152:155]
    v_cvt_pk_bf16_f32 v164, v120, v121
    v_cvt_pk_bf16_f32 v165, v122, v123
    v_mfma_f32_16x16x32_bf16 v[156:159], a[60:63], a[36:39], v[156:159]
    v_cvt_pk_bf16_f32 v166, v124, v125
    v_cvt_pk_bf16_f32 v167, v126, v127
    v_mfma_f32_16x16x32_bf16 v[152:155], a[64:67], a[40:43], v[152:155]
    v_exp_f32 v128, v128
    v_mfma_f32_16x16x32_bf16 v[156:159], a[68:71], a[40:43], v[156:159]
    v_exp_f32 v129, v129
    v_mfma_f32_16x16x32_bf16 v[152:155], a[72:75], a[44:47], v[152:155]
    v_exp_f32 v130, v130
    v_mfma_f32_16x16x32_bf16 v[156:159], a[76:79], a[44:47], v[156:159]
    v_exp_f32 v131, v131
    s_waitcnt lgkmcnt(0)
    v_mfma_f32_16x16x32_bf16 v[16:19], a[80:83], v[160:163], v[16:19]
    v_exp_f32 v132, v132
    v_mfma_f32_16x16x32_bf16 v[20:23], a[84:87], v[160:163], v[20:23]
    v_exp_f32 v133, v133
    v_mfma_f32_16x16x32_bf16 v[24:27], a[88:91], v[160:163], v[24:27]
    v_exp_f32 v134, v134
    v_mfma_f32_16x16x32_bf16 v[28:31], a[92:95], v[160:163], v[28:31]
    v_exp_f32 v135, v135
    v_mfma_f32_16x16x32_bf16 v[32:35], a[96:99], v[160:163], v[32:35]
    v_cvt_pk_bf16_f32 v168, v128, v129
    v_cvt_pk_bf16_f32 v169, v130, v131
    v_mfma_f32_16x16x32_bf16 v[36:39], a[100:103], v[160:163], v[36:39]
    v_cvt_pk_bf16_f32 v170, v132, v133
    v_cvt_pk_bf16_f32 v171, v134, v135
    v_mfma_f32_16x16x32_bf16 v[40:43], a[104:107], v[160:163], v[40:43]
    v_mfma_f32_16x16x32_bf16 v[44:47], a[108:111], v[160:163], v[44:47]
    v_mfma_f32_16x16x32_bf16 a[112:115], a[124:127], v[160:163], a[112:115]
    s_barrier
    v_mfma_f32_16x16x32_bf16 v[48:51], a[80:83], v[164:167], v[48:51]
    ds_read_b128 a[48:51], v184 offset:16384
    ds_read_b128 a[52:55], v184 offset:20480
    v_mfma_f32_16x16x32_bf16 v[52:55], a[84:87], v[164:167], v[52:55]
    ds_read_b128 a[56:59], v185 offset:16384
    ds_read_b128 a[60:63], v185 offset:20480
    v_mfma_f32_16x16x32_bf16 v[56:59], a[88:91], v[164:167], v[56:59]
    ds_read_b128 a[64:67], v186 offset:16384
    ds_read_b128 a[68:71], v186 offset:20480
    v_mfma_f32_16x16x32_bf16 v[60:63], a[92:95], v[164:167], v[60:63]
    ds_read_b128 a[72:75], v187 offset:16384
    ds_read_b128 a[76:79], v187 offset:20480
    v_mfma_f32_16x16x32_bf16 v[64:67], a[96:99], v[164:167], v[64:67]
    v_mfma_f32_16x16x32_bf16 v[68:71], a[100:103], v[164:167], v[68:71]
    v_mfma_f32_16x16x32_bf16 v[72:75], a[104:107], v[164:167], v[72:75]
    v_mfma_f32_16x16x32_bf16 v[76:79], a[108:111], v[164:167], v[76:79]
    v_mfma_f32_16x16x32_bf16 a[116:119], a[124:127], v[164:167], a[116:119]
    v_mfma_f32_16x16x32_bf16 v[80:83], a[80:83], v[168:171], v[80:83]
    ds_read_b64_tr_b16 a[80:81], v192 offset:24576
    ds_read_b64_tr_b16 a[82:83], v192 offset:28672
    v_mfma_f32_16x16x32_bf16 v[84:87], a[84:87], v[168:171], v[84:87]
    ds_read_b64_tr_b16 a[84:85], v193 offset:24576
    ds_read_b64_tr_b16 a[86:87], v193 offset:28672
    v_mfma_f32_16x16x32_bf16 v[88:91], a[88:91], v[168:171], v[88:91]
    ds_read_b64_tr_b16 a[88:89], v194 offset:24576
    ds_read_b64_tr_b16 a[90:91], v194 offset:28672
    v_mfma_f32_16x16x32_bf16 v[92:95], a[92:95], v[168:171], v[92:95]
    ds_read_b64_tr_b16 a[92:93], v195 offset:24576
    ds_read_b64_tr_b16 a[94:95], v195 offset:28672
    v_mfma_f32_16x16x32_bf16 v[96:99], a[96:99], v[168:171], v[96:99]
    ds_read_b64_tr_b16 a[96:97], v196 offset:24576
    ds_read_b64_tr_b16 a[98:99], v196 offset:28672
    v_mfma_f32_16x16x32_bf16 v[100:103], a[100:103], v[168:171], v[100:103]
    ds_read_b64_tr_b16 a[100:101], v197 offset:24576
    ds_read_b64_tr_b16 a[102:103], v197 offset:28672
    v_mfma_f32_16x16x32_bf16 v[104:107], a[104:107], v[168:171], v[104:107]
    ds_read_b64_tr_b16 a[104:105], v198 offset:24576
    ds_read_b64_tr_b16 a[106:107], v198 offset:28672
    v_mfma_f32_16x16x32_bf16 v[108:111], a[108:111], v[168:171], v[108:111]
    ds_read_b64_tr_b16 a[108:109], v199 offset:24576
    ds_read_b64_tr_b16 a[110:111], v199 offset:28672
    v_mfma_f32_16x16x32_bf16 a[120:123], a[124:127], v[168:171], a[120:123]
    s_waitcnt lgkmcnt(15)
    v_mfma_f32_16x16x32_bf16 v[112:115], a[48:51], a[0:3], v[172:175]
    v_exp_f32 v136, v136
    v_mfma_f32_16x16x32_bf16 v[116:119], a[52:55], a[0:3], v[172:175]
    v_exp_f32 v137, v137
    v_mfma_f32_16x16x32_bf16 v[112:115], a[56:59], a[4:7], v[112:115]
    v_exp_f32 v138, v138
    v_mfma_f32_16x16x32_bf16 v[116:119], a[60:63], a[4:7], v[116:119]
    v_exp_f32 v139, v139
    v_mfma_f32_16x16x32_bf16 v[112:115], a[64:67], a[8:11], v[112:115]
    v_exp_f32 v140, v140
    v_mfma_f32_16x16x32_bf16 v[116:119], a[68:71], a[8:11], v[116:119]
    v_exp_f32 v141, v141
    v_mfma_f32_16x16x32_bf16 v[112:115], a[72:75], a[12:15], v[112:115]
    v_exp_f32 v142, v142
    v_mfma_f32_16x16x32_bf16 v[116:119], a[76:79], a[12:15], v[116:119]
    v_exp_f32 v143, v143
    v_mfma_f32_16x16x32_bf16 v[120:123], a[48:51], a[16:19], v[176:179]
    v_cvt_pk_bf16_f32 v160, v136, v137
    v_cvt_pk_bf16_f32 v161, v138, v139
    v_mfma_f32_16x16x32_bf16 v[124:127], a[52:55], a[16:19], v[176:179]
    v_cvt_pk_bf16_f32 v162, v140, v141
    v_cvt_pk_bf16_f32 v163, v142, v143
    v_mfma_f32_16x16x32_bf16 v[120:123], a[56:59], a[20:23], v[120:123]
    v_exp_f32 v144, v144
    v_mfma_f32_16x16x32_bf16 v[124:127], a[60:63], a[20:23], v[124:127]
    v_exp_f32 v145, v145
    v_mfma_f32_16x16x32_bf16 v[120:123], a[64:67], a[24:27], v[120:123]
    v_exp_f32 v146, v146
    v_mfma_f32_16x16x32_bf16 v[124:127], a[68:71], a[24:27], v[124:127]
    v_exp_f32 v147, v147
    v_mfma_f32_16x16x32_bf16 v[120:123], a[72:75], a[28:31], v[120:123]
    v_exp_f32 v148, v148
    v_mfma_f32_16x16x32_bf16 v[124:127], a[76:79], a[28:31], v[124:127]
    v_exp_f32 v149, v149
    v_mfma_f32_16x16x32_bf16 v[128:131], a[48:51], a[32:35], v[180:183]
    v_exp_f32 v150, v150
    v_mfma_f32_16x16x32_bf16 v[132:135], a[52:55], a[32:35], v[180:183]
    v_exp_f32 v151, v151
    v_mfma_f32_16x16x32_bf16 v[128:131], a[56:59], a[36:39], v[128:131]
    v_cvt_pk_bf16_f32 v164, v144, v145
    v_cvt_pk_bf16_f32 v165, v146, v147
    v_mfma_f32_16x16x32_bf16 v[132:135], a[60:63], a[36:39], v[132:135]
    v_cvt_pk_bf16_f32 v166, v148, v149
    v_cvt_pk_bf16_f32 v167, v150, v151
    v_mfma_f32_16x16x32_bf16 v[128:131], a[64:67], a[40:43], v[128:131]
    v_exp_f32 v152, v152
    v_mfma_f32_16x16x32_bf16 v[132:135], a[68:71], a[40:43], v[132:135]
    v_exp_f32 v153, v153
    v_mfma_f32_16x16x32_bf16 v[128:131], a[72:75], a[44:47], v[128:131]
    v_exp_f32 v154, v154
    v_mfma_f32_16x16x32_bf16 v[132:135], a[76:79], a[44:47], v[132:135]
    v_exp_f32 v155, v155
    s_waitcnt lgkmcnt(0)
    v_mfma_f32_16x16x32_bf16 v[16:19], a[80:83], v[160:163], v[16:19]
    v_exp_f32 v156, v156
    v_mfma_f32_16x16x32_bf16 v[20:23], a[84:87], v[160:163], v[20:23]
    v_exp_f32 v157, v157
    v_mfma_f32_16x16x32_bf16 v[24:27], a[88:91], v[160:163], v[24:27]
    v_exp_f32 v158, v158
    v_mfma_f32_16x16x32_bf16 v[28:31], a[92:95], v[160:163], v[28:31]
    v_exp_f32 v159, v159
    v_mfma_f32_16x16x32_bf16 v[32:35], a[96:99], v[160:163], v[32:35]
    v_cvt_pk_bf16_f32 v168, v152, v153
    v_cvt_pk_bf16_f32 v169, v154, v155
    v_mfma_f32_16x16x32_bf16 v[36:39], a[100:103], v[160:163], v[36:39]
    v_cvt_pk_bf16_f32 v170, v156, v157
    v_cvt_pk_bf16_f32 v171, v158, v159
    v_mfma_f32_16x16x32_bf16 v[40:43], a[104:107], v[160:163], v[40:43]
    v_mfma_f32_16x16x32_bf16 v[44:47], a[108:111], v[160:163], v[44:47]
    v_mfma_f32_16x16x32_bf16 a[112:115], a[124:127], v[160:163], a[112:115]
    s_barrier
    v_mfma_f32_16x16x32_bf16 v[48:51], a[80:83], v[164:167], v[48:51]
    ds_read_b128 a[48:51], v184 offset:32768
    ds_read_b128 a[52:55], v184 offset:36864
    v_mfma_f32_16x16x32_bf16 v[52:55], a[84:87], v[164:167], v[52:55]
    ds_read_b128 a[56:59], v185 offset:32768
    ds_read_b128 a[60:63], v185 offset:36864
    v_mfma_f32_16x16x32_bf16 v[56:59], a[88:91], v[164:167], v[56:59]
    ds_read_b128 a[64:67], v186 offset:32768
    ds_read_b128 a[68:71], v186 offset:36864
    v_mfma_f32_16x16x32_bf16 v[60:63], a[92:95], v[164:167], v[60:63]
    ds_read_b128 a[72:75], v187 offset:32768
    ds_read_b128 a[76:79], v187 offset:36864
    v_mfma_f32_16x16x32_bf16 v[64:67], a[96:99], v[164:167], v[64:67]
    v_mfma_f32_16x16x32_bf16 v[68:71], a[100:103], v[164:167], v[68:71]
    v_mfma_f32_16x16x32_bf16 v[72:75], a[104:107], v[164:167], v[72:75]
    v_mfma_f32_16x16x32_bf16 v[76:79], a[108:111], v[164:167], v[76:79]
    v_mfma_f32_16x16x32_bf16 a[116:119], a[124:127], v[164:167], a[116:119]
    v_mfma_f32_16x16x32_bf16 v[80:83], a[80:83], v[168:171], v[80:83]
    ds_read_b64_tr_b16 a[80:81], v192 offset:40960
    ds_read_b64_tr_b16 a[82:83], v192 offset:45056
    v_mfma_f32_16x16x32_bf16 v[84:87], a[84:87], v[168:171], v[84:87]
    ds_read_b64_tr_b16 a[84:85], v193 offset:40960
    ds_read_b64_tr_b16 a[86:87], v193 offset:45056
    v_mfma_f32_16x16x32_bf16 v[88:91], a[88:91], v[168:171], v[88:91]
    ds_read_b64_tr_b16 a[88:89], v194 offset:40960
    ds_read_b64_tr_b16 a[90:91], v194 offset:45056
    v_mfma_f32_16x16x32_bf16 v[92:95], a[92:95], v[168:171], v[92:95]
    ds_read_b64_tr_b16 a[92:93], v195 offset:40960
    ds_read_b64_tr_b16 a[94:95], v195 offset:45056
    v_mfma_f32_16x16x32_bf16 v[96:99], a[96:99], v[168:171], v[96:99]
    ds_read_b64_tr_b16 a[96:97], v196 offset:40960
    ds_read_b64_tr_b16 a[98:99], v196 offset:45056
    v_mfma_f32_16x16x32_bf16 v[100:103], a[100:103], v[168:171], v[100:103]
    ds_read_b64_tr_b16 a[100:101], v197 offset:40960
    ds_read_b64_tr_b16 a[102:103], v197 offset:45056
    v_mfma_f32_16x16x32_bf16 v[104:107], a[104:107], v[168:171], v[104:107]
    ds_read_b64_tr_b16 a[104:105], v198 offset:40960
    ds_read_b64_tr_b16 a[106:107], v198 offset:45056
    v_mfma_f32_16x16x32_bf16 v[108:111], a[108:111], v[168:171], v[108:111]
    ds_read_b64_tr_b16 a[108:109], v199 offset:40960
    ds_read_b64_tr_b16 a[110:111], v199 offset:45056
    v_mfma_f32_16x16x32_bf16 a[120:123], a[124:127], v[168:171], a[120:123]
    s_waitcnt lgkmcnt(15)
    v_mfma_f32_16x16x32_bf16 v[136:139], a[48:51], a[0:3], v[172:175]
    v_exp_f32 v112, v112
    v_mfma_f32_16x16x32_bf16 v[140:143], a[52:55], a[0:3], v[172:175]
    v_exp_f32 v113, v113
    v_mfma_f32_16x16x32_bf16 v[136:139], a[56:59], a[4:7], v[136:139]
    v_exp_f32 v114, v114
    v_mfma_f32_16x16x32_bf16 v[140:143], a[60:63], a[4:7], v[140:143]
    v_exp_f32 v115, v115
    v_mfma_f32_16x16x32_bf16 v[136:139], a[64:67], a[8:11], v[136:139]
    v_exp_f32 v116, v116
    v_mfma_f32_16x16x32_bf16 v[140:143], a[68:71], a[8:11], v[140:143]
    v_exp_f32 v117, v117
    v_mfma_f32_16x16x32_bf16 v[136:139], a[72:75], a[12:15], v[136:139]
    v_exp_f32 v118, v118
    v_mfma_f32_16x16x32_bf16 v[140:143], a[76:79], a[12:15], v[140:143]
    v_exp_f32 v119, v119
    v_mfma_f32_16x16x32_bf16 v[144:147], a[48:51], a[16:19], v[176:179]
    v_cvt_pk_bf16_f32 v160, v112, v113
    v_cvt_pk_bf16_f32 v161, v114, v115
    v_mfma_f32_16x16x32_bf16 v[148:151], a[52:55], a[16:19], v[176:179]
    v_cvt_pk_bf16_f32 v162, v116, v117
    v_cvt_pk_bf16_f32 v163, v118, v119
    v_mfma_f32_16x16x32_bf16 v[144:147], a[56:59], a[20:23], v[144:147]
    v_exp_f32 v120, v120
    v_mfma_f32_16x16x32_bf16 v[148:151], a[60:63], a[20:23], v[148:151]
    v_exp_f32 v121, v121
    v_mfma_f32_16x16x32_bf16 v[144:147], a[64:67], a[24:27], v[144:147]
    v_exp_f32 v122, v122
    v_mfma_f32_16x16x32_bf16 v[148:151], a[68:71], a[24:27], v[148:151]
    v_exp_f32 v123, v123
    v_mfma_f32_16x16x32_bf16 v[144:147], a[72:75], a[28:31], v[144:147]
    v_exp_f32 v124, v124
    v_mfma_f32_16x16x32_bf16 v[148:151], a[76:79], a[28:31], v[148:151]
    v_exp_f32 v125, v125
    v_mfma_f32_16x16x32_bf16 v[152:155], a[48:51], a[32:35], v[180:183]
    v_exp_f32 v126, v126
    v_mfma_f32_16x16x32_bf16 v[156:159], a[52:55], a[32:35], v[180:183]
    v_exp_f32 v127, v127
    v_mfma_f32_16x16x32_bf16 v[152:155], a[56:59], a[36:39], v[152:155]
    v_cvt_pk_bf16_f32 v164, v120, v121
    v_cvt_pk_bf16_f32 v165, v122, v123
    v_mfma_f32_16x16x32_bf16 v[156:159], a[60:63], a[36:39], v[156:159]
    v_cvt_pk_bf16_f32 v166, v124, v125
    v_cvt_pk_bf16_f32 v167, v126, v127
    v_mfma_f32_16x16x32_bf16 v[152:155], a[64:67], a[40:43], v[152:155]
    v_exp_f32 v128, v128
    v_mfma_f32_16x16x32_bf16 v[156:159], a[68:71], a[40:43], v[156:159]
    v_exp_f32 v129, v129
    v_mfma_f32_16x16x32_bf16 v[152:155], a[72:75], a[44:47], v[152:155]
    v_exp_f32 v130, v130
    v_mfma_f32_16x16x32_bf16 v[156:159], a[76:79], a[44:47], v[156:159]
    v_exp_f32 v131, v131
    s_waitcnt lgkmcnt(0)
    v_mfma_f32_16x16x32_bf16 v[16:19], a[80:83], v[160:163], v[16:19]
    v_exp_f32 v132, v132
    v_mfma_f32_16x16x32_bf16 v[20:23], a[84:87], v[160:163], v[20:23]
    v_exp_f32 v133, v133
    v_mfma_f32_16x16x32_bf16 v[24:27], a[88:91], v[160:163], v[24:27]
    v_exp_f32 v134, v134
    v_mfma_f32_16x16x32_bf16 v[28:31], a[92:95], v[160:163], v[28:31]
    v_exp_f32 v135, v135
    v_mfma_f32_16x16x32_bf16 v[32:35], a[96:99], v[160:163], v[32:35]
    v_cvt_pk_bf16_f32 v168, v128, v129
    v_cvt_pk_bf16_f32 v169, v130, v131
    v_mfma_f32_16x16x32_bf16 v[36:39], a[100:103], v[160:163], v[36:39]
    v_cvt_pk_bf16_f32 v170, v132, v133
    v_cvt_pk_bf16_f32 v171, v134, v135
    v_mfma_f32_16x16x32_bf16 v[40:43], a[104:107], v[160:163], v[40:43]
    v_mfma_f32_16x16x32_bf16 v[44:47], a[108:111], v[160:163], v[44:47]
    v_mfma_f32_16x16x32_bf16 a[112:115], a[124:127], v[160:163], a[112:115]
    s_barrier
    v_mfma_f32_16x16x32_bf16 v[48:51], a[80:83], v[164:167], v[48:51]
    ds_read_b128 a[48:51], v184 offset:49152
    ds_read_b128 a[52:55], v184 offset:53248
    v_mfma_f32_16x16x32_bf16 v[52:55], a[84:87], v[164:167], v[52:55]
    ds_read_b128 a[56:59], v185 offset:49152
    ds_read_b128 a[60:63], v185 offset:53248
    v_mfma_f32_16x16x32_bf16 v[56:59], a[88:91], v[164:167], v[56:59]
    ds_read_b128 a[64:67], v186 offset:49152
    ds_read_b128 a[68:71], v186 offset:53248
    v_mfma_f32_16x16x32_bf16 v[60:63], a[92:95], v[164:167], v[60:63]
    ds_read_b128 a[72:75], v187 offset:49152
    ds_read_b128 a[76:79], v187 offset:53248
    v_mfma_f32_16x16x32_bf16 v[64:67], a[96:99], v[164:167], v[64:67]
    v_mfma_f32_16x16x32_bf16 v[68:71], a[100:103], v[164:167], v[68:71]
    v_mfma_f32_16x16x32_bf16 v[72:75], a[104:107], v[164:167], v[72:75]
    v_mfma_f32_16x16x32_bf16 v[76:79], a[108:111], v[164:167], v[76:79]
    v_mfma_f32_16x16x32_bf16 a[116:119], a[124:127], v[164:167], a[116:119]
    v_mfma_f32_16x16x32_bf16 v[80:83], a[80:83], v[168:171], v[80:83]
    ds_read_b64_tr_b16 a[80:81], v192 offset:57344
    ds_read_b64_tr_b16 a[82:83], v192 offset:61440
    v_mfma_f32_16x16x32_bf16 v[84:87], a[84:87], v[168:171], v[84:87]
    ds_read_b64_tr_b16 a[84:85], v193 offset:57344
    ds_read_b64_tr_b16 a[86:87], v193 offset:61440
    v_mfma_f32_16x16x32_bf16 v[88:91], a[88:91], v[168:171], v[88:91]
    ds_read_b64_tr_b16 a[88:89], v194 offset:57344
    ds_read_b64_tr_b16 a[90:91], v194 offset:61440
    v_mfma_f32_16x16x32_bf16 v[92:95], a[92:95], v[168:171], v[92:95]
    ds_read_b64_tr_b16 a[92:93], v195 offset:57344
    ds_read_b64_tr_b16 a[94:95], v195 offset:61440
    v_mfma_f32_16x16x32_bf16 v[96:99], a[96:99], v[168:171], v[96:99]
    ds_read_b64_tr_b16 a[96:97], v196 offset:57344
    ds_read_b64_tr_b16 a[98:99], v196 offset:61440
    v_mfma_f32_16x16x32_bf16 v[100:103], a[100:103], v[168:171], v[100:103]
    ds_read_b64_tr_b16 a[100:101], v197 offset:57344
    ds_read_b64_tr_b16 a[102:103], v197 offset:61440
    v_mfma_f32_16x16x32_bf16 v[104:107], a[104:107], v[168:171], v[104:107]
    ds_read_b64_tr_b16 a[104:105], v198 offset:57344
    ds_read_b64_tr_b16 a[106:107], v198 offset:61440
    v_mfma_f32_16x16x32_bf16 v[108:111], a[108:111], v[168:171], v[108:111]
    ds_read_b64_tr_b16 a[108:109], v199 offset:57344
    ds_read_b64_tr_b16 a[110:111], v199 offset:61440
    v_mfma_f32_16x16x32_bf16 a[120:123], a[124:127], v[168:171], a[120:123]
    s_waitcnt lgkmcnt(15)
    v_mfma_f32_16x16x32_bf16 v[112:115], a[48:51], a[0:3], v[172:175]
    v_exp_f32 v136, v136
    v_mfma_f32_16x16x32_bf16 v[116:119], a[52:55], a[0:3], v[172:175]
    v_exp_f32 v137, v137
    v_mfma_f32_16x16x32_bf16 v[112:115], a[56:59], a[4:7], v[112:115]
    v_exp_f32 v138, v138
    v_mfma_f32_16x16x32_bf16 v[116:119], a[60:63], a[4:7], v[116:119]
    v_exp_f32 v139, v139
    v_mfma_f32_16x16x32_bf16 v[112:115], a[64:67], a[8:11], v[112:115]
    v_exp_f32 v140, v140
    v_mfma_f32_16x16x32_bf16 v[116:119], a[68:71], a[8:11], v[116:119]
    v_exp_f32 v141, v141
    v_mfma_f32_16x16x32_bf16 v[112:115], a[72:75], a[12:15], v[112:115]
    v_exp_f32 v142, v142
    v_mfma_f32_16x16x32_bf16 v[116:119], a[76:79], a[12:15], v[116:119]
    v_exp_f32 v143, v143
    v_mfma_f32_16x16x32_bf16 v[120:123], a[48:51], a[16:19], v[176:179]
    v_cvt_pk_bf16_f32 v160, v136, v137
    v_cvt_pk_bf16_f32 v161, v138, v139
    v_mfma_f32_16x16x32_bf16 v[124:127], a[52:55], a[16:19], v[176:179]
    v_cvt_pk_bf16_f32 v162, v140, v141
    v_cvt_pk_bf16_f32 v163, v142, v143
    v_mfma_f32_16x16x32_bf16 v[120:123], a[56:59], a[20:23], v[120:123]
    v_exp_f32 v144, v144
    v_mfma_f32_16x16x32_bf16 v[124:127], a[60:63], a[20:23], v[124:127]
    v_exp_f32 v145, v145
    v_mfma_f32_16x16x32_bf16 v[120:123], a[64:67], a[24:27], v[120:123]
    v_exp_f32 v146, v146
    v_mfma_f32_16x16x32_bf16 v[124:127], a[68:71], a[24:27], v[124:127]
    v_exp_f32 v147, v147
    v_mfma_f32_16x16x32_bf16 v[120:123], a[72:75], a[28:31], v[120:123]
    v_exp_f32 v148, v148
    v_mfma_f32_16x16x32_bf16 v[124:127], a[76:79], a[28:31], v[124:127]
    v_exp_f32 v149, v149
    v_mfma_f32_16x16x32_bf16 v[128:131], a[48:51], a[32:35], v[180:183]
    v_exp_f32 v150, v150
    v_mfma_f32_16x16x32_bf16 v[132:135], a[52:55], a[32:35], v[180:183]
    v_exp_f32 v151, v151
    v_mfma_f32_16x16x32_bf16 v[128:131], a[56:59], a[36:39], v[128:131]
    v_cvt_pk_bf16_f32 v164, v144, v145
    v_cvt_pk_bf16_f32 v165, v146, v147
    v_mfma_f32_16x16x32_bf16 v[132:135], a[60:63], a[36:39], v[132:135]
    v_cvt_pk_bf16_f32 v166, v148, v149
    v_cvt_pk_bf16_f32 v167, v150, v151
    v_mfma_f32_16x16x32_bf16 v[128:131], a[64:67], a[40:43], v[128:131]
    v_exp_f32 v152, v152
    v_mfma_f32_16x16x32_bf16 v[132:135], a[68:71], a[40:43], v[132:135]
    v_exp_f32 v153, v153
    v_mfma_f32_16x16x32_bf16 v[128:131], a[72:75], a[44:47], v[128:131]
    v_exp_f32 v154, v154
    v_mfma_f32_16x16x32_bf16 v[132:135], a[76:79], a[44:47], v[132:135]
    v_exp_f32 v155, v155
    s_waitcnt lgkmcnt(0)
    v_mfma_f32_16x16x32_bf16 v[16:19], a[80:83], v[160:163], v[16:19]
    v_exp_f32 v156, v156
    v_mfma_f32_16x16x32_bf16 v[20:23], a[84:87], v[160:163], v[20:23]
    v_exp_f32 v157, v157
    v_mfma_f32_16x16x32_bf16 v[24:27], a[88:91], v[160:163], v[24:27]
    v_exp_f32 v158, v158
    v_mfma_f32_16x16x32_bf16 v[28:31], a[92:95], v[160:163], v[28:31]
    v_exp_f32 v159, v159
    v_mfma_f32_16x16x32_bf16 v[32:35], a[96:99], v[160:163], v[32:35]
    v_cvt_pk_bf16_f32 v168, v152, v153
    v_cvt_pk_bf16_f32 v169, v154, v155
    v_mfma_f32_16x16x32_bf16 v[36:39], a[100:103], v[160:163], v[36:39]
    v_cvt_pk_bf16_f32 v170, v156, v157
    v_cvt_pk_bf16_f32 v171, v158, v159
    v_mfma_f32_16x16x32_bf16 v[40:43], a[104:107], v[160:163], v[40:43]
    v_mfma_f32_16x16x32_bf16 v[44:47], a[108:111], v[160:163], v[44:47]
    v_mfma_f32_16x16x32_bf16 a[112:115], a[124:127], v[160:163], a[112:115]
    s_barrier
    v_mfma_f32_16x16x32_bf16 v[48:51], a[80:83], v[164:167], v[48:51]
    ds_read_b128 a[48:51], v188 offset:0
    ds_read_b128 a[52:55], v188 offset:4096
    v_mfma_f32_16x16x32_bf16 v[52:55], a[84:87], v[164:167], v[52:55]
    ds_read_b128 a[56:59], v189 offset:0
    ds_read_b128 a[60:63], v189 offset:4096
    v_mfma_f32_16x16x32_bf16 v[56:59], a[88:91], v[164:167], v[56:59]
    ds_read_b128 a[64:67], v190 offset:0
    ds_read_b128 a[68:71], v190 offset:4096
    v_mfma_f32_16x16x32_bf16 v[60:63], a[92:95], v[164:167], v[60:63]
    ds_read_b128 a[72:75], v191 offset:0
    ds_read_b128 a[76:79], v191 offset:4096
    v_mfma_f32_16x16x32_bf16 v[64:67], a[96:99], v[164:167], v[64:67]
    v_mfma_f32_16x16x32_bf16 v[68:71], a[100:103], v[164:167], v[68:71]
    v_mfma_f32_16x16x32_bf16 v[72:75], a[104:107], v[164:167], v[72:75]
    v_mfma_f32_16x16x32_bf16 v[76:79], a[108:111], v[164:167], v[76:79]
    v_mfma_f32_16x16x32_bf16 a[116:119], a[124:127], v[164:167], a[116:119]
    v_mfma_f32_16x16x32_bf16 v[80:83], a[80:83], v[168:171], v[80:83]
    ds_read_b64_tr_b16 a[80:81], v200 offset:8192
    ds_read_b64_tr_b16 a[82:83], v200 offset:12288
    v_mfma_f32_16x16x32_bf16 v[84:87], a[84:87], v[168:171], v[84:87]
    ds_read_b64_tr_b16 a[84:85], v201 offset:8192
    ds_read_b64_tr_b16 a[86:87], v201 offset:12288
    v_mfma_f32_16x16x32_bf16 v[88:91], a[88:91], v[168:171], v[88:91]
    ds_read_b64_tr_b16 a[88:89], v202 offset:8192
    ds_read_b64_tr_b16 a[90:91], v202 offset:12288
    v_mfma_f32_16x16x32_bf16 v[92:95], a[92:95], v[168:171], v[92:95]
    ds_read_b64_tr_b16 a[92:93], v203 offset:8192
    ds_read_b64_tr_b16 a[94:95], v203 offset:12288
    v_mfma_f32_16x16x32_bf16 v[96:99], a[96:99], v[168:171], v[96:99]
    ds_read_b64_tr_b16 a[96:97], v204 offset:8192
    ds_read_b64_tr_b16 a[98:99], v204 offset:12288
    v_mfma_f32_16x16x32_bf16 v[100:103], a[100:103], v[168:171], v[100:103]
    ds_read_b64_tr_b16 a[100:101], v205 offset:8192
    ds_read_b64_tr_b16 a[102:103], v205 offset:12288
    v_mfma_f32_16x16x32_bf16 v[104:107], a[104:107], v[168:171], v[104:107]
    ds_read_b64_tr_b16 a[104:105], v206 offset:8192
    ds_read_b64_tr_b16 a[106:107], v206 offset:12288
    v_mfma_f32_16x16x32_bf16 v[108:111], a[108:111], v[168:171], v[108:111]
    ds_read_b64_tr_b16 a[108:109], v207 offset:8192
    ds_read_b64_tr_b16 a[110:111], v207 offset:12288
    v_mfma_f32_16x16x32_bf16 a[120:123], a[124:127], v[168:171], a[120:123]
    s_waitcnt lgkmcnt(15)
    v_mfma_f32_16x16x32_bf16 v[136:139], a[48:51], a[0:3], v[172:175]
    v_exp_f32 v112, v112
    v_mfma_f32_16x16x32_bf16 v[140:143], a[52:55], a[0:3], v[172:175]
    v_exp_f32 v113, v113
    v_mfma_f32_16x16x32_bf16 v[136:139], a[56:59], a[4:7], v[136:139]
    v_exp_f32 v114, v114
    v_mfma_f32_16x16x32_bf16 v[140:143], a[60:63], a[4:7], v[140:143]
    v_exp_f32 v115, v115
    v_mfma_f32_16x16x32_bf16 v[136:139], a[64:67], a[8:11], v[136:139]
    v_exp_f32 v116, v116
    v_mfma_f32_16x16x32_bf16 v[140:143], a[68:71], a[8:11], v[140:143]
    v_exp_f32 v117, v117
    v_mfma_f32_16x16x32_bf16 v[136:139], a[72:75], a[12:15], v[136:139]
    v_exp_f32 v118, v118
    v_mfma_f32_16x16x32_bf16 v[140:143], a[76:79], a[12:15], v[140:143]
    v_exp_f32 v119, v119
    v_mfma_f32_16x16x32_bf16 v[144:147], a[48:51], a[16:19], v[176:179]
    v_cvt_pk_bf16_f32 v160, v112, v113
    v_cvt_pk_bf16_f32 v161, v114, v115
    v_mfma_f32_16x16x32_bf16 v[148:151], a[52:55], a[16:19], v[176:179]
    v_cvt_pk_bf16_f32 v162, v116, v117
    v_cvt_pk_bf16_f32 v163, v118, v119
    v_mfma_f32_16x16x32_bf16 v[144:147], a[56:59], a[20:23], v[144:147]
    v_exp_f32 v120, v120
    v_mfma_f32_16x16x32_bf16 v[148:151], a[60:63], a[20:23], v[148:151]
    v_exp_f32 v121, v121
    v_mfma_f32_16x16x32_bf16 v[144:147], a[64:67], a[24:27], v[144:147]
    v_exp_f32 v122, v122
    v_mfma_f32_16x16x32_bf16 v[148:151], a[68:71], a[24:27], v[148:151]
    v_exp_f32 v123, v123
    v_mfma_f32_16x16x32_bf16 v[144:147], a[72:75], a[28:31], v[144:147]
    v_exp_f32 v124, v124
    v_mfma_f32_16x16x32_bf16 v[148:151], a[76:79], a[28:31], v[148:151]
    v_exp_f32 v125, v125
    v_mfma_f32_16x16x32_bf16 v[152:155], a[48:51], a[32:35], v[180:183]
    v_exp_f32 v126, v126
    v_mfma_f32_16x16x32_bf16 v[156:159], a[52:55], a[32:35], v[180:183]
    v_exp_f32 v127, v127
    v_mfma_f32_16x16x32_bf16 v[152:155], a[56:59], a[36:39], v[152:155]
    v_cvt_pk_bf16_f32 v164, v120, v121
    v_cvt_pk_bf16_f32 v165, v122, v123
    v_mfma_f32_16x16x32_bf16 v[156:159], a[60:63], a[36:39], v[156:159]
    v_cvt_pk_bf16_f32 v166, v124, v125
    v_cvt_pk_bf16_f32 v167, v126, v127
    v_mfma_f32_16x16x32_bf16 v[152:155], a[64:67], a[40:43], v[152:155]
    v_exp_f32 v128, v128
    v_mfma_f32_16x16x32_bf16 v[156:159], a[68:71], a[40:43], v[156:159]
    v_exp_f32 v129, v129
    v_mfma_f32_16x16x32_bf16 v[152:155], a[72:75], a[44:47], v[152:155]
    v_exp_f32 v130, v130
    v_mfma_f32_16x16x32_bf16 v[156:159], a[76:79], a[44:47], v[156:159]
    v_exp_f32 v131, v131
    s_waitcnt lgkmcnt(0)
    v_mfma_f32_16x16x32_bf16 v[16:19], a[80:83], v[160:163], v[16:19]
    v_exp_f32 v132, v132
    v_mfma_f32_16x16x32_bf16 v[20:23], a[84:87], v[160:163], v[20:23]
    v_exp_f32 v133, v133
    v_mfma_f32_16x16x32_bf16 v[24:27], a[88:91], v[160:163], v[24:27]
    v_exp_f32 v134, v134
    v_mfma_f32_16x16x32_bf16 v[28:31], a[92:95], v[160:163], v[28:31]
    v_exp_f32 v135, v135
    v_mfma_f32_16x16x32_bf16 v[32:35], a[96:99], v[160:163], v[32:35]
    v_cvt_pk_bf16_f32 v168, v128, v129
    v_cvt_pk_bf16_f32 v169, v130, v131
    v_mfma_f32_16x16x32_bf16 v[36:39], a[100:103], v[160:163], v[36:39]
    v_cvt_pk_bf16_f32 v170, v132, v133
    v_cvt_pk_bf16_f32 v171, v134, v135
    v_mfma_f32_16x16x32_bf16 v[40:43], a[104:107], v[160:163], v[40:43]
    v_mfma_f32_16x16x32_bf16 v[44:47], a[108:111], v[160:163], v[44:47]
    v_mfma_f32_16x16x32_bf16 a[112:115], a[124:127], v[160:163], a[112:115]
    s_barrier
    v_mfma_f32_16x16x32_bf16 v[48:51], a[80:83], v[164:167], v[48:51]
    ds_read_b128 a[48:51], v188 offset:16384
    ds_read_b128 a[52:55], v188 offset:20480
    v_mfma_f32_16x16x32_bf16 v[52:55], a[84:87], v[164:167], v[52:55]
    ds_read_b128 a[56:59], v189 offset:16384
    ds_read_b128 a[60:63], v189 offset:20480
    v_mfma_f32_16x16x32_bf16 v[56:59], a[88:91], v[164:167], v[56:59]
    ds_read_b128 a[64:67], v190 offset:16384
    ds_read_b128 a[68:71], v190 offset:20480
    v_mfma_f32_16x16x32_bf16 v[60:63], a[92:95], v[164:167], v[60:63]
    ds_read_b128 a[72:75], v191 offset:16384
    ds_read_b128 a[76:79], v191 offset:20480
    v_mfma_f32_16x16x32_bf16 v[64:67], a[96:99], v[164:167], v[64:67]
    v_mfma_f32_16x16x32_bf16 v[68:71], a[100:103], v[164:167], v[68:71]
    v_mfma_f32_16x16x32_bf16 v[72:75], a[104:107], v[164:167], v[72:75]
    v_mfma_f32_16x16x32_bf16 v[76:79], a[108:111], v[164:167], v[76:79]
    v_mfma_f32_16x16x32_bf16 a[116:119], a[124:127], v[164:167], a[116:119]
    v_mfma_f32_16x16x32_bf16 v[80:83], a[80:83], v[168:171], v[80:83]
    ds_read_b64_tr_b16 a[80:81], v200 offset:24576
    ds_read_b64_tr_b16 a[82:83], v200 offset:28672
    v_mfma_f32_16x16x32_bf16 v[84:87], a[84:87], v[168:171], v[84:87]
    ds_read_b64_tr_b16 a[84:85], v201 offset:24576
    ds_read_b64_tr_b16 a[86:87], v201 offset:28672
    v_mfma_f32_16x16x32_bf16 v[88:91], a[88:91], v[168:171], v[88:91]
    ds_read_b64_tr_b16 a[88:89], v202 offset:24576
    ds_read_b64_tr_b16 a[90:91], v202 offset:28672
    v_mfma_f32_16x16x32_bf16 v[92:95], a[92:95], v[168:171], v[92:95]
    ds_read_b64_tr_b16 a[92:93], v203 offset:24576
    ds_read_b64_tr_b16 a[94:95], v203 offset:28672
    v_mfma_f32_16x16x32_bf16 v[96:99], a[96:99], v[168:171], v[96:99]
    ds_read_b64_tr_b16 a[96:97], v204 offset:24576
    ds_read_b64_tr_b16 a[98:99], v204 offset:28672
    v_mfma_f32_16x16x32_bf16 v[100:103], a[100:103], v[168:171], v[100:103]
    ds_read_b64_tr_b16 a[100:101], v205 offset:24576
    ds_read_b64_tr_b16 a[102:103], v205 offset:28672
    v_mfma_f32_16x16x32_bf16 v[104:107], a[104:107], v[168:171], v[104:107]
    ds_read_b64_tr_b16 a[104:105], v206 offset:24576
    ds_read_b64_tr_b16 a[106:107], v206 offset:28672
    v_mfma_f32_16x16x32_bf16 v[108:111], a[108:111], v[168:171], v[108:111]
    ds_read_b64_tr_b16 a[108:109], v207 offset:24576
    ds_read_b64_tr_b16 a[110:111], v207 offset:28672
    v_mfma_f32_16x16x32_bf16 a[120:123], a[124:127], v[168:171], a[120:123]
    global_load_dwordx2 v[240:241], v248, s[16:17] sc1
    s_waitcnt lgkmcnt(15)
    v_mfma_f32_16x16x32_bf16 v[112:115], a[48:51], a[0:3], v[172:175]
    v_exp_f32 v136, v136
    v_mfma_f32_16x16x32_bf16 v[116:119], a[52:55], a[0:3], v[172:175]
    v_exp_f32 v137, v137
    v_mfma_f32_16x16x32_bf16 v[112:115], a[56:59], a[4:7], v[112:115]
    v_exp_f32 v138, v138
    v_mfma_f32_16x16x32_bf16 v[116:119], a[60:63], a[4:7], v[116:119]
    v_exp_f32 v139, v139
    v_mfma_f32_16x16x32_bf16 v[112:115], a[64:67], a[8:11], v[112:115]
    v_exp_f32 v140, v140
    v_mfma_f32_16x16x32_bf16 v[116:119], a[68:71], a[8:11], v[116:119]
    v_exp_f32 v141, v141
    v_mfma_f32_16x16x32_bf16 v[112:115], a[72:75], a[12:15], v[112:115]
    v_exp_f32 v142, v142
    v_mfma_f32_16x16x32_bf16 v[116:119], a[76:79], a[12:15], v[116:119]
    v_exp_f32 v143, v143
    v_mfma_f32_16x16x32_bf16 v[120:123], a[48:51], a[16:19], v[176:179]
    v_cvt_pk_bf16_f32 v160, v136, v137
    v_cvt_pk_bf16_f32 v161, v138, v139
    v_mfma_f32_16x16x32_bf16 v[124:127], a[52:55], a[16:19], v[176:179]
    v_cvt_pk_bf16_f32 v162, v140, v141
    v_cvt_pk_bf16_f32 v163, v142, v143
    v_mfma_f32_16x16x32_bf16 v[120:123], a[56:59], a[20:23], v[120:123]
    v_exp_f32 v144, v144
    v_mfma_f32_16x16x32_bf16 v[124:127], a[60:63], a[20:23], v[124:127]
    v_exp_f32 v145, v145
    v_mfma_f32_16x16x32_bf16 v[120:123], a[64:67], a[24:27], v[120:123]
    v_exp_f32 v146, v146
    v_mfma_f32_16x16x32_bf16 v[124:127], a[68:71], a[24:27], v[124:127]
    v_exp_f32 v147, v147
    v_mfma_f32_16x16x32_bf16 v[120:123], a[72:75], a[28:31], v[120:123]
    v_exp_f32 v148, v148
    v_mfma_f32_16x16x32_bf16 v[124:127], a[76:79], a[28:31], v[124:127]
    v_exp_f32 v149, v149
    v_mfma_f32_16x16x32_bf16 v[128:131], a[48:51], a[32:35], v[180:183]
    v_exp_f32 v150, v150
    v_mfma_f32_16x16x32_bf16 v[132:135], a[52:55], a[32:35], v[180:183]
    v_exp_f32 v151, v151
    v_mfma_f32_16x16x32_bf16 v[128:131], a[56:59], a[36:39], v[128:131]
    v_cvt_pk_bf16_f32 v164, v144, v145
    v_cvt_pk_bf16_f32 v165, v146, v147
    v_mfma_f32_16x16x32_bf16 v[132:135], a[60:63], a[36:39], v[132:135]
    v_cvt_pk_bf16_f32 v166, v148, v149
    v_cvt_pk_bf16_f32 v167, v150, v151
    v_mfma_f32_16x16x32_bf16 v[128:131], a[64:67], a[40:43], v[128:131]
    v_exp_f32 v152, v152
    v_mfma_f32_16x16x32_bf16 v[132:135], a[68:71], a[40:43], v[132:135]
    v_exp_f32 v153, v153
    v_mfma_f32_16x16x32_bf16 v[128:131], a[72:75], a[44:47], v[128:131]
    v_exp_f32 v154, v154
    v_mfma_f32_16x16x32_bf16 v[132:135], a[76:79], a[44:47], v[132:135]
    v_exp_f32 v155, v155
    s_waitcnt lgkmcnt(0)
    v_mfma_f32_16x16x32_bf16 v[16:19], a[80:83], v[160:163], v[16:19]
    v_exp_f32 v156, v156
    v_mfma_f32_16x16x32_bf16 v[20:23], a[84:87], v[160:163], v[20:23]
    v_exp_f32 v157, v157
    v_mfma_f32_16x16x32_bf16 v[24:27], a[88:91], v[160:163], v[24:27]
    v_exp_f32 v158, v158
    v_mfma_f32_16x16x32_bf16 v[28:31], a[92:95], v[160:163], v[28:31]
    v_exp_f32 v159, v159
    v_mfma_f32_16x16x32_bf16 v[32:35], a[96:99], v[160:163], v[32:35]
    v_cvt_pk_bf16_f32 v168, v152, v153
    v_cvt_pk_bf16_f32 v169, v154, v155
    v_mfma_f32_16x16x32_bf16 v[36:39], a[100:103], v[160:163], v[36:39]
    v_cvt_pk_bf16_f32 v170, v156, v157
    v_cvt_pk_bf16_f32 v171, v158, v159
    v_mfma_f32_16x16x32_bf16 v[40:43], a[104:107], v[160:163], v[40:43]
    v_mfma_f32_16x16x32_bf16 v[44:47], a[108:111], v[160:163], v[44:47]
    v_mfma_f32_16x16x32_bf16 a[112:115], a[124:127], v[160:163], a[112:115]
    s_barrier
    v_mfma_f32_16x16x32_bf16 v[48:51], a[80:83], v[164:167], v[48:51]
    ds_read_b128 a[48:51], v188 offset:32768
    ds_read_b128 a[52:55], v188 offset:36864
    v_mfma_f32_16x16x32_bf16 v[52:55], a[84:87], v[164:167], v[52:55]
    ds_read_b128 a[56:59], v189 offset:32768
    ds_read_b128 a[60:63], v189 offset:36864
    v_mfma_f32_16x16x32_bf16 v[56:59], a[88:91], v[164:167], v[56:59]
    ds_read_b128 a[64:67], v190 offset:32768
    ds_read_b128 a[68:71], v190 offset:36864
    v_mfma_f32_16x16x32_bf16 v[60:63], a[92:95], v[164:167], v[60:63]
    ds_read_b128 a[72:75], v191 offset:32768
    ds_read_b128 a[76:79], v191 offset:36864
    v_mfma_f32_16x16x32_bf16 v[64:67], a[96:99], v[164:167], v[64:67]
    v_mfma_f32_16x16x32_bf16 v[68:71], a[100:103], v[164:167], v[68:71]
    v_mfma_f32_16x16x32_bf16 v[72:75], a[104:107], v[164:167], v[72:75]
    v_mfma_f32_16x16x32_bf16 v[76:79], a[108:111], v[164:167], v[76:79]
    v_mfma_f32_16x16x32_bf16 a[116:119], a[124:127], v[164:167], a[116:119]
    v_mfma_f32_16x16x32_bf16 v[80:83], a[80:83], v[168:171], v[80:83]
    ds_read_b64_tr_b16 a[80:81], v200 offset:40960
    ds_read_b64_tr_b16 a[82:83], v200 offset:45056
    v_mfma_f32_16x16x32_bf16 v[84:87], a[84:87], v[168:171], v[84:87]
    ds_read_b64_tr_b16 a[84:85], v201 offset:40960
    ds_read_b64_tr_b16 a[86:87], v201 offset:45056
    v_mfma_f32_16x16x32_bf16 v[88:91], a[88:91], v[168:171], v[88:91]
    ds_read_b64_tr_b16 a[88:89], v202 offset:40960
    ds_read_b64_tr_b16 a[90:91], v202 offset:45056
    v_mfma_f32_16x16x32_bf16 v[92:95], a[92:95], v[168:171], v[92:95]
    ds_read_b64_tr_b16 a[92:93], v203 offset:40960
    ds_read_b64_tr_b16 a[94:95], v203 offset:45056
    v_mfma_f32_16x16x32_bf16 v[96:99], a[96:99], v[168:171], v[96:99]
    ds_read_b64_tr_b16 a[96:97], v204 offset:40960
    ds_read_b64_tr_b16 a[98:99], v204 offset:45056
    v_mfma_f32_16x16x32_bf16 v[100:103], a[100:103], v[168:171], v[100:103]
    ds_read_b64_tr_b16 a[100:101], v205 offset:40960
    ds_read_b64_tr_b16 a[102:103], v205 offset:45056
    v_mfma_f32_16x16x32_bf16 v[104:107], a[104:107], v[168:171], v[104:107]
    ds_read_b64_tr_b16 a[104:105], v206 offset:40960
    ds_read_b64_tr_b16 a[106:107], v206 offset:45056
    v_mfma_f32_16x16x32_bf16 v[108:111], a[108:111], v[168:171], v[108:111]
    ds_read_b64_tr_b16 a[108:109], v207 offset:40960
    ds_read_b64_tr_b16 a[110:111], v207 offset:45056
    v_mfma_f32_16x16x32_bf16 a[120:123], a[124:127], v[168:171], a[120:123]
    s_mov_b32 s44, 0
L_loop:
    s_waitcnt lgkmcnt(15)
    v_mfma_f32_16x16x32_bf16 v[136:139], a[48:51], a[0:3], v[172:175]
    v_exp_f32 v112, v112
    v_mfma_f32_16x16x32_bf16 v[140:143], a[52:55], a[0:3], v[172:175]
    v_exp_f32 v113, v113
    v_mfma_f32_16x16x32_bf16 v[136:139], a[56:59], a[4:7], v[136:139]
    v_exp_f32 v114, v114
    v_mfma_f32_16x16x32_bf16 v[140:143], a[60:63], a[4:7], v[140:143]
    v_exp_f32 v115, v115
    v_mfma_f32_16x16x32_bf16 v[136:139], a[64:67], a[8:11], v[136:139]
    v_exp_f32 v116, v116
    v_mfma_f32_16x16x32_bf16 v[140:143], a[68:71], a[8:11], v[140:143]
    v_exp_f32 v117, v117
    v_mfma_f32_16x16x32_bf16 v[136:139], a[72:75], a[12:15], v[136:139]
    v_exp_f32 v118, v118
    v_mfma_f32_16x16x32_bf16 v[140:143], a[76:79], a[12:15], v[140:143]
    v_exp_f32 v119, v119
    v_mfma_f32_16x16x32_bf16 v[144:147], a[48:51], a[16:19], v[176:179]
    v_cvt_pk_bf16_f32 v160, v112, v113
    v_cvt_pk_bf16_f32 v161, v114, v115
    v_mfma_f32_16x16x32_bf16 v[148:151], a[52:55], a[16:19], v[176:179]
    v_cvt_pk_bf16_f32 v162, v116, v117
    v_cvt_pk_bf16_f32 v163, v118, v119
    v_mfma_f32_16x16x32_bf16 v[144:147], a[56:59], a[20:23], v[144:147]
    v_exp_f32 v120, v120
    v_mfma_f32_16x16x32_bf16 v[148:151], a[60:63], a[20:23], v[148:151]
    v_exp_f32 v121, v121
    v_mfma_f32_16x16x32_bf16 v[144:147], a[64:67], a[24:27], v[144:147]
    v_exp_f32 v122, v122
    v_mfma_f32_16x16x32_bf16 v[148:151], a[68:71], a[24:27], v[148:151]
    v_exp_f32 v123, v123
    v_mfma_f32_16x16x32_bf16 v[144:147], a[72:75], a[28:31], v[144:147]
    v_exp_f32 v124, v124
    v_mfma_f32_16x16x32_bf16 v[148:151], a[76:79], a[28:31], v[148:151]
    v_exp_f32 v125, v125
    v_mfma_f32_16x16x32_bf16 v[152:155], a[48:51], a[32:35], v[180:183]
    v_exp_f32 v126, v126
    v_mfma_f32_16x16x32_bf16 v[156:159], a[52:55], a[32:35], v[180:183]
    v_exp_f32 v127, v127
    v_mfma_f32_16x16x32_bf16 v[152:155], a[56:59], a[36:39], v[152:155]
    v_cvt_pk_bf16_f32 v164, v120, v121
    v_cvt_pk_bf16_f32 v165, v122, v123
    v_mfma_f32_16x16x32_bf16 v[156:159], a[60:63], a[36:39], v[156:159]
    v_cvt_pk_bf16_f32 v166, v124, v125
    v_cvt_pk_bf16_f32 v167, v126, v127
    v_mfma_f32_16x16x32_bf16 v[152:155], a[64:67], a[40:43], v[152:155]
    v_exp_f32 v128, v128
    v_mfma_f32_16x16x32_bf16 v[156:159], a[68:71], a[40:43], v[156:159]
    v_exp_f32 v129, v129
    v_mfma_f32_16x16x32_bf16 v[152:155], a[72:75], a[44:47], v[152:155]
    v_exp_f32 v130, v130
    v_mfma_f32_16x16x32_bf16 v[156:159], a[76:79], a[44:47], v[156:159]
    v_exp_f32 v131, v131
    s_waitcnt lgkmcnt(0)
    v_mfma_f32_16x16x32_bf16 v[16:19], a[80:83], v[160:163], v[16:19]
    v_exp_f32 v132, v132
    v_mfma_f32_16x16x32_bf16 v[20:23], a[84:87], v[160:163], v[20:23]
    v_exp_f32 v133, v133
    v_mfma_f32_16x16x32_bf16 v[24:27], a[88:91], v[160:163], v[24:27]
    v_exp_f32 v134, v134
    v_mfma_f32_16x16x32_bf16 v[28:31], a[92:95], v[160:163], v[28:31]
    v_exp_f32 v135, v135
    v_mfma_f32_16x16x32_bf16 v[32:35], a[96:99], v[160:163], v[32:35]
    v_cvt_pk_bf16_f32 v168, v128, v129
    v_cvt_pk_bf16_f32 v169, v130, v131
    v_mfma_f32_16x16x32_bf16 v[36:39], a[100:103], v[160:163], v[36:39]
    v_cvt_pk_bf16_f32 v170, v132, v133
    v_cvt_pk_bf16_f32 v171, v134, v135
    v_mfma_f32_16x16x32_bf16 v[40:43], a[104:107], v[160:163], v[40:43]
    v_mfma_f32_16x16x32_bf16 v[44:47], a[108:111], v[160:163], v[44:47]
    v_mfma_f32_16x16x32_bf16 a[112:115], a[124:127], v[160:163], a[112:115]
    s_barrier
    v_mfma_f32_16x16x32_bf16 v[48:51], a[80:83], v[164:167], v[48:51]
    ds_read_b128 a[48:51], v188 offset:49152
    ds_read_b128 a[52:55], v188 offset:53248
    v_mfma_f32_16x16x32_bf16 v[52:55], a[84:87], v[164:167], v[52:55]
    ds_read_b128 a[56:59], v189 offset:49152
    ds_read_b128 a[60:63], v189 offset:53248
    v_mfma_f32_16x16x32_bf16 v[56:59], a[88:91], v[164:167], v[56:59]
    ds_read_b128 a[64:67], v190 offset:49152
    ds_read_b128 a[68:71], v190 offset:53248
    v_mfma_f32_16x16x32_bf16 v[60:63], a[92:95], v[164:167], v[60:63]
    ds_read_b128 a[72:75], v191 offset:49152
    ds_read_b128 a[76:79], v191 offset:53248
    v_mfma_f32_16x16x32_bf16 v[64:67], a[96:99], v[164:167], v[64:67]
    v_mfma_f32_16x16x32_bf16 v[68:71], a[100:103], v[164:167], v[68:71]
    v_mfma_f32_16x16x32_bf16 v[72:75], a[104:107], v[164:167], v[72:75]
    v_mfma_f32_16x16x32_bf16 v[76:79], a[108:111], v[164:167], v[76:79]
    v_mfma_f32_16x16x32_bf16 a[116:119], a[124:127], v[164:167], a[116:119]
    v_mfma_f32_16x16x32_bf16 v[80:83], a[80:83], v[168:171], v[80:83]
    ds_read_b64_tr_b16 a[80:81], v200 offset:57344
    ds_read_b64_tr_b16 a[82:83], v200 offset:61440
    v_mfma_f32_16x16x32_bf16 v[84:87], a[84:87], v[168:171], v[84:87]
    ds_read_b64_tr_b16 a[84:85], v201 offset:57344
    ds_read_b64_tr_b16 a[86:87], v201 offset:61440
    v_mfma_f32_16x16x32_bf16 v[88:91], a[88:91], v[168:171], v[88:91]
    ds_read_b64_tr_b16 a[88:89], v202 offset:57344
    ds_read_b64_tr_b16 a[90:91], v202 offset:61440
    v_mfma_f32_16x16x32_bf16 v[92:95], a[92:95], v[168:171], v[92:95]
    ds_read_b64_tr_b16 a[92:93], v203 offset:57344
    ds_read_b64_tr_b16 a[94:95], v203 offset:61440
    v_mfma_f32_16x16x32_bf16 v[96:99], a[96:99], v[168:171], v[96:99]
    ds_read_b64_tr_b16 a[96:97], v204 offset:57344
    ds_read_b64_tr_b16 a[98:99], v204 offset:61440
    v_mfma_f32_16x16x32_bf16 v[100:103], a[100:103], v[168:171], v[100:103]
    ds_read_b64_tr_b16 a[100:101], v205 offset:57344
    ds_read_b64_tr_b16 a[102:103], v205 offset:61440
    v_mfma_f32_16x16x32_bf16 v[104:107], a[104:107], v[168:171], v[104:107]
    ds_read_b64_tr_b16 a[104:105], v206 offset:57344
    ds_read_b64_tr_b16 a[106:107], v206 offset:61440
    v_mfma_f32_16x16x32_bf16 v[108:111], a[108:111], v[168:171], v[108:111]
    ds_read_b64_tr_b16 a[108:109], v207 offset:57344
    ds_read_b64_tr_b16 a[110:111], v207 offset:61440
    v_mfma_f32_16x16x32_bf16 a[120:123], a[124:127], v[168:171], a[120:123]
    s_waitcnt lgkmcnt(15)
    v_mfma_f32_16x16x32_bf16 v[112:115], a[48:51], a[0:3], v[172:175]
    v_exp_f32 v136, v136
    v_mfma_f32_16x16x32_bf16 v[116:119], a[52:55], a[0:3], v[172:175]
    v_exp_f32 v137, v137
    v_mfma_f32_16x16x32_bf16 v[112:115], a[56:59], a[4:7], v[112:115]
    v_exp_f32 v138, v138
    v_mfma_f32_16x16x32_bf16 v[116:119], a[60:63], a[4:7], v[116:119]
    v_exp_f32 v139, v139
    v_mfma_f32_16x16x32_bf16 v[112:115], a[64:67], a[8:11], v[112:115]
    v_exp_f32 v140, v140
    v_mfma_f32_16x16x32_bf16 v[116:119], a[68:71], a[8:11], v[116:119]
    v_exp_f32 v141, v141
    v_mfma_f32_16x16x32_bf16 v[112:115], a[72:75], a[12:15], v[112:115]
    v_exp_f32 v142, v142
    v_mfma_f32_16x16x32_bf16 v[116:119], a[76:79], a[12:15], v[116:119]
    v_exp_f32 v143, v143
    v_mfma_f32_16x16x32_bf16 v[120:123], a[48:51], a[16:19], v[176:179]
    v_cvt_pk_bf16_f32 v160, v136, v137
    v_cvt_pk_bf16_f32 v161, v138, v139
    v_mfma_f32_16x16x32_bf16 v[124:127], a[52:55], a[16:19], v[176:179]
    v_cvt_pk_bf16_f32 v162, v140, v141
    v_cvt_pk_bf16_f32 v163, v142, v143
    v_mfma_f32_16x16x32_bf16 v[120:123], a[56:59], a[20:23], v[120:123]
    v_exp_f32 v144, v144
    v_mfma_f32_16x16x32_bf16 v[124:127], a[60:63], a[20:23], v[124:127]
    v_exp_f32 v145, v145
    v_mfma_f32_16x16x32_bf16 v[120:123], a[64:67], a[24:27], v[120:123]
    v_exp_f32 v146, v146
    v_mfma_f32_16x16x32_bf16 v[124:127], a[68:71], a[24:27], v[124:127]
    v_exp_f32 v147, v147
    v_mfma_f32_16x16x32_bf16 v[120:123], a[72:75], a[28:31], v[120:123]
    v_exp_f32 v148, v148
    v_mfma_f32_16x16x32_bf16 v[124:127], a[76:79], a[28:31], v[124:127]
    v_exp_f32 v149, v149
    v_mfma_f32_16x16x32_bf16 v[128:131], a[48:51], a[32:35], v[180:183]
    v_exp_f32 v150, v150
    v_mfma_f32_16x16x32_bf16 v[132:135], a[52:55], a[32:35], v[180:183]
    v_exp_f32 v151, v151
    v_mfma_f32_16x16x32_bf16 v[128:131], a[56:59], a[36:39], v[128:131]
    v_cvt_pk_bf16_f32 v164, v144, v145
    v_cvt_pk_bf16_f32 v165, v146, v147
    v_mfma_f32_16x16x32_bf16 v[132:135], a[60:63], a[36:39], v[132:135]
    v_cvt_pk_bf16_f32 v166, v148, v149
    v_cvt_pk_bf16_f32 v167, v150, v151
    v_mfma_f32_16x16x32_bf16 v[128:131], a[64:67], a[40:43], v[128:131]
    v_exp_f32 v152, v152
    v_mfma_f32_16x16x32_bf16 v[132:135], a[68:71], a[40:43], v[132:135]
    v_exp_f32 v153, v153
    v_mfma_f32_16x16x32_bf16 v[128:131], a[72:75], a[44:47], v[128:131]
    v_exp_f32 v154, v154
    v_mfma_f32_16x16x32_bf16 v[132:135], a[76:79], a[44:47], v[132:135]
    v_exp_f32 v155, v155
    s_waitcnt lgkmcnt(0)
    v_mfma_f32_16x16x32_bf16 v[16:19], a[80:83], v[160:163], v[16:19]
    v_exp_f32 v156, v156
    v_mfma_f32_16x16x32_bf16 v[20:23], a[84:87], v[160:163], v[20:23]
    v_exp_f32 v157, v157
    v_mfma_f32_16x16x32_bf16 v[24:27], a[88:91], v[160:163], v[24:27]
    v_exp_f32 v158, v158
    v_mfma_f32_16x16x32_bf16 v[28:31], a[92:95], v[160:163], v[28:31]
    v_exp_f32 v159, v159
    v_mfma_f32_16x16x32_bf16 v[32:35], a[96:99], v[160:163], v[32:35]
    v_cvt_pk_bf16_f32 v168, v152, v153
    v_cvt_pk_bf16_f32 v169, v154, v155
    v_mfma_f32_16x16x32_bf16 v[36:39], a[100:103], v[160:163], v[36:39]
    v_cvt_pk_bf16_f32 v170, v156, v157
    v_cvt_pk_bf16_f32 v171, v158, v159
    v_mfma_f32_16x16x32_bf16 v[40:43], a[104:107], v[160:163], v[40:43]
    v_mfma_f32_16x16x32_bf16 v[44:47], a[108:111], v[160:163], v[44:47]
    v_mfma_f32_16x16x32_bf16 a[112:115], a[124:127], v[160:163], a[112:115]
    s_barrier
    v_mfma_f32_16x16x32_bf16 v[48:51], a[80:83], v[164:167], v[48:51]
    ds_read_b128 a[48:51], v184 offset:0
    ds_read_b128 a[52:55], v184 offset:4096
    v_mfma_f32_16x16x32_bf16 v[52:55], a[84:87], v[164:167], v[52:55]
    ds_read_b128 a[56:59], v185 offset:0
    ds_read_b128 a[60:63], v185 offset:4096
    v_mfma_f32_16x16x32_bf16 v[56:59], a[88:91], v[164:167], v[56:59]
    ds_read_b128 a[64:67], v186 offset:0
    ds_read_b128 a[68:71], v186 offset:4096
    v_mfma_f32_16x16x32_bf16 v[60:63], a[92:95], v[164:167], v[60:63]
    ds_read_b128 a[72:75], v187 offset:0
    ds_read_b128 a[76:79], v187 offset:4096
    v_mfma_f32_16x16x32_bf16 v[64:67], a[96:99], v[164:167], v[64:67]
    v_mfma_f32_16x16x32_bf16 v[68:71], a[100:103], v[164:167], v[68:71]
    v_mfma_f32_16x16x32_bf16 v[72:75], a[104:107], v[164:167], v[72:75]
    v_mfma_f32_16x16x32_bf16 v[76:79], a[108:111], v[164:167], v[76:79]
    v_mfma_f32_16x16x32_bf16 a[116:119], a[124:127], v[164:167], a[116:119]
    v_mfma_f32_16x16x32_bf16 v[80:83], a[80:83], v[168:171], v[80:83]
    ds_read_b64_tr_b16 a[80:81], v192 offset:8192
    ds_read_b64_tr_b16 a[82:83], v192 offset:12288
    v_mfma_f32_16x16x32_bf16 v[84:87], a[84:87], v[168:171], v[84:87]
    ds_read_b64_tr_b16 a[84:85], v193 offset:8192
    ds_read_b64_tr_b16 a[86:87], v193 offset:12288
    v_mfma_f32_16x16x32_bf16 v[88:91], a[88:91], v[168:171], v[88:91]
    ds_read_b64_tr_b16 a[88:89], v194 offset:8192
    ds_read_b64_tr_b16 a[90:91], v194 offset:12288
    v_mfma_f32_16x16x32_bf16 v[92:95], a[92:95], v[168:171], v[92:95]
    ds_read_b64_tr_b16 a[92:93], v195 offset:8192
    ds_read_b64_tr_b16 a[94:95], v195 offset:12288
    v_mfma_f32_16x16x32_bf16 v[96:99], a[96:99], v[168:171], v[96:99]
    ds_read_b64_tr_b16 a[96:97], v196 offset:8192
    ds_read_b64_tr_b16 a[98:99], v196 offset:12288
    v_mfma_f32_16x16x32_bf16 v[100:103], a[100:103], v[168:171], v[100:103]
    ds_read_b64_tr_b16 a[100:101], v197 offset:8192
    ds_read_b64_tr_b16 a[102:103], v197 offset:12288
    v_mfma_f32_16x16x32_bf16 v[104:107], a[104:107], v[168:171], v[104:107]
    ds_read_b64_tr_b16 a[104:105], v198 offset:8192
    ds_read_b64_tr_b16 a[106:107], v198 offset:12288
    v_mfma_f32_16x16x32_bf16 v[108:111], a[108:111], v[168:171], v[108:111]
    ds_read_b64_tr_b16 a[108:109], v199 offset:8192
    ds_read_b64_tr_b16 a[110:111], v199 offset:12288
    v_mfma_f32_16x16x32_bf16 a[120:123], a[124:127], v[168:171], a[120:123]
    s_waitcnt lgkmcnt(15)
    v_mfma_f32_16x16x32_bf16 v[136:139], a[48:51], a[0:3], v[172:175]
    v_exp_f32 v112, v112
    v_mfma_f32_16x16x32_bf16 v[140:143], a[52:55], a[0:3], v[172:175]
    v_exp_f32 v113, v113
    v_mfma_f32_16x16x32_bf16 v[136:139], a[56:59], a[4:7], v[136:139]
    v_exp_f32 v114, v114
    v_mfma_f32_16x16x32_bf16 v[140:143], a[60:63], a[4:7], v[140:143]
    v_exp_f32 v115, v115
    v_mfma_f32_16x16x32_bf16 v[136:139], a[64:67], a[8:11], v[136:139]
    v_exp_f32 v116, v116
    v_mfma_f32_16x16x32_bf16 v[140:143], a[68:71], a[8:11], v[140:143]
    v_exp_f32 v117, v117
    v_mfma_f32_16x16x32_bf16 v[136:139], a[72:75], a[12:15], v[136:139]
    v_exp_f32 v118, v118
    v_mfma_f32_16x16x32_bf16 v[140:143], a[76:79], a[12:15], v[140:143]
    v_exp_f32 v119, v119
    v_mfma_f32_16x16x32_bf16 v[144:147], a[48:51], a[16:19], v[176:179]
    v_cvt_pk_bf16_f32 v160, v112, v113
    v_cvt_pk_bf16_f32 v161, v114, v115
    v_mfma_f32_16x16x32_bf16 v[148:151], a[52:55], a[16:19], v[176:179]
    v_cvt_pk_bf16_f32 v162, v116, v117
    v_cvt_pk_bf16_f32 v163, v118, v119
    v_mfma_f32_16x16x32_bf16 v[144:147], a[56:59], a[20:23], v[144:147]
    v_exp_f32 v120, v120
    v_mfma_f32_16x16x32_bf16 v[148:151], a[60:63], a[20:23], v[148:151]
    v_exp_f32 v121, v121
    v_mfma_f32_16x16x32_bf16 v[144:147], a[64:67], a[24:27], v[144:147]
    v_exp_f32 v122, v122
    v_mfma_f32_16x16x32_bf16 v[148:151], a[68:71], a[24:27], v[148:151]
    v_exp_f32 v123, v123
    v_mfma_f32_16x16x32_bf16 v[144:147], a[72:75], a[28:31], v[144:147]
    v_exp_f32 v124, v124
    v_mfma_f32_16x16x32_bf16 v[148:151], a[76:79], a[28:31], v[148:151]
    v_exp_f32 v125, v125
    v_mfma_f32_16x16x32_bf16 v[152:155], a[48:51], a[32:35], v[180:183]
    v_exp_f32 v126, v126
    v_mfma_f32_16x16x32_bf16 v[156:159], a[52:55], a[32:35], v[180:183]
    v_exp_f32 v127, v127
    v_mfma_f32_16x16x32_bf16 v[152:155], a[56:59], a[36:39], v[152:155]
    v_cvt_pk_bf16_f32 v164, v120, v121
    v_cvt_pk_bf16_f32 v165, v122, v123
    v_mfma_f32_16x16x32_bf16 v[156:159], a[60:63], a[36:39], v[156:159]
    v_cvt_pk_bf16_f32 v166, v124, v125
    v_cvt_pk_bf16_f32 v167, v126, v127
    v_mfma_f32_16x16x32_bf16 v[152:155], a[64:67], a[40:43], v[152:155]
    v_exp_f32 v128, v128
    v_mfma_f32_16x16x32_bf16 v[156:159], a[68:71], a[40:43], v[156:159]
    v_exp_f32 v129, v129
    v_mfma_f32_16x16x32_bf16 v[152:155], a[72:75], a[44:47], v[152:155]
    v_exp_f32 v130, v130
    v_mfma_f32_16x16x32_bf16 v[156:159], a[76:79], a[44:47], v[156:159]
    v_exp_f32 v131, v131
    s_waitcnt lgkmcnt(0)
    v_mfma_f32_16x16x32_bf16 v[16:19], a[80:83], v[160:163], v[16:19]
    v_exp_f32 v132, v132
    v_mfma_f32_16x16x32_bf16 v[20:23], a[84:87], v[160:163], v[20:23]
    v_exp_f32 v133, v133
    v_mfma_f32_16x16x32_bf16 v[24:27], a[88:91], v[160:163], v[24:27]
    v_exp_f32 v134, v134
    v_mfma_f32_16x16x32_bf16 v[28:31], a[92:95], v[160:163], v[28:31]
    v_exp_f32 v135, v135
    v_mfma_f32_16x16x32_bf16 v[32:35], a[96:99], v[160:163], v[32:35]
    v_cvt_pk_bf16_f32 v168, v128, v129
    v_cvt_pk_bf16_f32 v169, v130, v131
    v_mfma_f32_16x16x32_bf16 v[36:39], a[100:103], v[160:163], v[36:39]
    v_cvt_pk_bf16_f32 v170, v132, v133
    v_cvt_pk_bf16_f32 v171, v134, v135
    v_mfma_f32_16x16x32_bf16 v[40:43], a[104:107], v[160:163], v[40:43]
    v_mfma_f32_16x16x32_bf16 v[44:47], a[108:111], v[160:163], v[44:47]
    v_mfma_f32_16x16x32_bf16 a[112:115], a[124:127], v[160:163], a[112:115]
    s_barrier
    v_mfma_f32_16x16x32_bf16 v[48:51], a[80:83], v[164:167], v[48:51]
    ds_read_b128 a[48:51], v184 offset:16384
    ds_read_b128 a[52:55], v184 offset:20480
    v_mfma_f32_16x16x32_bf16 v[52:55], a[84:87], v[164:167], v[52:55]
    ds_read_b128 a[56:59], v185 offset:16384
    ds_read_b128 a[60:63], v185 offset:20480
    v_mfma_f32_16x16x32_bf16 v[56:59], a[88:91], v[164:167], v[56:59]
    ds_read_b128 a[64:67], v186 offset:16384
    ds_read_b128 a[68:71], v186 offset:20480
    v_mfma_f32_16x16x32_bf16 v[60:63], a[92:95], v[164:167], v[60:63]
    ds_read_b128 a[72:75], v187 offset:16384
    ds_read_b128 a[76:79], v187 offset:20480
    v_mfma_f32_16x16x32_bf16 v[64:67], a[96:99], v[164:167], v[64:67]
    v_mfma_f32_16x16x32_bf16 v[68:71], a[100:103], v[164:167], v[68:71]
    v_mfma_f32_16x16x32_bf16 v[72:75], a[104:107], v[164:167], v[72:75]
    v_mfma_f32_16x16x32_bf16 v[76:79], a[108:111], v[164:167], v[76:79]
    v_mfma_f32_16x16x32_bf16 a[116:119], a[124:127], v[164:167], a[116:119]
    v_mfma_f32_16x16x32_bf16 v[80:83], a[80:83], v[168:171], v[80:83]
    ds_read_b64_tr_b16 a[80:81], v192 offset:24576
    ds_read_b64_tr_b16 a[82:83], v192 offset:28672
    v_mfma_f32_16x16x32_bf16 v[84:87], a[84:87], v[168:171], v[84:87]
    ds_read_b64_tr_b16 a[84:85], v193 offset:24576
    ds_read_b64_tr_b16 a[86:87], v193 offset:28672
    v_mfma_f32_16x16x32_bf16 v[88:91], a[88:91], v[168:171], v[88:91]
    ds_read_b64_tr_b16 a[88:89], v194 offset:24576
    ds_read_b64_tr_b16 a[90:91], v194 offset:28672
    v_mfma_f32_16x16x32_bf16 v[92:95], a[92:95], v[168:171], v[92:95]
    ds_read_b64_tr_b16 a[92:93], v195 offset:24576
    ds_read_b64_tr_b16 a[94:95], v195 offset:28672
    v_mfma_f32_16x16x32_bf16 v[96:99], a[96:99], v[168:171], v[96:99]
    ds_read_b64_tr_b16 a[96:97], v196 offset:24576
    ds_read_b64_tr_b16 a[98:99], v196 offset:28672
    v_mfma_f32_16x16x32_bf16 v[100:103], a[100:103], v[168:171], v[100:103]
    ds_read_b64_tr_b16 a[100:101], v197 offset:24576
    ds_read_b64_tr_b16 a[102:103], v197 offset:28672
    v_mfma_f32_16x16x32_bf16 v[104:107], a[104:107], v[168:171], v[104:107]
    ds_read_b64_tr_b16 a[104:105], v198 offset:24576
    ds_read_b64_tr_b16 a[106:107], v198 offset:28672
    v_mfma_f32_16x16x32_bf16 v[108:111], a[108:111], v[168:171], v[108:111]
    ds_read_b64_tr_b16 a[108:109], v199 offset:24576
    ds_read_b64_tr_b16 a[110:111], v199 offset:28672
    v_mfma_f32_16x16x32_bf16 a[120:123], a[124:127], v[168:171], a[120:123]
    s_waitcnt lgkmcnt(15)
    v_mfma_f32_16x16x32_bf16 v[112:115], a[48:51], a[0:3], v[172:175]
    v_exp_f32 v136, v136
    v_mfma_f32_16x16x32_bf16 v[116:119], a[52:55], a[0:3], v[172:175]
    v_exp_f32 v137, v137
    v_mfma_f32_16x16x32_bf16 v[112:115], a[56:59], a[4:7], v[112:115]
    v_exp_f32 v138, v138
    v_mfma_f32_16x16x32_bf16 v[116:119], a[60:63], a[4:7], v[116:119]
    v_exp_f32 v139, v139
    v_mfma_f32_16x16x32_bf16 v[112:115], a[64:67], a[8:11], v[112:115]
    v_exp_f32 v140, v140
    v_mfma_f32_16x16x32_bf16 v[116:119], a[68:71], a[8:11], v[116:119]
    v_exp_f32 v141, v141
    v_mfma_f32_16x16x32_bf16 v[112:115], a[72:75], a[12:15], v[112:115]
    v_exp_f32 v142, v142
    v_mfma_f32_16x16x32_bf16 v[116:119], a[76:79], a[12:15], v[116:119]
    v_exp_f32 v143, v143
    v_mfma_f32_16x16x32_bf16 v[120:123], a[48:51], a[16:19], v[176:179]
    v_cvt_pk_bf16_f32 v160, v136, v137
    v_cvt_pk_bf16_f32 v161, v138, v139
    v_mfma_f32_16x16x32_bf16 v[124:127], a[52:55], a[16:19], v[176:179]
    v_cvt_pk_bf16_f32 v162, v140, v141
    v_cvt_pk_bf16_f32 v163, v142, v143
    v_mfma_f32_16x16x32_bf16 v[120:123], a[56:59], a[20:23], v[120:123]
    v_exp_f32 v144, v144
    v_mfma_f32_16x16x32_bf16 v[124:127], a[60:63], a[20:23], v[124:127]
    v_exp_f32 v145, v145
    v_mfma_f32_16x16x32_bf16 v[120:123], a[64:67], a[24:27], v[120:123]
    v_exp_f32 v146, v146
    v_mfma_f32_16x16x32_bf16 v[124:127], a[68:71], a[24:27], v[124:127]
    v_exp_f32 v147, v147
    v_mfma_f32_16x16x32_bf16 v[120:123], a[72:75], a[28:31], v[120:123]
    v_exp_f32 v148, v148
    v_mfma_f32_16x16x32_bf16 v[124:127], a[76:79], a[28:31], v[124:127]
    v_exp_f32 v149, v149
    v_mfma_f32_16x16x32_bf16 v[128:131], a[48:51], a[32:35], v[180:183]
    v_exp_f32 v150, v150
    v_mfma_f32_16x16x32_bf16 v[132:135], a[52:55], a[32:35], v[180:183]
    v_exp_f32 v151, v151
    v_mfma_f32_16x16x32_bf16 v[128:131], a[56:59], a[36:39], v[128:131]
    v_cvt_pk_bf16_f32 v164, v144, v145
    v_cvt_pk_bf16_f32 v165, v146, v147
    v_mfma_f32_16x16x32_bf16 v[132:135], a[60:63], a[36:39], v[132:135]
    v_cvt_pk_bf16_f32 v166, v148, v149
    v_cvt_pk_bf16_f32 v167, v150, v151
    v_mfma_f32_16x16x32_bf16 v[128:131], a[64:67], a[40:43], v[128:131]
    v_exp_f32 v152, v152
    v_mfma_f32_16x16x32_bf16 v[132:135], a[68:71], a[40:43], v[132:135]
    v_exp_f32 v153, v153
    v_mfma_f32_16x16x32_bf16 v[128:131], a[72:75], a[44:47], v[128:131]
    v_exp_f32 v154, v154
    v_mfma_f32_16x16x32_bf16 v[132:135], a[76:79], a[44:47], v[132:135]
    v_exp_f32 v155, v155
    s_waitcnt lgkmcnt(0)
    v_mfma_f32_16x16x32_bf16 v[16:19], a[80:83], v[160:163], v[16:19]
    v_exp_f32 v156, v156
    v_mfma_f32_16x16x32_bf16 v[20:23], a[84:87], v[160:163], v[20:23]
    v_exp_f32 v157, v157
    v_mfma_f32_16x16x32_bf16 v[24:27], a[88:91], v[160:163], v[24:27]
    v_exp_f32 v158, v158
    v_mfma_f32_16x16x32_bf16 v[28:31], a[92:95], v[160:163], v[28:31]
    v_exp_f32 v159, v159
    v_mfma_f32_16x16x32_bf16 v[32:35], a[96:99], v[160:163], v[32:35]
    v_cvt_pk_bf16_f32 v168, v152, v153
    v_cvt_pk_bf16_f32 v169, v154, v155
    v_mfma_f32_16x16x32_bf16 v[36:39], a[100:103], v[160:163], v[36:39]
    v_cvt_pk_bf16_f32 v170, v156, v157
    v_cvt_pk_bf16_f32 v171, v158, v159
    v_mfma_f32_16x16x32_bf16 v[40:43], a[104:107], v[160:163], v[40:43]
    v_mfma_f32_16x16x32_bf16 v[44:47], a[108:111], v[160:163], v[44:47]
    v_mfma_f32_16x16x32_bf16 a[112:115], a[124:127], v[160:163], a[112:115]
    s_barrier
    v_mfma_f32_16x16x32_bf16 v[48:51], a[80:83], v[164:167], v[48:51]
    ds_read_b128 a[48:51], v184 offset:32768
    ds_read_b128 a[52:55], v184 offset:36864
    v_mfma_f32_16x16x32_bf16 v[52:55], a[84:87], v[164:167], v[52:55]
    ds_read_b128 a[56:59], v185 offset:32768
    ds_read_b128 a[60:63], v185 offset:36864
    v_mfma_f32_16x16x32_bf16 v[56:59], a[88:91], v[164:167], v[56:59]
    ds_read_b128 a[64:67], v186 offset:32768
    ds_read_b128 a[68:71], v186 offset:36864
    v_mfma_f32_16x16x32_bf16 v[60:63], a[92:95], v[164:167], v[60:63]
    ds_read_b128 a[72:75], v187 offset:32768
    ds_read_b128 a[76:79], v187 offset:36864
    v_mfma_f32_16x16x32_bf16 v[64:67], a[96:99], v[164:167], v[64:67]
    v_mfma_f32_16x16x32_bf16 v[68:71], a[100:103], v[164:167], v[68:71]
    v_mfma_f32_16x16x32_bf16 v[72:75], a[104:107], v[164:167], v[72:75]
    v_mfma_f32_16x16x32_bf16 v[76:79], a[108:111], v[164:167], v[76:79]
    v_mfma_f32_16x16x32_bf16 a[116:119], a[124:127], v[164:167], a[116:119]
    v_mfma_f32_16x16x32_bf16 v[80:83], a[80:83], v[168:171], v[80:83]
    ds_read_b64_tr_b16 a[80:81], v192 offset:40960
    ds_read_b64_tr_b16 a[82:83], v192 offset:45056
    v_mfma_f32_16x16x32_bf16 v[84:87], a[84:87], v[168:171], v[84:87]
    ds_read_b64_tr_b16 a[84:85], v193 offset:40960
    ds_read_b64_tr_b16 a[86:87], v193 offset:45056
    v_mfma_f32_16x16x32_bf16 v[88:91], a[88:91], v[168:171], v[88:91]
    ds_read_b64_tr_b16 a[88:89], v194 offset:40960
    ds_read_b64_tr_b16 a[90:91], v194 offset:45056
    v_mfma_f32_16x16x32_bf16 v[92:95], a[92:95], v[168:171], v[92:95]
    ds_read_b64_tr_b16 a[92:93], v195 offset:40960
    ds_read_b64_tr_b16 a[94:95], v195 offset:45056
    v_mfma_f32_16x16x32_bf16 v[96:99], a[96:99], v[168:171], v[96:99]
    ds_read_b64_tr_b16 a[96:97], v196 offset:40960
    ds_read_b64_tr_b16 a[98:99], v196 offset:45056
    v_mfma_f32_16x16x32_bf16 v[100:103], a[100:103], v[168:171], v[100:103]
    ds_read_b64_tr_b16 a[100:101], v197 offset:40960
    ds_read_b64_tr_b16 a[102:103], v197 offset:45056
    v_mfma_f32_16x16x32_bf16 v[104:107], a[104:107], v[168:171], v[104:107]
    ds_read_b64_tr_b16 a[104:105], v198 offset:40960
    ds_read_b64_tr_b16 a[106:107], v198 offset:45056
    v_mfma_f32_16x16x32_bf16 v[108:111], a[108:111], v[168:171], v[108:111]
    ds_read_b64_tr_b16 a[108:109], v199 offset:40960
    ds_read_b64_tr_b16 a[110:111], v199 offset:45056
    v_mfma_f32_16x16x32_bf16 a[120:123], a[124:127], v[168:171], a[120:123]
    s_waitcnt lgkmcnt(15)
    v_mfma_f32_16x16x32_bf16 v[136:139], a[48:51], a[0:3], v[172:175]
    v_exp_f32 v112, v112
    v_mfma_f32_16x16x32_bf16 v[140:143], a[52:55], a[0:3], v[172:175]
    v_exp_f32 v113, v113
    v_mfma_f32_16x16x32_bf16 v[136:139], a[56:59], a[4:7], v[136:139]
    v_exp_f32 v114, v114
    v_mfma_f32_16x16x32_bf16 v[140:143], a[60:63], a[4:7], v[140:143]
    v_exp_f32 v115, v115
    v_mfma_f32_16x16x32_bf16 v[136:139], a[64:67], a[8:11], v[136:139]
    v_exp_f32 v116, v116
    v_mfma_f32_16x16x32_bf16 v[140:143], a[68:71], a[8:11], v[140:143]
    v_exp_f32 v117, v117
    v_mfma_f32_16x16x32_bf16 v[136:139], a[72:75], a[12:15], v[136:139]
    v_exp_f32 v118, v118
    v_mfma_f32_16x16x32_bf16 v[140:143], a[76:79], a[12:15], v[140:143]
    v_exp_f32 v119, v119
    v_mfma_f32_16x16x32_bf16 v[144:147], a[48:51], a[16:19], v[176:179]
    v_cvt_pk_bf16_f32 v160, v112, v113
    v_cvt_pk_bf16_f32 v161, v114, v115
    v_mfma_f32_16x16x32_bf16 v[148:151], a[52:55], a[16:19], v[176:179]
    v_cvt_pk_bf16_f32 v162, v116, v117
    v_cvt_pk_bf16_f32 v163, v118, v119
    v_mfma_f32_16x16x32_bf16 v[144:147], a[56:59], a[20:23], v[144:147]
    v_exp_f32 v120, v120
    v_mfma_f32_16x16x32_bf16 v[148:151], a[60:63], a[20:23], v[148:151]
    v_exp_f32 v121, v121
    v_mfma_f32_16x16x32_bf16 v[144:147], a[64:67], a[24:27], v[144:147]
    v_exp_f32 v122, v122
    v_mfma_f32_16x16x32_bf16 v[148:151], a[68:71], a[24:27], v[148:151]
    v_exp_f32 v123, v123
    v_mfma_f32_16x16x32_bf16 v[144:147], a[72:75], a[28:31], v[144:147]
    v_exp_f32 v124, v124
    v_mfma_f32_16x16x32_bf16 v[148:151], a[76:79], a[28:31], v[148:151]
    v_exp_f32 v125, v125
    v_mfma_f32_16x16x32_bf16 v[152:155], a[48:51], a[32:35], v[180:183]
    v_exp_f32 v126, v126
    v_mfma_f32_16x16x32_bf16 v[156:159], a[52:55], a[32:35], v[180:183]
    v_exp_f32 v127, v127
    v_mfma_f32_16x16x32_bf16 v[152:155], a[56:59], a[36:39], v[152:155]
    v_cvt_pk_bf16_f32 v164, v120, v121
    v_cvt_pk_bf16_f32 v165, v122, v123
    v_mfma_f32_16x16x32_bf16 v[156:159], a[60:63], a[36:39], v[156:159]
    v_cvt_pk_bf16_f32 v166, v124, v125
    v_cvt_pk_bf16_f32 v167, v126, v127
    v_mfma_f32_16x16x32_bf16 v[152:155], a[64:67], a[40:43], v[152:155]
    v_exp_f32 v128, v128
    v_mfma_f32_16x16x32_bf16 v[156:159], a[68:71], a[40:43], v[156:159]
    v_exp_f32 v129, v129
    v_mfma_f32_16x16x32_bf16 v[152:155], a[72:75], a[44:47], v[152:155]
    v_exp_f32 v130, v130
    v_mfma_f32_16x16x32_bf16 v[156:159], a[76:79], a[44:47], v[156:159]
    v_exp_f32 v131, v131
    s_waitcnt lgkmcnt(0)
    v_mfma_f32_16x16x32_bf16 v[16:19], a[80:83], v[160:163], v[16:19]
    v_exp_f32 v132, v132
    v_mfma_f32_16x16x32_bf16 v[20:23], a[84:87], v[160:163], v[20:23]
    v_exp_f32 v133, v133
    v_mfma_f32_16x16x32_bf16 v[24:27], a[88:91], v[160:163], v[24:27]
    v_exp_f32 v134, v134
    v_mfma_f32_16x16x32_bf16 v[28:31], a[92:95], v[160:163], v[28:31]
    v_exp_f32 v135, v135
    v_mfma_f32_16x16x32_bf16 v[32:35], a[96:99], v[160:163], v[32:35]
    v_cvt_pk_bf16_f32 v168, v128, v129
    v_cvt_pk_bf16_f32 v169, v130, v131
    v_mfma_f32_16x16x32_bf16 v[36:39], a[100:103], v[160:163], v[36:39]
    v_cvt_pk_bf16_f32 v170, v132, v133
    v_cvt_pk_bf16_f32 v171, v134, v135
    v_mfma_f32_16x16x32_bf16 v[40:43], a[104:107], v[160:163], v[40:43]
    v_mfma_f32_16x16x32_bf16 v[44:47], a[108:111], v[160:163], v[44:47]
    v_mfma_f32_16x16x32_bf16 a[112:115], a[124:127], v[160:163], a[112:115]
    s_barrier
    v_mfma_f32_16x16x32_bf16 v[48:51], a[80:83], v[164:167], v[48:51]
    ds_read_b128 a[48:51], v184 offset:49152
    ds_read_b128 a[52:55], v184 offset:53248
    v_mfma_f32_16x16x32_bf16 v[52:55], a[84:87], v[164:167], v[52:55]
    ds_read_b128 a[56:59], v185 offset:49152
    ds_read_b128 a[60:63], v185 offset:53248
    v_mfma_f32_16x16x32_bf16 v[56:59], a[88:91], v[164:167], v[56:59]
    ds_read_b128 a[64:67], v186 offset:49152
    ds_read_b128 a[68:71], v186 offset:53248
    v_mfma_f32_16x16x32_bf16 v[60:63], a[92:95], v[164:167], v[60:63]
    ds_read_b128 a[72:75], v187 offset:49152
    ds_read_b128 a[76:79], v187 offset:53248
    v_mfma_f32_16x16x32_bf16 v[64:67], a[96:99], v[164:167], v[64:67]
    v_mfma_f32_16x16x32_bf16 v[68:71], a[100:103], v[164:167], v[68:71]
    v_mfma_f32_16x16x32_bf16 v[72:75], a[104:107], v[164:167], v[72:75]
    v_mfma_f32_16x16x32_bf16 v[76:79], a[108:111], v[164:167], v[76:79]
    v_mfma_f32_16x16x32_bf16 a[116:119], a[124:127], v[164:167], a[116:119]
    v_mfma_f32_16x16x32_bf16 v[80:83], a[80:83], v[168:171], v[80:83]
    ds_read_b64_tr_b16 a[80:81], v192 offset:57344
    ds_read_b64_tr_b16 a[82:83], v192 offset:61440
    v_mfma_f32_16x16x32_bf16 v[84:87], a[84:87], v[168:171], v[84:87]
    ds_read_b64_tr_b16 a[84:85], v193 offset:57344
    ds_read_b64_tr_b16 a[86:87], v193 offset:61440
    v_mfma_f32_16x16x32_bf16 v[88:91], a[88:91], v[168:171], v[88:91]
    ds_read_b64_tr_b16 a[88:89], v194 offset:57344
    ds_read_b64_tr_b16 a[90:91], v194 offset:61440
    v_mfma_f32_16x16x32_bf16 v[92:95], a[92:95], v[168:171], v[92:95]
    ds_read_b64_tr_b16 a[92:93], v195 offset:57344
    ds_read_b64_tr_b16 a[94:95], v195 offset:61440
    v_mfma_f32_16x16x32_bf16 v[96:99], a[96:99], v[168:171], v[96:99]
    ds_read_b64_tr_b16 a[96:97], v196 offset:57344
    ds_read_b64_tr_b16 a[98:99], v196 offset:61440
    v_mfma_f32_16x16x32_bf16 v[100:103], a[100:103], v[168:171], v[100:103]
    ds_read_b64_tr_b16 a[100:101], v197 offset:57344
    ds_read_b64_tr_b16 a[102:103], v197 offset:61440
    v_mfma_f32_16x16x32_bf16 v[104:107], a[104:107], v[168:171], v[104:107]
    ds_read_b64_tr_b16 a[104:105], v198 offset:57344
    ds_read_b64_tr_b16 a[106:107], v198 offset:61440
    v_mfma_f32_16x16x32_bf16 v[108:111], a[108:111], v[168:171], v[108:111]
    ds_read_b64_tr_b16 a[108:109], v199 offset:57344
    ds_read_b64_tr_b16 a[110:111], v199 offset:61440
    v_mfma_f32_16x16x32_bf16 a[120:123], a[124:127], v[168:171], a[120:123]
    s_waitcnt lgkmcnt(15)
    v_mfma_f32_16x16x32_bf16 v[112:115], a[48:51], a[0:3], v[172:175]
    v_exp_f32 v136, v136
    v_mfma_f32_16x16x32_bf16 v[116:119], a[52:55], a[0:3], v[172:175]
    v_exp_f32 v137, v137
    v_mfma_f32_16x16x32_bf16 v[112:115], a[56:59], a[4:7], v[112:115]
    v_exp_f32 v138, v138
    v_mfma_f32_16x16x32_bf16 v[116:119], a[60:63], a[4:7], v[116:119]
    v_exp_f32 v139, v139
    v_mfma_f32_16x16x32_bf16 v[112:115], a[64:67], a[8:11], v[112:115]
    v_exp_f32 v140, v140
    v_mfma_f32_16x16x32_bf16 v[116:119], a[68:71], a[8:11], v[116:119]
    v_exp_f32 v141, v141
    v_mfma_f32_16x16x32_bf16 v[112:115], a[72:75], a[12:15], v[112:115]
    v_exp_f32 v142, v142
    v_mfma_f32_16x16x32_bf16 v[116:119], a[76:79], a[12:15], v[116:119]
    v_exp_f32 v143, v143
    v_mfma_f32_16x16x32_bf16 v[120:123], a[48:51], a[16:19], v[176:179]
    v_cvt_pk_bf16_f32 v160, v136, v137
    v_cvt_pk_bf16_f32 v161, v138, v139
    v_mfma_f32_16x16x32_bf16 v[124:127], a[52:55], a[16:19], v[176:179]
    v_cvt_pk_bf16_f32 v162, v140, v141
    v_cvt_pk_bf16_f32 v163, v142, v143
    v_mfma_f32_16x16x32_bf16 v[120:123], a[56:59], a[20:23], v[120:123]
    v_exp_f32 v144, v144
    v_mfma_f32_16x16x32_bf16 v[124:127], a[60:63], a[20:23], v[124:127]
    v_exp_f32 v145, v145
    v_mfma_f32_16x16x32_bf16 v[120:123], a[64:67], a[24:27], v[120:123]
    v_exp_f32 v146, v146
    v_mfma_f32_16x16x32_bf16 v[124:127], a[68:71], a[24:27], v[124:127]
    v_exp_f32 v147, v147
    v_mfma_f32_16x16x32_bf16 v[120:123], a[72:75], a[28:31], v[120:123]
    v_exp_f32 v148, v148
    v_mfma_f32_16x16x32_bf16 v[124:127], a[76:79], a[28:31], v[124:127]
    v_exp_f32 v149, v149
    v_mfma_f32_16x16x32_bf16 v[128:131], a[48:51], a[32:35], v[180:183]
    v_exp_f32 v150, v150
    v_mfma_f32_16x16x32_bf16 v[132:135], a[52:55], a[32:35], v[180:183]
    v_exp_f32 v151, v151
    v_mfma_f32_16x16x32_bf16 v[128:131], a[56:59], a[36:39], v[128:131]
    v_cvt_pk_bf16_f32 v164, v144, v145
    v_cvt_pk_bf16_f32 v165, v146, v147
    v_mfma_f32_16x16x32_bf16 v[132:135], a[60:63], a[36:39], v[132:135]
    v_cvt_pk_bf16_f32 v166, v148, v149
    v_cvt_pk_bf16_f32 v167, v150, v151
    v_mfma_f32_16x16x32_bf16 v[128:131], a[64:67], a[40:43], v[128:131]
    v_exp_f32 v152, v152
    v_mfma_f32_16x16x32_bf16 v[132:135], a[68:71], a[40:43], v[132:135]
    v_exp_f32 v153, v153
    v_mfma_f32_16x16x32_bf16 v[128:131], a[72:75], a[44:47], v[128:131]
    v_exp_f32 v154, v154
    v_mfma_f32_16x16x32_bf16 v[132:135], a[76:79], a[44:47], v[132:135]
    v_exp_f32 v155, v155
    s_waitcnt lgkmcnt(0)
    v_mfma_f32_16x16x32_bf16 v[16:19], a[80:83], v[160:163], v[16:19]
    v_exp_f32 v156, v156
    v_mfma_f32_16x16x32_bf16 v[20:23], a[84:87], v[160:163], v[20:23]
    v_exp_f32 v157, v157
    v_mfma_f32_16x16x32_bf16 v[24:27], a[88:91], v[160:163], v[24:27]
    v_exp_f32 v158, v158
    v_mfma_f32_16x16x32_bf16 v[28:31], a[92:95], v[160:163], v[28:31]
    v_exp_f32 v159, v159
    v_mfma_f32_16x16x32_bf16 v[32:35], a[96:99], v[160:163], v[32:35]
    v_cvt_pk_bf16_f32 v168, v152, v153
    v_cvt_pk_bf16_f32 v169, v154, v155
    v_mfma_f32_16x16x32_bf16 v[36:39], a[100:103], v[160:163], v[36:39]
    v_cvt_pk_bf16_f32 v170, v156, v157
    v_cvt_pk_bf16_f32 v171, v158, v159
    v_mfma_f32_16x16x32_bf16 v[40:43], a[104:107], v[160:163], v[40:43]
    v_mfma_f32_16x16x32_bf16 v[44:47], a[108:111], v[160:163], v[44:47]
    v_mfma_f32_16x16x32_bf16 a[112:115], a[124:127], v[160:163], a[112:115]
    s_barrier
    v_mfma_f32_16x16x32_bf16 v[48:51], a[80:83], v[164:167], v[48:51]
    ds_read_b128 a[48:51], v188 offset:0
    ds_read_b128 a[52:55], v188 offset:4096
    v_mfma_f32_16x16x32_bf16 v[52:55], a[84:87], v[164:167], v[52:55]
    ds_read_b128 a[56:59], v189 offset:0
    ds_read_b128 a[60:63], v189 offset:4096
    v_mfma_f32_16x16x32_bf16 v[56:59], a[88:91], v[164:167], v[56:59]
    ds_read_b128 a[64:67], v190 offset:0
    ds_read_b128 a[68:71], v190 offset:4096
    v_mfma_f32_16x16x32_bf16 v[60:63], a[92:95], v[164:167], v[60:63]
    ds_read_b128 a[72:75], v191 offset:0
    ds_read_b128 a[76:79], v191 offset:4096
    v_mfma_f32_16x16x32_bf16 v[64:67], a[96:99], v[164:167], v[64:67]
    v_mfma_f32_16x16x32_bf16 v[68:71], a[100:103], v[164:167], v[68:71]
    v_mfma_f32_16x16x32_bf16 v[72:75], a[104:107], v[164:167], v[72:75]
    v_mfma_f32_16x16x32_bf16 v[76:79], a[108:111], v[164:167], v[76:79]
    v_mfma_f32_16x16x32_bf16 a[116:119], a[124:127], v[164:167], a[116:119]
    v_mfma_f32_16x16x32_bf16 v[80:83], a[80:83], v[168:171], v[80:83]
    ds_read_b64_tr_b16 a[80:81], v200 offset:8192
    ds_read_b64_tr_b16 a[82:83], v200 offset:12288
    v_mfma_f32_16x16x32_bf16 v[84:87], a[84:87], v[168:171], v[84:87]
    ds_read_b64_tr_b16 a[84:85], v201 offset:8192
    ds_read_b64_tr_b16 a[86:87], v201 offset:12288
    v_mfma_f32_16x16x32_bf16 v[88:91], a[88:91], v[168:171], v[88:91]
    ds_read_b64_tr_b16 a[88:89], v202 offset:8192
    ds_read_b64_tr_b16 a[90:91], v202 offset:12288
    v_mfma_f32_16x16x32_bf16 v[92:95], a[92:95], v[168:171], v[92:95]
    ds_read_b64_tr_b16 a[92:93], v203 offset:8192
    ds_read_b64_tr_b16 a[94:95], v203 offset:12288
    v_mfma_f32_16x16x32_bf16 v[96:99], a[96:99], v[168:171], v[96:99]
    ds_read_b64_tr_b16 a[96:97], v204 offset:8192
    ds_read_b64_tr_b16 a[98:99], v204 offset:12288
    v_mfma_f32_16x16x32_bf16 v[100:103], a[100:103], v[168:171], v[100:103]
    ds_read_b64_tr_b16 a[100:101], v205 offset:8192
    ds_read_b64_tr_b16 a[102:103], v205 offset:12288
    v_mfma_f32_16x16x32_bf16 v[104:107], a[104:107], v[168:171], v[104:107]
    ds_read_b64_tr_b16 a[104:105], v206 offset:8192
    ds_read_b64_tr_b16 a[106:107], v206 offset:12288
    v_mfma_f32_16x16x32_bf16 v[108:111], a[108:111], v[168:171], v[108:111]
    ds_read_b64_tr_b16 a[108:109], v207 offset:8192
    ds_read_b64_tr_b16 a[110:111], v207 offset:12288
    v_mfma_f32_16x16x32_bf16 a[120:123], a[124:127], v[168:171], a[120:123]
    s_waitcnt lgkmcnt(15)
    v_mfma_f32_16x16x32_bf16 v[136:139], a[48:51], a[0:3], v[172:175]
    v_exp_f32 v112, v112
    v_mfma_f32_16x16x32_bf16 v[140:143], a[52:55], a[0:3], v[172:175]
    v_exp_f32 v113, v113
    v_mfma_f32_16x16x32_bf16 v[136:139], a[56:59], a[4:7], v[136:139]
    v_exp_f32 v114, v114
    v_mfma_f32_16x16x32_bf16 v[140:143], a[60:63], a[4:7], v[140:143]
    v_exp_f32 v115, v115
    v_mfma_f32_16x16x32_bf16 v[136:139], a[64:67], a[8:11], v[136:139]
    v_exp_f32 v116, v116
    v_mfma_f32_16x16x32_bf16 v[140:143], a[68:71], a[8:11], v[140:143]
    v_exp_f32 v117, v117
    v_mfma_f32_16x16x32_bf16 v[136:139], a[72:75], a[12:15], v[136:139]
    v_exp_f32 v118, v118
    v_mfma_f32_16x16x32_bf16 v[140:143], a[76:79], a[12:15], v[140:143]
    v_exp_f32 v119, v119
    v_mfma_f32_16x16x32_bf16 v[144:147], a[48:51], a[16:19], v[176:179]
    v_cvt_pk_bf16_f32 v160, v112, v113
    v_cvt_pk_bf16_f32 v161, v114, v115
    v_mfma_f32_16x16x32_bf16 v[148:151], a[52:55], a[16:19], v[176:179]
    v_cvt_pk_bf16_f32 v162, v116, v117
    v_cvt_pk_bf16_f32 v163, v118, v119
    v_mfma_f32_16x16x32_bf16 v[144:147], a[56:59], a[20:23], v[144:147]
    v_exp_f32 v120, v120
    v_mfma_f32_16x16x32_bf16 v[148:151], a[60:63], a[20:23], v[148:151]
    v_exp_f32 v121, v121
    v_mfma_f32_16x16x32_bf16 v[144:147], a[64:67], a[24:27], v[144:147]
    v_exp_f32 v122, v122
    v_mfma_f32_16x16x32_bf16 v[148:151], a[68:71], a[24:27], v[148:151]
    v_exp_f32 v123, v123
    v_mfma_f32_16x16x32_bf16 v[144:147], a[72:75], a[28:31], v[144:147]
    v_exp_f32 v124, v124
    v_mfma_f32_16x16x32_bf16 v[148:151], a[76:79], a[28:31], v[148:151]
    v_exp_f32 v125, v125
    v_mfma_f32_16x16x32_bf16 v[152:155], a[48:51], a[32:35], v[180:183]
    v_exp_f32 v126, v126
    v_mfma_f32_16x16x32_bf16 v[156:159], a[52:55], a[32:35], v[180:183]
    v_exp_f32 v127, v127
    v_mfma_f32_16x16x32_bf16 v[152:155], a[56:59], a[36:39], v[152:155]
    v_cvt_pk_bf16_f32 v164, v120, v121
    v_cvt_pk_bf16_f32 v165, v122, v123
    v_mfma_f32_16x16x32_bf16 v[156:159], a[60:63], a[36:39], v[156:159]
    v_cvt_pk_bf16_f32 v166, v124, v125
    v_cvt_pk_bf16_f32 v167, v126, v127
    v_mfma_f32_16x16x32_bf16 v[152:155], a[64:67], a[40:43], v[152:155]
    v_exp_f32 v128, v128
    v_mfma_f32_16x16x32_bf16 v[156:159], a[68:71], a[40:43], v[156:159]
    v_exp_f32 v129, v129
    v_mfma_f32_16x16x32_bf16 v[152:155], a[72:75], a[44:47], v[152:155]
    v_exp_f32 v130, v130
    v_mfma_f32_16x16x32_bf16 v[156:159], a[76:79], a[44:47], v[156:159]
    v_exp_f32 v131, v131
    s_waitcnt lgkmcnt(0)
    v_mfma_f32_16x16x32_bf16 v[16:19], a[80:83], v[160:163], v[16:19]
    v_exp_f32 v132, v132
    v_mfma_f32_16x16x32_bf16 v[20:23], a[84:87], v[160:163], v[20:23]
    v_exp_f32 v133, v133
    v_mfma_f32_16x16x32_bf16 v[24:27], a[88:91], v[160:163], v[24:27]
    v_exp_f32 v134, v134
    v_mfma_f32_16x16x32_bf16 v[28:31], a[92:95], v[160:163], v[28:31]
    v_exp_f32 v135, v135
    v_mfma_f32_16x16x32_bf16 v[32:35], a[96:99], v[160:163], v[32:35]
    v_cvt_pk_bf16_f32 v168, v128, v129
    v_cvt_pk_bf16_f32 v169, v130, v131
    v_mfma_f32_16x16x32_bf16 v[36:39], a[100:103], v[160:163], v[36:39]
    v_cvt_pk_bf16_f32 v170, v132, v133
    v_cvt_pk_bf16_f32 v171, v134, v135
    v_mfma_f32_16x16x32_bf16 v[40:43], a[104:107], v[160:163], v[40:43]
    v_mfma_f32_16x16x32_bf16 v[44:47], a[108:111], v[160:163], v[44:47]
    v_mfma_f32_16x16x32_bf16 a[112:115], a[124:127], v[160:163], a[112:115]
    s_barrier
    v_mfma_f32_16x16x32_bf16 v[48:51], a[80:83], v[164:167], v[48:51]
    ds_read_b128 a[48:51], v188 offset:16384
    ds_read_b128 a[52:55], v188 offset:20480
    v_mfma_f32_16x16x32_bf16 v[52:55], a[84:87], v[164:167], v[52:55]
    ds_read_b128 a[56:59], v189 offset:16384
    ds_read_b128 a[60:63], v189 offset:20480
    v_mfma_f32_16x16x32_bf16 v[56:59], a[88:91], v[164:167], v[56:59]
    ds_read_b128 a[64:67], v190 offset:16384
    ds_read_b128 a[68:71], v190 offset:20480
    v_mfma_f32_16x16x32_bf16 v[60:63], a[92:95], v[164:167], v[60:63]
    ds_read_b128 a[72:75], v191 offset:16384
    ds_read_b128 a[76:79], v191 offset:20480
    v_mfma_f32_16x16x32_bf16 v[64:67], a[96:99], v[164:167], v[64:67]
    v_mfma_f32_16x16x32_bf16 v[68:71], a[100:103], v[164:167], v[68:71]
    v_mfma_f32_16x16x32_bf16 v[72:75], a[104:107], v[164:167], v[72:75]
    v_mfma_f32_16x16x32_bf16 v[76:79], a[108:111], v[164:167], v[76:79]
    v_mfma_f32_16x16x32_bf16 a[116:119], a[124:127], v[164:167], a[116:119]
    v_mfma_f32_16x16x32_bf16 v[80:83], a[80:83], v[168:171], v[80:83]
    ds_read_b64_tr_b16 a[80:81], v200 offset:24576
    ds_read_b64_tr_b16 a[82:83], v200 offset:28672
    v_mfma_f32_16x16x32_bf16 v[84:87], a[84:87], v[168:171], v[84:87]
    ds_read_b64_tr_b16 a[84:85], v201 offset:24576
    ds_read_b64_tr_b16 a[86:87], v201 offset:28672
    v_mfma_f32_16x16x32_bf16 v[88:91], a[88:91], v[168:171], v[88:91]
    ds_read_b64_tr_b16 a[88:89], v202 offset:24576
    ds_read_b64_tr_b16 a[90:91], v202 offset:28672
    v_mfma_f32_16x16x32_bf16 v[92:95], a[92:95], v[168:171], v[92:95]
    ds_read_b64_tr_b16 a[92:93], v203 offset:24576
    ds_read_b64_tr_b16 a[94:95], v203 offset:28672
    v_mfma_f32_16x16x32_bf16 v[96:99], a[96:99], v[168:171], v[96:99]
    ds_read_b64_tr_b16 a[96:97], v204 offset:24576
    ds_read_b64_tr_b16 a[98:99], v204 offset:28672
    v_mfma_f32_16x16x32_bf16 v[100:103], a[100:103], v[168:171], v[100:103]
    ds_read_b64_tr_b16 a[100:101], v205 offset:24576
    ds_read_b64_tr_b16 a[102:103], v205 offset:28672
    v_mfma_f32_16x16x32_bf16 v[104:107], a[104:107], v[168:171], v[104:107]
    ds_read_b64_tr_b16 a[104:105], v206 offset:24576
    ds_read_b64_tr_b16 a[106:107], v206 offset:28672
    v_mfma_f32_16x16x32_bf16 v[108:111], a[108:111], v[168:171], v[108:111]
    ds_read_b64_tr_b16 a[108:109], v207 offset:24576
    ds_read_b64_tr_b16 a[110:111], v207 offset:28672
    v_mfma_f32_16x16x32_bf16 a[120:123], a[124:127], v[168:171], a[120:123]
    s_waitcnt lgkmcnt(15)
    v_mfma_f32_16x16x32_bf16 v[112:115], a[48:51], a[0:3], v[172:175]
    v_exp_f32 v136, v136
    v_mfma_f32_16x16x32_bf16 v[116:119], a[52:55], a[0:3], v[172:175]
    v_exp_f32 v137, v137
    v_mfma_f32_16x16x32_bf16 v[112:115], a[56:59], a[4:7], v[112:115]
    v_exp_f32 v138, v138
    v_mfma_f32_16x16x32_bf16 v[116:119], a[60:63], a[4:7], v[116:119]
    v_exp_f32 v139, v139
    v_mfma_f32_16x16x32_bf16 v[112:115], a[64:67], a[8:11], v[112:115]
    v_exp_f32 v140, v140
    v_mfma_f32_16x16x32_bf16 v[116:119], a[68:71], a[8:11], v[116:119]
    v_exp_f32 v141, v141
    v_mfma_f32_16x16x32_bf16 v[112:115], a[72:75], a[12:15], v[112:115]
    v_exp_f32 v142, v142
    v_mfma_f32_16x16x32_bf16 v[116:119], a[76:79], a[12:15], v[116:119]
    v_exp_f32 v143, v143
    v_mfma_f32_16x16x32_bf16 v[120:123], a[48:51], a[16:19], v[176:179]
    v_cvt_pk_bf16_f32 v160, v136, v137
    v_cvt_pk_bf16_f32 v161, v138, v139
    v_mfma_f32_16x16x32_bf16 v[124:127], a[52:55], a[16:19], v[176:179]
    v_cvt_pk_bf16_f32 v162, v140, v141
    v_cvt_pk_bf16_f32 v163, v142, v143
    v_mfma_f32_16x16x32_bf16 v[120:123], a[56:59], a[20:23], v[120:123]
    v_exp_f32 v144, v144
    v_mfma_f32_16x16x32_bf16 v[124:127], a[60:63], a[20:23], v[124:127]
    v_exp_f32 v145, v145
    v_mfma_f32_16x16x32_bf16 v[120:123], a[64:67], a[24:27], v[120:123]
    v_exp_f32 v146, v146
    v_mfma_f32_16x16x32_bf16 v[124:127], a[68:71], a[24:27], v[124:127]
    v_exp_f32 v147, v147
    v_mfma_f32_16x16x32_bf16 v[120:123], a[72:75], a[28:31], v[120:123]
    v_exp_f32 v148, v148
    v_mfma_f32_16x16x32_bf16 v[124:127], a[76:79], a[28:31], v[124:127]
    v_exp_f32 v149, v149
    v_mfma_f32_16x16x32_bf16 v[128:131], a[48:51], a[32:35], v[180:183]
    v_exp_f32 v150, v150
    v_mfma_f32_16x16x32_bf16 v[132:135], a[52:55], a[32:35], v[180:183]
    v_exp_f32 v151, v151
    v_mfma_f32_16x16x32_bf16 v[128:131], a[56:59], a[36:39], v[128:131]
    v_cvt_pk_bf16_f32 v164, v144, v145
    v_cvt_pk_bf16_f32 v165, v146, v147
    v_mfma_f32_16x16x32_bf16 v[132:135], a[60:63], a[36:39], v[132:135]
    v_cvt_pk_bf16_f32 v166, v148, v149
    v_cvt_pk_bf16_f32 v167, v150, v151
    v_mfma_f32_16x16x32_bf16 v[128:131], a[64:67], a[40:43], v[128:131]
    v_exp_f32 v152, v152
    v_mfma_f32_16x16x32_bf16 v[132:135], a[68:71], a[40:43], v[132:135]
    v_exp_f32 v153, v153
    v_mfma_f32_16x16x32_bf16 v[128:131], a[72:75], a[44:47], v[128:131]
    v_exp_f32 v154, v154
    v_mfma_f32_16x16x32_bf16 v[132:135], a[76:79], a[44:47], v[132:135]
    v_exp_f32 v155, v155
    s_waitcnt lgkmcnt(0)
    v_mfma_f32_16x16x32_bf16 v[16:19], a[80:83], v[160:163], v[16:19]
    v_exp_f32 v156, v156
    v_mfma_f32_16x16x32_bf16 v[20:23], a[84:87], v[160:163], v[20:23]
    v_exp_f32 v157, v157
    v_mfma_f32_16x16x32_bf16 v[24:27], a[88:91], v[160:163], v[24:27]
    v_exp_f32 v158, v158
    v_mfma_f32_16x16x32_bf16 v[28:31], a[92:95], v[160:163], v[28:31]
    v_exp_f32 v159, v159
    v_mfma_f32_16x16x32_bf16 v[32:35], a[96:99], v[160:163], v[32:35]
    v_cvt_pk_bf16_f32 v168, v152, v153
    v_cvt_pk_bf16_f32 v169, v154, v155
    v_mfma_f32_16x16x32_bf16 v[36:39], a[100:103], v[160:163], v[36:39]
    v_cvt_pk_bf16_f32 v170, v156, v157
    v_cvt_pk_bf16_f32 v171, v158, v159
    v_mfma_f32_16x16x32_bf16 v[40:43], a[104:107], v[160:163], v[40:43]
    v_mfma_f32_16x16x32_bf16 v[44:47], a[108:111], v[160:163], v[44:47]
    v_mfma_f32_16x16x32_bf16 a[112:115], a[124:127], v[160:163], a[112:115]
    s_barrier
    v_mfma_f32_16x16x32_bf16 v[48:51], a[80:83], v[164:167], v[48:51]
    ds_read_b128 a[48:51], v188 offset:32768
    ds_read_b128 a[52:55], v188 offset:36864
    v_mfma_f32_16x16x32_bf16 v[52:55], a[84:87], v[164:167], v[52:55]
    ds_read_b128 a[56:59], v189 offset:32768
    ds_read_b128 a[60:63], v189 offset:36864
    v_mfma_f32_16x16x32_bf16 v[56:59], a[88:91], v[164:167], v[56:59]
    ds_read_b128 a[64:67], v190 offset:32768
    ds_read_b128 a[68:71], v190 offset:36864
    v_mfma_f32_16x16x32_bf16 v[60:63], a[92:95], v[164:167], v[60:63]
    ds_read_b128 a[72:75], v191 offset:32768
    ds_read_b128 a[76:79], v191 offset:36864
    v_mfma_f32_16x16x32_bf16 v[64:67], a[96:99], v[164:167], v[64:67]
    v_mfma_f32_16x16x32_bf16 v[68:71], a[100:103], v[164:167], v[68:71]
    v_mfma_f32_16x16x32_bf16 v[72:75], a[104:107], v[164:167], v[72:75]
    v_mfma_f32_16x16x32_bf16 v[76:79], a[108:111], v[164:167], v[76:79]
    v_mfma_f32_16x16x32_bf16 a[116:119], a[124:127], v[164:167], a[116:119]
    v_mfma_f32_16x16x32_bf16 v[80:83], a[80:83], v[168:171], v[80:83]
    ds_read_b64_tr_b16 a[80:81], v200 offset:40960
    ds_read_b64_tr_b16 a[82:83], v200 offset:45056
    v_mfma_f32_16x16x32_bf16 v[84:87], a[84:87], v[168:171], v[84:87]
    ds_read_b64_tr_b16 a[84:85], v201 offset:40960
    ds_read_b64_tr_b16 a[86:87], v201 offset:45056
    v_mfma_f32_16x16x32_bf16 v[88:91], a[88:91], v[168:171], v[88:91]
    ds_read_b64_tr_b16 a[88:89], v202 offset:40960
    ds_read_b64_tr_b16 a[90:91], v202 offset:45056
    v_mfma_f32_16x16x32_bf16 v[92:95], a[92:95], v[168:171], v[92:95]
    ds_read_b64_tr_b16 a[92:93], v203 offset:40960
    ds_read_b64_tr_b16 a[94:95], v203 offset:45056
    v_mfma_f32_16x16x32_bf16 v[96:99], a[96:99], v[168:171], v[96:99]
    ds_read_b64_tr_b16 a[96:97], v204 offset:40960
    ds_read_b64_tr_b16 a[98:99], v204 offset:45056
    v_mfma_f32_16x16x32_bf16 v[100:103], a[100:103], v[168:171], v[100:103]
    ds_read_b64_tr_b16 a[100:101], v205 offset:40960
    ds_read_b64_tr_b16 a[102:103], v205 offset:45056
    v_mfma_f32_16x16x32_bf16 v[104:107], a[104:107], v[168:171], v[104:107]
    ds_read_b64_tr_b16 a[104:105], v206 offset:40960
    ds_read_b64_tr_b16 a[106:107], v206 offset:45056
    v_mfma_f32_16x16x32_bf16 v[108:111], a[108:111], v[168:171], v[108:111]
    ds_read_b64_tr_b16 a[108:109], v207 offset:40960
    ds_read_b64_tr_b16 a[110:111], v207 offset:45056
    v_mfma_f32_16x16x32_bf16 a[120:123], a[124:127], v[168:171], a[120:123]
    s_add_u32 s44, s44, 1
    s_cmp_lt_u32 s44, 7
    s_cbranch_scc1 L_loop
    s_waitcnt vmcnt(0)
    v_or_b32 v14, v240, v241
    v_cmp_ne_u32 vcc, 0, v14
    s_nop 1
    s_cmp_eq_u64 vcc, -1
    s_cbranch_scc1 L_non_ok
    s_mov_b32 s91, 0
L_non:
    global_load_dwordx2 v[240:241], v248, s[16:17] sc1
    s_waitcnt vmcnt(0)
    v_or_b32 v14, v240, v241
    v_cmp_ne_u32 vcc, 0, v14
    s_nop 1
    s_cmp_eq_u64 vcc, -1
    s_cbranch_scc1 L_non_ok
    s_add_u32 s91, s91, 1
    s_cmp_gt_u32 s91, 200000
    s_cbranch_scc0 L_non
L_non_ok:
    v_readfirstlane_b32 s86, v240
    v_readfirstlane_b32 s87, v241
    s_waitcnt lgkmcnt(15)
    v_mfma_f32_16x16x32_bf16 v[136:139], a[48:51], a[0:3], v[172:175]
    v_exp_f32 v112, v112
    v_mfma_f32_16x16x32_bf16 v[140:143], a[52:55], a[0:3], v[172:175]
    v_exp_f32 v113, v113
    v_mfma_f32_16x16x32_bf16 v[136:139], a[56:59], a[4:7], v[136:139]
    v_exp_f32 v114, v114
    v_mfma_f32_16x16x32_bf16 v[140:143], a[60:63], a[4:7], v[140:143]
    v_exp_f32 v115, v115
    v_mfma_f32_16x16x32_bf16 v[136:139], a[64:67], a[8:11], v[136:139]
    v_exp_f32 v116, v116
    v_mfma_f32_16x16x32_bf16 v[140:143], a[68:71], a[8:11], v[140:143]
    v_exp_f32 v117, v117
    v_mfma_f32_16x16x32_bf16 v[136:139], a[72:75], a[12:15], v[136:139]
    v_exp_f32 v118, v118
    v_mfma_f32_16x16x32_bf16 v[140:143], a[76:79], a[12:15], v[140:143]
    v_exp_f32 v119, v119
    v_mfma_f32_16x16x32_bf16 v[144:147], a[48:51], a[16:19], v[176:179]
    v_cvt_pk_bf16_f32 v160, v112, v113
    v_cvt_pk_bf16_f32 v161, v114, v115
    v_mfma_f32_16x16x32_bf16 v[148:151], a[52:55], a[16:19], v[176:179]
    v_cvt_pk_bf16_f32 v162, v116, v117
    v_cvt_pk_bf16_f32 v163, v118, v119
    v_mfma_f32_16x16x32_bf16 v[144:147], a[56:59], a[20:23], v[144:147]
    v_exp_f32 v120, v120
    v_mfma_f32_16x16x32_bf16 v[148:151], a[60:63], a[20:23], v[148:151]
    v_exp_f32 v121, v121
    v_mfma_f32_16x16x32_bf16 v[144:147], a[64:67], a[24:27], v[144:147]
    v_exp_f32 v122, v122
    v_mfma_f32_16x16x32_bf16 v[148:151], a[68:71], a[24:27], v[148:151]
    v_exp_f32 v123, v123
    v_mfma_f32_16x16x32_bf16 v[144:147], a[72:75], a[28:31], v[144:147]
    v_exp_f32 v124, v124
    v_mfma_f32_16x16x32_bf16 v[148:151], a[76:79], a[28:31], v[148:151]
    v_exp_f32 v125, v125
    v_mfma_f32_16x16x32_bf16 v[152:155], a[48:51], a[32:35], v[180:183]
    v_exp_f32 v126, v126
    v_mfma_f32_16x16x32_bf16 v[156:159], a[52:55], a[32:35], v[180:183]
    v_exp_f32 v127, v127
    v_mfma_f32_16x16x32_bf16 v[152:155], a[56:59], a[36:39], v[152:155]
    v_cvt_pk_bf16_f32 v164, v120, v121
    v_cvt_pk_bf16_f32 v165, v122, v123
    v_mfma_f32_16x16x32_bf16 v[156:159], a[60:63], a[36:39], v[156:159]
    v_cvt_pk_bf16_f32 v166, v124, v125
    v_cvt_pk_bf16_f32 v167, v126, v127
    v_mfma_f32_16x16x32_bf16 v[152:155], a[64:67], a[40:43], v[152:155]
    v_exp_f32 v128, v128
    v_mfma_f32_16x16x32_bf16 v[156:159], a[68:71], a[40:43], v[156:159]
    v_exp_f32 v129, v129
    v_mfma_f32_16x16x32_bf16 v[152:155], a[72:75], a[44:47], v[152:155]
    v_exp_f32 v130, v130
    v_mfma_f32_16x16x32_bf16 v[156:159], a[76:79], a[44:47], v[156:159]
    v_exp_f32 v131, v131
    s_waitcnt lgkmcnt(0)
    v_mfma_f32_16x16x32_bf16 v[16:19], a[80:83], v[160:163], v[16:19]
    v_exp_f32 v132, v132
    v_mfma_f32_16x16x32_bf16 v[20:23], a[84:87], v[160:163], v[20:23]
    v_exp_f32 v133, v133
    v_mfma_f32_16x16x32_bf16 v[24:27], a[88:91], v[160:163], v[24:27]
    v_exp_f32 v134, v134
    v_mfma_f32_16x16x32_bf16 v[28:31], a[92:95], v[160:163], v[28:31]
    v_exp_f32 v135, v135
    v_mfma_f32_16x16x32_bf16 v[32:35], a[96:99], v[160:163], v[32:35]
    v_cvt_pk_bf16_f32 v168, v128, v129
    v_cvt_pk_bf16_f32 v169, v130, v131
    v_mfma_f32_16x16x32_bf16 v[36:39], a[100:103], v[160:163], v[36:39]
    v_cvt_pk_bf16_f32 v170, v132, v133
    v_cvt_pk_bf16_f32 v171, v134, v135
    v_mfma_f32_16x16x32_bf16 v[40:43], a[104:107], v[160:163], v[40:43]
    v_mfma_f32_16x16x32_bf16 v[44:47], a[108:111], v[160:163], v[44:47]
    v_mfma_f32_16x16x32_bf16 a[112:115], a[124:127], v[160:163], a[112:115]
    s_barrier
    v_mfma_f32_16x16x32_bf16 v[48:51], a[80:83], v[164:167], v[48:51]
    v_mfma_f32_16x16x32_bf16 v[52:55], a[84:87], v[164:167], v[52:55]
    v_mfma_f32_16x16x32_bf16 v[56:59], a[88:91], v[164:167], v[56:59]
    v_mfma_f32_16x16x32_bf16 v[60:63], a[92:95], v[164:167], v[60:63]
    v_mfma_f32_16x16x32_bf16 v[64:67], a[96:99], v[164:167], v[64:67]
    v_mfma_f32_16x16x32_bf16 v[68:71], a[100:103], v[164:167], v[68:71]
    v_mfma_f32_16x16x32_bf16 v[72:75], a[104:107], v[164:167], v[72:75]
    v_mfma_f32_16x16x32_bf16 v[76:79], a[108:111], v[164:167], v[76:79]
    v_mfma_f32_16x16x32_bf16 a[116:119], a[124:127], v[164:167], a[116:119]
    v_mfma_f32_16x16x32_bf16 v[80:83], a[80:83], v[168:171], v[80:83]
    ds_read_b64_tr_b16 a[80:81], v200 offset:57344
    ds_read_b64_tr_b16 a[82:83], v200 offset:61440
    v_mfma_f32_16x16x32_bf16 v[84:87], a[84:87], v[168:171], v[84:87]
    ds_read_b64_tr_b16 a[84:85], v201 offset:57344
    ds_read_b64_tr_b16 a[86:87], v201 offset:61440
    v_mfma_f32_16x16x32_bf16 v[88:91], a[88:91], v[168:171], v[88:91]
    ds_read_b64_tr_b16 a[88:89], v202 offset:57344
    ds_read_b64_tr_b16 a[90:91], v202 offset:61440
    v_mfma_f32_16x16x32_bf16 v[92:95], a[92:95], v[168:171], v[92:95]
    ds_read_b64_tr_b16 a[92:93], v203 offset:57344
    ds_read_b64_tr_b16 a[94:95], v203 offset:61440
    v_mfma_f32_16x16x32_bf16 v[96:99], a[96:99], v[168:171], v[96:99]
    ds_read_b64_tr_b16 a[96:97], v204 offset:57344
    ds_read_b64_tr_b16 a[98:99], v204 offset:61440
    v_mfma_f32_16x16x32_bf16 v[100:103], a[100:103], v[168:171], v[100:103]
    ds_read_b64_tr_b16 a[100:101], v205 offset:57344
    ds_read_b64_tr_b16 a[102:103], v205 offset:61440
    v_mfma_f32_16x16x32_bf16 v[104:107], a[104:107], v[168:171], v[104:107]
    ds_read_b64_tr_b16 a[104:105], v206 offset:57344
    ds_read_b64_tr_b16 a[106:107], v206 offset:61440
    v_mfma_f32_16x16x32_bf16 v[108:111], a[108:111], v[168:171], v[108:111]
    ds_read_b64_tr_b16 a[108:109], v207 offset:57344
    ds_read_b64_tr_b16 a[110:111], v207 offset:61440
    v_mfma_f32_16x16x32_bf16 a[120:123], a[124:127], v[168:171], a[120:123]
    global_load_dwordx2 v[242:243], v247, s[88:89] sc1
    v_exp_f32 v136, v136
    v_exp_f32 v137, v137
    v_exp_f32 v138, v138
    v_exp_f32 v139, v139
    v_exp_f32 v140, v140
    v_exp_f32 v141, v141
    v_exp_f32 v142, v142
    v_exp_f32 v143, v143
    v_cvt_pk_bf16_f32 v160, v136, v137
    v_cvt_pk_bf16_f32 v161, v138, v139
    v_cvt_pk_bf16_f32 v162, v140, v141
    v_cvt_pk_bf16_f32 v163, v142, v143
    s_waitcnt lgkmcnt(0)
    s_nop 0
    v_mfma_f32_16x16x32_bf16 v[16:19], a[80:83], v[160:163], v[16:19]
    v_exp_f32 v144, v144
    v_mfma_f32_16x16x32_bf16 v[20:23], a[84:87], v[160:163], v[20:23]
    v_exp_f32 v145, v145
    v_mfma_f32_16x16x32_bf16 v[24:27], a[88:91], v[160:163], v[24:27]
    v_exp_f32 v146, v146
    v_mfma_f32_16x16x32_bf16 v[28:31], a[92:95], v[160:163], v[28:31]
    v_exp_f32 v147, v147
    v_mfma_f32_16x16x32_bf16 v[32:35], a[96:99], v[160:163], v[32:35]
    v_exp_f32 v148, v148
    v_mfma_f32_16x16x32_bf16 v[36:39], a[100:103], v[160:163], v[36:39]
    v_exp_f32 v149, v149
    v_mfma_f32_16x16x32_bf16 v[40:43], a[104:107], v[160:163], v[40:43]
    v_exp_f32 v150, v150
    v_mfma_f32_16x16x32_bf16 v[44:47], a[108:111], v[160:163], v[44:47]
    v_exp_f32 v151, v151
    v_mfma_f32_16x16x32_bf16 a[112:115], a[124:127], v[160:163], a[112:115]
    v_cvt_pk_bf16_f32 v164, v144, v145
    v_cvt_pk_bf16_f32 v165, v146, v147
    v_cvt_pk_bf16_f32 v166, v148, v149
    v_cvt_pk_bf16_f32 v167, v150, v151
    s_nop 1
    v_mfma_f32_16x16x32_bf16 v[48:51], a[80:83], v[164:167], v[48:51]
    v_exp_f32 v152, v152
    v_mfma_f32_16x16x32_bf16 v[52:55], a[84:87], v[164:167], v[52:55]
    v_exp_f32 v153, v153
    v_mfma_f32_16x16x32_bf16 v[56:59], a[88:91], v[164:167], v[56:59]
    v_exp_f32 v154, v154
    v_mfma_f32_16x16x32_bf16 v[60:63], a[92:95], v[164:167], v[60:63]
    v_exp_f32 v155, v155
    v_mfma_f32_16x16x32_bf16 v[64:67], a[96:99], v[164:167], v[64:67]
    v_exp_f32 v156, v156
    v_mfma_f32_16x16x32_bf16 v[68:71], a[100:103], v[164:167], v[68:71]
    v_exp_f32 v157, v157
    v_mfma_f32_16x16x32_bf16 v[72:75], a[104:107], v[164:167], v[72:75]
    v_exp_f32 v158, v158
    v_mfma_f32_16x16x32_bf16 v[76:79], a[108:111], v[164:167], v[76:79]
    v_exp_f32 v159, v159
    v_mfma_f32_16x16x32_bf16 a[116:119], a[124:127], v[164:167], a[116:119]
    v_cvt_pk_bf16_f32 v168, v152, v153
    v_cvt_pk_bf16_f32 v169, v154, v155
    v_cvt_pk_bf16_f32 v170, v156, v157
    v_cvt_pk_bf16_f32 v171, v158, v159
    s_nop 1
    v_mfma_f32_16x16x32_bf16 v[80:83], a[80:83], v[168:171], v[80:83]
    v_mfma_f32_16x16x32_bf16 v[84:87], a[84:87], v[168:171], v[84:87]
    v_mfma_f32_16x16x32_bf16 v[88:91], a[88:91], v[168:171], v[88:91]
    v_mfma_f32_16x16x32_bf16 v[92:95], a[92:95], v[168:171], v[92:95]
    v_mfma_f32_16x16x32_bf16 v[96:99], a[96:99], v[168:171], v[96:99]
    v_mfma_f32_16x16x32_bf16 v[100:103], a[100:103], v[168:171], v[100:103]
    v_mfma_f32_16x16x32_bf16 v[104:107], a[104:107], v[168:171], v[104:107]
    v_mfma_f32_16x16x32_bf16 v[108:111], a[108:111], v[168:171], v[108:111]
    v_mfma_f32_16x16x32_bf16 a[120:123], a[124:127], v[168:171], a[120:123]
L_norm:
    s_nop 7
    v_accvgpr_read_b32 v4, a112
    v_accvgpr_read_b32 v5, a116
    v_accvgpr_read_b32 v6, a120
    v_rcp_f32 v8, v4
    v_rcp_f32 v10, v5
    v_rcp_f32 v12, v6
    v_lshlrev_b32 v1, 4, v0
    v_mov_b32 v9, v8
    v_mov_b32 v11, v10
    v_mov_b32 v13, v12
    v_pk_mul_f32 v[16:17], v[16:17], v[8:9]
    v_pk_mul_f32 v[18:19], v[18:19], v[8:9]
    v_pk_mul_f32 v[20:21], v[20:21], v[8:9]
    v_pk_mul_f32 v[22:23], v[22:23], v[8:9]
    v_cvt_pk_bf16_f32 v112, v16, v17
    v_cvt_pk_bf16_f32 v113, v18, v19
    v_cvt_pk_bf16_f32 v114, v20, v21
    v_cvt_pk_bf16_f32 v115, v22, v23
    global_store_dwordx4 v1, v[112:115], s[94:95] offset:0 sc1
    v_pk_mul_f32 v[24:25], v[24:25], v[8:9]
    v_pk_mul_f32 v[26:27], v[26:27], v[8:9]
    v_pk_mul_f32 v[28:29], v[28:29], v[8:9]
    v_pk_mul_f32 v[30:31], v[30:31], v[8:9]
    v_cvt_pk_bf16_f32 v116, v24, v25
    v_cvt_pk_bf16_f32 v117, v26, v27
    v_cvt_pk_bf16_f32 v118, v28, v29
    v_cvt_pk_bf16_f32 v119, v30, v31
    global_store_dwordx4 v1, v[116:119], s[94:95] offset:1024 sc1
    v_pk_mul_f32 v[32:33], v[32:33], v[8:9]
    v_pk_mul_f32 v[34:35], v[34:35], v[8:9]
    v_pk_mul_f32 v[36:37], v[36:37], v[8:9]
    v_pk_mul_f32 v[38:39], v[38:39], v[8:9]
    v_cvt_pk_bf16_f32 v120, v32, v33
    v_cvt_pk_bf16_f32 v121, v34, v35
    v_cvt_pk_bf16_f32 v122, v36, v37
    v_cvt_pk_bf16_f32 v123, v38, v39
    global_store_dwordx4 v1, v[120:123], s[94:95] offset:2048 sc1
    v_pk_mul_f32 v[40:41], v[40:41], v[8:9]
    v_pk_mul_f32 v[42:43], v[42:43], v[8:9]
    v_pk_mul_f32 v[44:45], v[44:45], v[8:9]
    v_pk_mul_f32 v[46:47], v[46:47], v[8:9]
    v_cvt_pk_bf16_f32 v124, v40, v41
    v_cvt_pk_bf16_f32 v125, v42, v43
    v_cvt_pk_bf16_f32 v126, v44, v45
    v_cvt_pk_bf16_f32 v127, v46, v47
    global_store_dwordx4 v1, v[124:127], s[94:95] offset:3072 sc1
    v_add_u32 v1, 4096, v1
    v_pk_mul_f32 v[48:49], v[48:49], v[10:11]
    v_pk_mul_f32 v[50:51], v[50:51], v[10:11]
    v_pk_mul_f32 v[52:53], v[52:53], v[10:11]
    v_pk_mul_f32 v[54:55], v[54:55], v[10:11]
    v_cvt_pk_bf16_f32 v128, v48, v49
    v_cvt_pk_bf16_f32 v129, v50, v51
    v_cvt_pk_bf16_f32 v130, v52, v53
    v_cvt_pk_bf16_f32 v131, v54, v55
    global_store_dwordx4 v1, v[128:131], s[94:95] offset:0 sc1
    v_pk_mul_f32 v[56:57], v[56:57], v[10:11]
    v_pk_mul_f32 v[58:59], v[58:59], v[10:11]
    v_pk_mul_f32 v[60:61], v[60:61], v[10:11]
    v_pk_mul_f32 v[62:63], v[62:63], v[10:11]
    v_cvt_pk_bf16_f32 v132, v56, v57
    v_cvt_pk_bf16_f32 v133, v58, v59
    v_cvt_pk_bf16_f32 v134, v60, v61
    v_cvt_pk_bf16_f32 v135, v62, v63
    global_store_dwordx4 v1, v[132:135], s[94:95] offset:1024 sc1
    v_pk_mul_f32 v[64:65], v[64:65], v[10:11]
    v_pk_mul_f32 v[66:67], v[66:67], v[10:11]
    v_pk_mul_f32 v[68:69], v[68:69], v[10:11]
    v_pk_mul_f32 v[70:71], v[70:71], v[10:11]
    v_cvt_pk_bf16_f32 v136, v64, v65
    v_cvt_pk_bf16_f32 v137, v66, v67
    v_cvt_pk_bf16_f32 v138, v68, v69
    v_cvt_pk_bf16_f32 v139, v70, v71
    global_store_dwordx4 v1, v[136:139], s[94:95] offset:2048 sc1
    v_pk_mul_f32 v[72:73], v[72:73], v[10:11]
    v_pk_mul_f32 v[74:75], v[74:75], v[10:11]
    v_pk_mul_f32 v[76:77], v[76:77], v[10:11]
    v_pk_mul_f32 v[78:79], v[78:79], v[10:11]
    v_cvt_pk_bf16_f32 v140, v72, v73
    v_cvt_pk_bf16_f32 v141, v74, v75
    v_cvt_pk_bf16_f32 v142, v76, v77
    v_cvt_pk_bf16_f32 v143, v78, v79
    global_store_dwordx4 v1, v[140:143], s[94:95] offset:3072 sc1
    v_add_u32 v1, 4096, v1
    v_pk_mul_f32 v[80:81], v[80:81], v[12:13]
    v_pk_mul_f32 v[82:83], v[82:83], v[12:13]
    v_pk_mul_f32 v[84:85], v[84:85], v[12:13]
    v_pk_mul_f32 v[86:87], v[86:87], v[12:13]
    v_cvt_pk_bf16_f32 v144, v80, v81
    v_cvt_pk_bf16_f32 v145, v82, v83
    v_cvt_pk_bf16_f32 v146, v84, v85
    v_cvt_pk_bf16_f32 v147, v86, v87
    global_store_dwordx4 v1, v[144:147], s[94:95] offset:0 sc1
    v_pk_mul_f32 v[88:89], v[88:89], v[12:13]
    v_pk_mul_f32 v[90:91], v[90:91], v[12:13]
    v_pk_mul_f32 v[92:93], v[92:93], v[12:13]
    v_pk_mul_f32 v[94:95], v[94:95], v[12:13]
    v_cvt_pk_bf16_f32 v148, v88, v89
    v_cvt_pk_bf16_f32 v149, v90, v91
    v_cvt_pk_bf16_f32 v150, v92, v93
    v_cvt_pk_bf16_f32 v151, v94, v95
    global_store_dwordx4 v1, v[148:151], s[94:95] offset:1024 sc1
    v_pk_mul_f32 v[96:97], v[96:97], v[12:13]
    v_pk_mul_f32 v[98:99], v[98:99], v[12:13]
    v_pk_mul_f32 v[100:101], v[100:101], v[12:13]
    v_pk_mul_f32 v[102:103], v[102:103], v[12:13]
    v_cvt_pk_bf16_f32 v152, v96, v97
    v_cvt_pk_bf16_f32 v153, v98, v99
    v_cvt_pk_bf16_f32 v154, v100, v101
    v_cvt_pk_bf16_f32 v155, v102, v103
    global_store_dwordx4 v1, v[152:155], s[94:95] offset:2048 sc1
    v_pk_mul_f32 v[104:105], v[104:105], v[12:13]
    v_pk_mul_f32 v[106:107], v[106:107], v[12:13]
    v_pk_mul_f32 v[108:109], v[108:109], v[12:13]
    v_pk_mul_f32 v[110:111], v[110:111], v[12:13]
    v_cvt_pk_bf16_f32 v156, v104, v105
    v_cvt_pk_bf16_f32 v157, v106, v107
    v_cvt_pk_bf16_f32 v158, v108, v109
    v_cvt_pk_bf16_f32 v159, v110, v111
    global_store_dwordx4 v1, v[156:159], s[94:95] offset:3072 sc1
    s_cmp_eq_u32 s60, 1
    s_cbranch_scc1 L_store
    v_mov_b32 v220, 0
    v_mov_b32 v221, 0
    v_mov_b32 v222, 0
    v_mov_b32 v223, 0
    s_nop 1
    v_mfma_f32_16x16x32_bf16 v[160:163], v[220:223], v[112:115], 0
    v_mfma_f32_16x16x32_bf16 v[160:163], v[220:223], v[116:119], v[160:163]
    v_mfma_f32_16x16x32_bf16 v[160:163], v[220:223], v[120:123], v[160:163]
    v_mfma_f32_16x16x32_bf16 v[160:163], v[220:223], v[124:127], v[160:163]
    v_mfma_f32_16x16x32_bf16 v[160:163], v[220:223], v[128:131], v[160:163]
    v_mfma_f32_16x16x32_bf16 v[160:163], v[220:223], v[132:135], v[160:163]
    v_mfma_f32_16x16x32_bf16 v[160:163], v[220:223], v[136:139], v[160:163]
    v_mfma_f32_16x16x32_bf16 v[160:163], v[220:223], v[140:143], v[160:163]
    v_mfma_f32_16x16x32_bf16 v[160:163], v[220:223], v[144:147], v[160:163]
    v_mfma_f32_16x16x32_bf16 v[160:163], v[220:223], v[148:151], v[160:163]
    v_mfma_f32_16x16x32_bf16 v[160:163], v[220:223], v[152:155], v[160:163]
    v_mfma_f32_16x16x32_bf16 v[160:163], v[220:223], v[156:159], v[160:163]
    s_mov_b32 s45, 0x71800000
    v_cmp_nle_f32 s[46:47], v4, s45
    v_cmp_nle_f32 s[48:49], v5, s45
    v_cmp_nle_f32 vcc, v6, s45
    s_nop 3
    s_or_b64 s[46:47], s[46:47], s[48:49]
    s_or_b64 s[46:47], s[46:47], vcc
    v_cmp_u_f32 vcc, v160, v160
    s_nop 1
    s_or_b64 s[46:47], s[46:47], vcc
    s_cbranch_scc1 L_slow
L_store:
    v_add_u32 v184, 131072, v192
    v_add_u32 v185, 131072, v193
    v_add_u32 v186, 131072, v194
    v_add_u32 v187, 131072, v195
    v_add_u32 v188, 131072, v196
    v_add_u32 v189, 131072, v197
    v_add_u32 v190, 131072, v198
    v_add_u32 v191, 131072, v199
    v_mov_b32 v208, v192
    v_mov_b32 v209, v193
    v_mov_b32 v210, v194
    v_mov_b32 v211, v195
    v_mov_b32 v212, v196
    v_mov_b32 v213, v197
    v_mov_b32 v214, v198
    v_mov_b32 v215, v199
    s_lshl_b32 s90, 1, s39
    s_mov_b32 s92, 0
    s_waitcnt vmcnt(12)
    s_mov_b32 s92, 0
    v_cmp_eq_u64 vcc, s[86:87], v[242:243]
    s_nop 1
    s_and_b32 s62, vcc_lo, 0xf
    s_andn2_b32 s62, s62, s90
    s_cbranch_scc0 L_t1
    s_ff1_i32_b32 s63, s62
    s_lshl_b32 s62, 1, s63
    s_or_b32 s90, s90, s62
    s_mul_i32 s53, s63, 36864
    s_sub_u32 s63, s63, s39
    s_and_b32 s63, s63, 3
    s_sub_u32 s63, s63, 1
    s_lshl_b32 s62, s63, 15
    v_add_u32 v208, s62, v192
    v_add_u32 v209, s62, v193
    v_add_u32 v210, s62, v194
    v_add_u32 v211, s62, v195
    v_add_u32 v212, s62, v196
    v_add_u32 v213, s62, v197
    v_add_u32 v214, s62, v198
    v_add_u32 v215, s62, v199
    s_mov_b32 s92, 1
L_t1:
    ds_read_b64_tr_b16 a[80:81], v184 offset:0
    ds_read_b64_tr_b16 a[82:83], v184 offset:4096
    ds_read_b64_tr_b16 a[84:85], v185 offset:0
    ds_read_b64_tr_b16 a[86:87], v185 offset:4096
    ds_read_b64_tr_b16 a[88:89], v186 offset:0
    ds_read_b64_tr_b16 a[90:91], v186 offset:4096
    ds_read_b64_tr_b16 a[92:93], v187 offset:0
    ds_read_b64_tr_b16 a[94:95], v187 offset:4096
    ds_read_b64_tr_b16 a[96:97], v188 offset:0
    ds_read_b64_tr_b16 a[98:99], v188 offset:4096
    ds_read_b64_tr_b16 a[100:101], v189 offset:0
    ds_read_b64_tr_b16 a[102:103], v189 offset:4096
    ds_read_b64_tr_b16 a[104:105], v190 offset:0
    ds_read_b64_tr_b16 a[106:107], v190 offset:4096
    s_waitcnt lgkmcnt(12)
    v_mfma_f32_16x16x32_bf16 v[16:19], a[80:83], v[112:115], 0
    ds_read_b64_tr_b16 a[108:109], v191 offset:0
    ds_read_b64_tr_b16 a[110:111], v191 offset:4096
    v_mfma_f32_16x16x32_bf16 v[48:51], a[80:83], v[128:131], 0
    v_mfma_f32_16x16x32_bf16 v[80:83], a[80:83], v[144:147], 0
    s_waitcnt lgkmcnt(12)
    v_mfma_f32_16x16x32_bf16 v[20:23], a[84:87], v[112:115], 0
    v_mfma_f32_16x16x32_bf16 v[52:55], a[84:87], v[128:131], 0
    v_mfma_f32_16x16x32_bf16 v[84:87], a[84:87], v[144:147], 0
    s_cmp_eq_u32 s92, 1
    s_cbranch_scc0 L_t2
    buffer_load_dwordx4 a[128:131], v244, s[28:31], s53 offen offset:0 sc1
    buffer_load_dwordx4 a[132:135], v245, s[28:31], s53 offen offset:0 sc1
    buffer_load_dwordx4 a[136:139], v246, s[28:31], s53 offen offset:0 sc1
L_t3:
    ds_read_b64_tr_b16 a[80:81], v184 offset:8192
    ds_read_b64_tr_b16 a[82:83], v184 offset:12288
    ds_read_b64_tr_b16 a[84:85], v185 offset:8192
    ds_read_b64_tr_b16 a[86:87], v185 offset:12288
    s_waitcnt lgkmcnt(14)
    v_mfma_f32_16x16x32_bf16 v[24:27], a[88:91], v[112:115], 0
    v_mfma_f32_16x16x32_bf16 v[56:59], a[88:91], v[128:131], 0
    v_mfma_f32_16x16x32_bf16 v[88:91], a[88:91], v[144:147], 0
    ds_read_b64_tr_b16 a[88:89], v186 offset:8192
    ds_read_b64_tr_b16 a[90:91], v186 offset:12288
    s_waitcnt lgkmcnt(14)
    v_mfma_f32_16x16x32_bf16 v[28:31], a[92:95], v[112:115], 0
    v_mfma_f32_16x16x32_bf16 v[60:63], a[92:95], v[128:131], 0
    v_mfma_f32_16x16x32_bf16 v[92:95], a[92:95], v[144:147], 0
    ds_read_b64_tr_b16 a[92:93], v187 offset:8192
    ds_read_b64_tr_b16 a[94:95], v187 offset:12288
    s_waitcnt lgkmcnt(14)
    v_mfma_f32_16x16x32_bf16 v[32:35], a[96:99], v[112:115], 0
    v_mfma_f32_16x16x32_bf16 v[64:67], a[96:99], v[128:131], 0
    v_mfma_f32_16x16x32_bf16 v[96:99], a[96:99], v[144:147], 0
    ds_read_b64_tr_b16 a[96:97], v188 offset:8192
    ds_read_b64_tr_b16 a[98:99], v188 offset:12288
    s_waitcnt lgkmcnt(14)
    v_mfma_f32_16x16x32_bf16 v[36:39], a[100:103], v[112:115], 0
    v_mfma_f32_16x16x32_bf16 v[68:71], a[100:103], v[128:131], 0
    v_mfma_f32_16x16x32_bf16 v[100:103], a[100:103], v[144:147], 0
    ds_read_b64_tr_b16 a[100:101], v189 offset:8192
    ds_read_b64_tr_b16 a[102:103], v189 offset:12288
    s_waitcnt lgkmcnt(14)
    v_mfma_f32_16x16x32_bf16 v[40:43], a[104:107], v[112:115], 0
    v_mfma_f32_16x16x32_bf16 v[72:75], a[104:107], v[128:131], 0
    v_mfma_f32_16x16x32_bf16 v[104:107], a[104:107], v[144:147], 0
    ds_read_b64_tr_b16 a[104:105], v190 offset:8192
    ds_read_b64_tr_b16 a[106:107], v190 offset:12288
    s_waitcnt lgkmcnt(14)
    v_mfma_f32_16x16x32_bf16 v[44:47], a[108:111], v[112:115], 0
    v_mfma_f32_16x16x32_bf16 v[76:79], a[108:111], v[128:131], 0
    v_mfma_f32_16x16x32_bf16 v[108:111], a[108:111], v[144:147], 0
    s_waitcnt lgkmcnt(12)
    v_mfma_f32_16x16x32_bf16 v[16:19], a[80:83], v[116:119], v[16:19]
    ds_read_b64_tr_b16 a[108:109], v191 offset:8192
    ds_read_b64_tr_b16 a[110:111], v191 offset:12288
    v_mfma_f32_16x16x32_bf16 v[48:51], a[80:83], v[132:135], v[48:51]
    v_mfma_f32_16x16x32_bf16 v[80:83], a[80:83], v[148:151], v[80:83]
    s_waitcnt lgkmcnt(12)
    v_mfma_f32_16x16x32_bf16 v[20:23], a[84:87], v[116:119], v[20:23]
    v_mfma_f32_16x16x32_bf16 v[52:55], a[84:87], v[132:135], v[52:55]
    v_mfma_f32_16x16x32_bf16 v[84:87], a[84:87], v[148:151], v[84:87]
    s_cmp_eq_u32 s92, 1
    s_cbranch_scc0 L_t4
    buffer_load_dwordx4 a[140:143], v244, s[28:31], s53 offen offset:1024 sc1
    buffer_load_dwordx4 a[144:147], v245, s[28:31], s53 offen offset:1024 sc1
    buffer_load_dwordx4 a[148:151], v246, s[28:31], s53 offen offset:1024 sc1
L_t5:
    ds_read_b64_tr_b16 a[80:81], v184 offset:16384
    ds_read_b64_tr_b16 a[82:83], v184 offset:20480
    ds_read_b64_tr_b16 a[84:85], v185 offset:16384
    ds_read_b64_tr_b16 a[86:87], v185 offset:20480
    s_waitcnt lgkmcnt(14)
    v_mfma_f32_16x16x32_bf16 v[24:27], a[88:91], v[116:119], v[24:27]
    v_mfma_f32_16x16x32_bf16 v[56:59], a[88:91], v[132:135], v[56:59]
    v_mfma_f32_16x16x32_bf16 v[88:91], a[88:91], v[148:151], v[88:91]
    ds_read_b64_tr_b16 a[88:89], v186 offset:16384
    ds_read_b64_tr_b16 a[90:91], v186 offset:20480
    s_waitcnt lgkmcnt(14)
    v_mfma_f32_16x16x32_bf16 v[28:31], a[92:95], v[116:119], v[28:31]
    v_mfma_f32_16x16x32_bf16 v[60:63], a[92:95], v[132:135], v[60:63]
    v_mfma_f32_16x16x32_bf16 v[92:95], a[92:95], v[148:151], v[92:95]
    ds_read_b64_tr_b16 a[92:93], v187 offset:16384
    ds_read_b64_tr_b16 a[94:95], v187 offset:20480
    s_waitcnt lgkmcnt(14)
    v_mfma_f32_16x16x32_bf16 v[32:35], a[96:99], v[116:119], v[32:35]
    v_mfma_f32_16x16x32_bf16 v[64:67], a[96:99], v[132:135], v[64:67]
    v_mfma_f32_16x16x32_bf16 v[96:99], a[96:99], v[148:151], v[96:99]
    ds_read_b64_tr_b16 a[96:97], v188 offset:16384
    ds_read_b64_tr_b16 a[98:99], v188 offset:20480
    s_waitcnt lgkmcnt(14)
    v_mfma_f32_16x16x32_bf16 v[36:39], a[100:103], v[116:119], v[36:39]
    v_mfma_f32_16x16x32_bf16 v[68:71], a[100:103], v[132:135], v[68:71]
    v_mfma_f32_16x16x32_bf16 v[100:103], a[100:103], v[148:151], v[100:103]
    ds_read_b64_tr_b16 a[100:101], v189 offset:16384
    ds_read_b64_tr_b16 a[102:103], v189 offset:20480
    s_waitcnt lgkmcnt(14)
    v_mfma_f32_16x16x32_bf16 v[40:43], a[104:107], v[116:119], v[40:43]
    v_mfma_f32_16x16x32_bf16 v[72:75], a[104:107], v[132:135], v[72:75]
    v_mfma_f32_16x16x32_bf16 v[104:107], a[104:107], v[148:151], v[104:107]
    ds_read_b64_tr_b16 a[104:105], v190 offset:16384
    ds_read_b64_tr_b16 a[106:107], v190 offset:20480
    s_waitcnt lgkmcnt(14)
    v_mfma_f32_16x16x32_bf16 v[44:47], a[108:111], v[116:119], v[44:47]
    v_mfma_f32_16x16x32_bf16 v[76:79], a[108:111], v[132:135], v[76:79]
    v_mfma_f32_16x16x32_bf16 v[108:111], a[108:111], v[148:151], v[108:111]
    s_waitcnt lgkmcnt(12)
    v_mfma_f32_16x16x32_bf16 v[16:19], a[80:83], v[120:123], v[16:19]
    ds_read_b64_tr_b16 a[108:109], v191 offset:16384
    ds_read_b64_tr_b16 a[110:111], v191 offset:20480
    v_mfma_f32_16x16x32_bf16 v[48:51], a[80:83], v[136:139], v[48:51]
    v_mfma_f32_16x16x32_bf16 v[80:83], a[80:83], v[152:155], v[80:83]
    s_waitcnt lgkmcnt(12)
    v_mfma_f32_16x16x32_bf16 v[20:23], a[84:87], v[120:123], v[20:23]
    v_mfma_f32_16x16x32_bf16 v[52:55], a[84:87], v[136:139], v[52:55]
    v_mfma_f32_16x16x32_bf16 v[84:87], a[84:87], v[152:155], v[84:87]
    s_waitcnt vmcnt(6)
    s_mov_b64 exec, 15
    global_store_dwordx2 v249, v[240:241], s[18:19] sc1
    s_mov_b64 exec, -1
    s_cmp_eq_u32 s92, 1
    s_cbranch_scc0 L_t6
    buffer_load_dwordx4 a[152:155], v244, s[28:31], s53 offen offset:2048 sc1
    buffer_load_dwordx4 a[156:159], v245, s[28:31], s53 offen offset:2048 sc1
    buffer_load_dwordx4 a[160:163], v246, s[28:31], s53 offen offset:2048 sc1
L_t7:
    ds_read_b64_tr_b16 a[80:81], v184 offset:24576
    ds_read_b64_tr_b16 a[82:83], v184 offset:28672
    ds_read_b64_tr_b16 a[84:85], v185 offset:24576
    ds_read_b64_tr_b16 a[86:87], v185 offset:28672
    s_waitcnt lgkmcnt(14)
    v_mfma_f32_16x16x32_bf16 v[24:27], a[88:91], v[120:123], v[24:27]
    v_mfma_f32_16x16x32_bf16 v[56:59], a[88:91], v[136:139], v[56:59]
    v_mfma_f32_16x16x32_bf16 v[88:91], a[88:91], v[152:155], v[88:91]
    ds_read_b64_tr_b16 a[88:89], v186 offset:24576
    ds_read_b64_tr_b16 a[90:91], v186 offset:28672
    s_waitcnt lgkmcnt(14)
    v_mfma_f32_16x16x32_bf16 v[28:31], a[92:95], v[120:123], v[28:31]
    v_mfma_f32_16x16x32_bf16 v[60:63], a[92:95], v[136:139], v[60:63]
    v_mfma_f32_16x16x32_bf16 v[92:95], a[92:95], v[152:155], v[92:95]
    ds_read_b64_tr_b16 a[92:93], v187 offset:24576
    ds_read_b64_tr_b16 a[94:95], v187 offset:28672
    s_waitcnt lgkmcnt(14)
    v_mfma_f32_16x16x32_bf16 v[32:35], a[96:99], v[120:123], v[32:35]
    v_mfma_f32_16x16x32_bf16 v[64:67], a[96:99], v[136:139], v[64:67]
    v_mfma_f32_16x16x32_bf16 v[96:99], a[96:99], v[152:155], v[96:99]
    ds_read_b64_tr_b16 a[96:97], v188 offset:24576
    ds_read_b64_tr_b16 a[98:99], v188 offset:28672
    s_waitcnt lgkmcnt(14)
    v_mfma_f32_16x16x32_bf16 v[36:39], a[100:103], v[120:123], v[36:39]
    v_mfma_f32_16x16x32_bf16 v[68:71], a[100:103], v[136:139], v[68:71]
    v_mfma_f32_16x16x32_bf16 v[100:103], a[100:103], v[152:155], v[100:103]
    ds_read_b64_tr_b16 a[100:101], v189 offset:24576
    ds_read_b64_tr_b16 a[102:103], v189 offset:28672
    s_waitcnt lgkmcnt(14)
    v_mfma_f32_16x16x32_bf16 v[40:43], a[104:107], v[120:123], v[40:43]
    v_mfma_f32_16x16x32_bf16 v[72:75], a[104:107], v[136:139], v[72:75]
    v_mfma_f32_16x16x32_bf16 v[104:107], a[104:107], v[152:155], v[104:107]
    ds_read_b64_tr_b16 a[104:105], v190 offset:24576
    ds_read_b64_tr_b16 a[106:107], v190 offset:28672
    s_waitcnt lgkmcnt(14)
    v_mfma_f32_16x16x32_bf16 v[44:47], a[108:111], v[120:123], v[44:47]
    v_mfma_f32_16x16x32_bf16 v[76:79], a[108:111], v[136:139], v[76:79]
    v_mfma_f32_16x16x32_bf16 v[108:111], a[108:111], v[152:155], v[108:111]
    s_waitcnt lgkmcnt(12)
    v_mfma_f32_16x16x32_bf16 v[16:19], a[80:83], v[124:127], v[16:19]
    ds_read_b64_tr_b16 a[108:109], v191 offset:24576
    ds_read_b64_tr_b16 a[110:111], v191 offset:28672
    v_mfma_f32_16x16x32_bf16 v[48:51], a[80:83], v[140:143], v[48:51]
    v_mfma_f32_16x16x32_bf16 v[80:83], a[80:83], v[156:159], v[80:83]
    s_waitcnt lgkmcnt(12)
    v_mfma_f32_16x16x32_bf16 v[20:23], a[84:87], v[124:127], v[20:23]
    v_mfma_f32_16x16x32_bf16 v[52:55], a[84:87], v[140:143], v[52:55]
    v_mfma_f32_16x16x32_bf16 v[84:87], a[84:87], v[156:159], v[84:87]
    s_cmp_eq_u32 s92, 1
    s_cbranch_scc0 L_t8
    buffer_load_dwordx4 a[164:167], v244, s[28:31], s53 offen offset:3072 sc1
    buffer_load_dwordx4 a[168:171], v245, s[28:31], s53 offen offset:3072 sc1
    buffer_load_dwordx4 a[172:175], v246, s[28:31], s53 offen offset:3072 sc1
L_t9:
    s_waitcnt lgkmcnt(0)
    s_barrier
    ds_read_b64_tr_b16 a[80:81], v208 offset:0
    ds_read_b64_tr_b16 a[82:83], v208 offset:4096
    ds_read_b64_tr_b16 a[84:85], v209 offset:0
    ds_read_b64_tr_b16 a[86:87], v209 offset:4096
    v_mfma_f32_16x16x32_bf16 v[24:27], a[88:91], v[124:127], v[24:27]
    v_mfma_f32_16x16x32_bf16 v[56:59], a[88:91], v[140:143], v[56:59]
    v_mfma_f32_16x16x32_bf16 v[88:91], a[88:91], v[156:159], v[88:91]
    ds_read_b64_tr_b16 a[88:89], v210 offset:0
    ds_read_b64_tr_b16 a[90:91], v210 offset:4096
    v_mfma_f32_16x16x32_bf16 v[28:31], a[92:95], v[124:127], v[28:31]
    v_mfma_f32_16x16x32_bf16 v[60:63], a[92:95], v[140:143], v[60:63]
    v_mfma_f32_16x16x32_bf16 v[92:95], a[92:95], v[156:159], v[92:95]
    ds_read_b64_tr_b16 a[92:93], v211 offset:0
    ds_read_b64_tr_b16 a[94:95], v211 offset:4096
    v_mfma_f32_16x16x32_bf16 v[32:35], a[96:99], v[124:127], v[32:35]
    v_mfma_f32_16x16x32_bf16 v[64:67], a[96:99], v[140:143], v[64:67]
    v_mfma_f32_16x16x32_bf16 v[96:99], a[96:99], v[156:159], v[96:99]
    ds_read_b64_tr_b16 a[96:97], v212 offset:0
    ds_read_b64_tr_b16 a[98:99], v212 offset:4096
    v_mfma_f32_16x16x32_bf16 v[36:39], a[100:103], v[124:127], v[36:39]
    v_mfma_f32_16x16x32_bf16 v[68:71], a[100:103], v[140:143], v[68:71]
    v_mfma_f32_16x16x32_bf16 v[100:103], a[100:103], v[156:159], v[100:103]
    ds_read_b64_tr_b16 a[100:101], v213 offset:0
    ds_read_b64_tr_b16 a[102:103], v213 offset:4096
    v_mfma_f32_16x16x32_bf16 v[40:43], a[104:107], v[124:127], v[40:43]
    v_mfma_f32_16x16x32_bf16 v[72:75], a[104:107], v[140:143], v[72:75]
    v_mfma_f32_16x16x32_bf16 v[104:107], a[104:107], v[156:159], v[104:107]
    ds_read_b64_tr_b16 a[104:105], v214 offset:0
    ds_read_b64_tr_b16 a[106:107], v214 offset:4096
    v_mfma_f32_16x16x32_bf16 v[44:47], a[108:111], v[124:127], v[44:47]
    v_mfma_f32_16x16x32_bf16 v[76:79], a[108:111], v[140:143], v[76:79]
    v_mfma_f32_16x16x32_bf16 v[108:111], a[108:111], v[156:159], v[108:111]
    s_cmp_eq_u32 s92, 1
    s_cbranch_scc0 L_t11
L_t12:
    s_mov_b32 s92, 0
    v_cmp_eq_u64 vcc, s[86:87], v[242:243]
    s_nop 1
    s_and_b32 s62, vcc_lo, 0xf
    s_andn2_b32 s62, s62, s90
    s_cbranch_scc0 L_t17
    s_ff1_i32_b32 s63, s62
    s_lshl_b32 s62, 1, s63
    s_or_b32 s90, s90, s62
    s_mul_i32 s54, s63, 36864
    s_sub_u32 s63, s63, s39
    s_and_b32 s63, s63, 3
    s_sub_u32 s63, s63, 1
    s_lshl_b32 s62, s63, 15
    v_add_u32 v184, s62, v192
    v_add_u32 v185, s62, v193
    v_add_u32 v186, s62, v194
    v_add_u32 v187, s62, v195
    v_add_u32 v188, s62, v196
    v_add_u32 v189, s62, v197
    v_add_u32 v190, s62, v198
    v_add_u32 v191, s62, v199
    s_mov_b32 s92, 1
L_t17:
    s_waitcnt vmcnt(9)
    s_waitcnt lgkmcnt(12)
    v_mfma_f32_16x16x32_bf16 v[16:19], a[80:83], a[128:131], v[16:19]
    ds_read_b64_tr_b16 a[108:109], v215 offset:0
    ds_read_b64_tr_b16 a[110:111], v215 offset:4096
    v_mfma_f32_16x16x32_bf16 v[48:51], a[80:83], a[132:135], v[48:51]
    v_mfma_f32_16x16x32_bf16 v[80:83], a[80:83], a[136:139], v[80:83]
    s_waitcnt lgkmcnt(12)
    v_mfma_f32_16x16x32_bf16 v[20:23], a[84:87], a[128:131], v[20:23]
    v_mfma_f32_16x16x32_bf16 v[52:55], a[84:87], a[132:135], v[52:55]
    v_mfma_f32_16x16x32_bf16 v[84:87], a[84:87], a[136:139], v[84:87]
    s_cmp_eq_u32 s92, 1
    s_cbranch_scc0 L_t18
    buffer_load_dwordx4 a[176:179], v244, s[28:31], s54 offen offset:0 sc1
    buffer_load_dwordx4 a[180:183], v245, s[28:31], s54 offen offset:0 sc1
    buffer_load_dwordx4 a[184:187], v246, s[28:31], s54 offen offset:0 sc1
L_t19:
    ds_read_b64_tr_b16 a[80:81], v208 offset:8192
    ds_read_b64_tr_b16 a[82:83], v208 offset:12288
    ds_read_b64_tr_b16 a[84:85], v209 offset:8192
    ds_read_b64_tr_b16 a[86:87], v209 offset:12288
    s_waitcnt lgkmcnt(14)
    v_mfma_f32_16x16x32_bf16 v[24:27], a[88:91], a[128:131], v[24:27]
    v_mfma_f32_16x16x32_bf16 v[56:59], a[88:91], a[132:135], v[56:59]
    v_mfma_f32_16x16x32_bf16 v[88:91], a[88:91], a[136:139], v[88:91]
    ds_read_b64_tr_b16 a[88:89], v210 offset:8192
    ds_read_b64_tr_b16 a[90:91], v210 offset:12288
    s_waitcnt lgkmcnt(14)
    v_mfma_f32_16x16x32_bf16 v[28:31], a[92:95], a[128:131], v[28:31]
    v_mfma_f32_16x16x32_bf16 v[60:63], a[92:95], a[132:135], v[60:63]
    v_mfma_f32_16x16x32_bf16 v[92:95], a[92:95], a[136:139], v[92:95]
    ds_read_b64_tr_b16 a[92:93], v211 offset:8192
    ds_read_b64_tr_b16 a[94:95], v211 offset:12288
    s_waitcnt lgkmcnt(14)
    v_mfma_f32_16x16x32_bf16 v[32:35], a[96:99], a[128:131], v[32:35]
    v_mfma_f32_16x16x32_bf16 v[64:67], a[96:99], a[132:135], v[64:67]
    v_mfma_f32_16x16x32_bf16 v[96:99], a[96:99], a[136:139], v[96:99]
    ds_read_b64_tr_b16 a[96:97], v212 offset:8192
    ds_read_b64_tr_b16 a[98:99], v212 offset:12288
    s_waitcnt lgkmcnt(14)
    v_mfma_f32_16x16x32_bf16 v[36:39], a[100:103], a[128:131], v[36:39]
    v_mfma_f32_16x16x32_bf16 v[68:71], a[100:103], a[132:135], v[68:71]
    v_mfma_f32_16x16x32_bf16 v[100:103], a[100:103], a[136:139], v[100:103]
    ds_read_b64_tr_b16 a[100:101], v213 offset:8192
    ds_read_b64_tr_b16 a[102:103], v213 offset:12288
    s_waitcnt lgkmcnt(14)
    v_mfma_f32_16x16x32_bf16 v[40:43], a[104:107], a[128:131], v[40:43]
    v_mfma_f32_16x16x32_bf16 v[72:75], a[104:107], a[132:135], v[72:75]
    v_mfma_f32_16x16x32_bf16 v[104:107], a[104:107], a[136:139], v[104:107]
    ds_read_b64_tr_b16 a[104:105], v214 offset:8192
    ds_read_b64_tr_b16 a[106:107], v214 offset:12288
    s_waitcnt lgkmcnt(14)
    v_mfma_f32_16x16x32_bf16 v[44:47], a[108:111], a[128:131], v[44:47]
    v_mfma_f32_16x16x32_bf16 v[76:79], a[108:111], a[132:135], v[76:79]
    v_mfma_f32_16x16x32_bf16 v[108:111], a[108:111], a[136:139], v[108:111]
    s_waitcnt vmcnt(9)
    s_waitcnt lgkmcnt(12)
    v_mfma_f32_16x16x32_bf16 v[16:19], a[80:83], a[140:143], v[16:19]
    ds_read_b64_tr_b16 a[108:109], v215 offset:8192
    ds_read_b64_tr_b16 a[110:111], v215 offset:12288
    v_mfma_f32_16x16x32_bf16 v[48:51], a[80:83], a[144:147], v[48:51]
    v_mfma_f32_16x16x32_bf16 v[80:83], a[80:83], a[148:151], v[80:83]
    s_waitcnt lgkmcnt(12)
    v_mfma_f32_16x16x32_bf16 v[20:23], a[84:87], a[140:143], v[20:23]
    v_mfma_f32_16x16x32_bf16 v[52:55], a[84:87], a[144:147], v[52:55]
    v_mfma_f32_16x16x32_bf16 v[84:87], a[84:87], a[148:151], v[84:87]
    s_cmp_eq_u32 s92, 1
    s_cbranch_scc0 L_t20
    buffer_load_dwordx4 a[188:191], v244, s[28:31], s54 offen offset:1024 sc1
    buffer_load_dwordx4 a[192:195], v245, s[28:31], s54 offen offset:1024 sc1
    buffer_load_dwordx4 a[196:199], v246, s[28:31], s54 offen offset:1024 sc1
L_t21:
    ds_read_b64_tr_b16 a[80:81], v208 offset:16384
    ds_read_b64_tr_b16 a[82:83], v208 offset:20480
    ds_read_b64_tr_b16 a[84:85], v209 offset:16384
    ds_read_b64_tr_b16 a[86:87], v209 offset:20480
    s_waitcnt lgkmcnt(14)
    v_mfma_f32_16x16x32_bf16 v[24:27], a[88:91], a[140:143], v[24:27]
    v_mfma_f32_16x16x32_bf16 v[56:59], a[88:91], a[144:147], v[56:59]
    v_mfma_f32_16x16x32_bf16 v[88:91], a[88:91], a[148:151], v[88:91]
    ds_read_b64_tr_b16 a[88:89], v210 offset:16384
    ds_read_b64_tr_b16 a[90:91], v210 offset:20480
    s_waitcnt lgkmcnt(14)
    v_mfma_f32_16x16x32_bf16 v[28:31], a[92:95], a[140:143], v[28:31]
    v_mfma_f32_16x16x32_bf16 v[60:63], a[92:95], a[144:147], v[60:63]
    v_mfma_f32_16x16x32_bf16 v[92:95], a[92:95], a[148:151], v[92:95]
    ds_read_b64_tr_b16 a[92:93], v211 offset:16384
    ds_read_b64_tr_b16 a[94:95], v211 offset:20480
    s_waitcnt lgkmcnt(14)
    v_mfma_f32_16x16x32_bf16 v[32:35], a[96:99], a[140:143], v[32:35]
    v_mfma_f32_16x16x32_bf16 v[64:67], a[96:99], a[144:147], v[64:67]
    v_mfma_f32_16x16x32_bf16 v[96:99], a[96:99], a[148:151], v[96:99]
    ds_read_b64_tr_b16 a[96:97], v212 offset:16384
    ds_read_b64_tr_b16 a[98:99], v212 offset:20480
    s_waitcnt lgkmcnt(14)
    v_mfma_f32_16x16x32_bf16 v[36:39], a[100:103], a[140:143], v[36:39]
    v_mfma_f32_16x16x32_bf16 v[68:71], a[100:103], a[144:147], v[68:71]
    v_mfma_f32_16x16x32_bf16 v[100:103], a[100:103], a[148:151], v[100:103]
    ds_read_b64_tr_b16 a[100:101], v213 offset:16384
    ds_read_b64_tr_b16 a[102:103], v213 offset:20480
    s_waitcnt lgkmcnt(14)
    v_mfma_f32_16x16x32_bf16 v[40:43], a[104:107], a[140:143], v[40:43]
    v_mfma_f32_16x16x32_bf16 v[72:75], a[104:107], a[144:147], v[72:75]
    v_mfma_f32_16x16x32_bf16 v[104:107], a[104:107], a[148:151], v[104:107]
    ds_read_b64_tr_b16 a[104:105], v214 offset:16384
    ds_read_b64_tr_b16 a[106:107], v214 offset:20480
    s_waitcnt lgkmcnt(14)
    v_mfma_f32_16x16x32_bf16 v[44:47], a[108:111], a[140:143], v[44:47]
    v_mfma_f32_16x16x32_bf16 v[76:79], a[108:111], a[144:147], v[76:79]
    v_mfma_f32_16x16x32_bf16 v[108:111], a[108:111], a[148:151], v[108:111]
    s_waitcnt vmcnt(9)
    s_waitcnt lgkmcnt(12)
    v_mfma_f32_16x16x32_bf16 v[16:19], a[80:83], a[152:155], v[16:19]
    ds_read_b64_tr_b16 a[108:109], v215 offset:16384
    ds_read_b64_tr_b16 a[110:111], v215 offset:20480
    v_mfma_f32_16x16x32_bf16 v[48:51], a[80:83], a[156:159], v[48:51]
    v_mfma_f32_16x16x32_bf16 v[80:83], a[80:83], a[160:163], v[80:83]
    s_waitcnt lgkmcnt(12)
    v_mfma_f32_16x16x32_bf16 v[20:23], a[84:87], a[152:155], v[20:23]
    v_mfma_f32_16x16x32_bf16 v[52:55], a[84:87], a[156:159], v[52:55]
    v_mfma_f32_16x16x32_bf16 v[84:87], a[84:87], a[160:163], v[84:87]
    s_cmp_eq_u32 s92, 1
    s_cbranch_scc0 L_t22
    buffer_load_dwordx4 a[200:203], v244, s[28:31], s54 offen offset:2048 sc1
    buffer_load_dwordx4 a[204:207], v245, s[28:31], s54 offen offset:2048 sc1
    buffer_load_dwordx4 a[208:211], v246, s[28:31], s54 offen offset:2048 sc1
L_t23:
    ds_read_b64_tr_b16 a[80:81], v208 offset:24576
    ds_read_b64_tr_b16 a[82:83], v208 offset:28672
    ds_read_b64_tr_b16 a[84:85], v209 offset:24576
    ds_read_b64_tr_b16 a[86:87], v209 offset:28672
    s_waitcnt lgkmcnt(14)
    v_mfma_f32_16x16x32_bf16 v[24:27], a[88:91], a[152:155], v[24:27]
    v_mfma_f32_16x16x32_bf16 v[56:59], a[88:91], a[156:159], v[56:59]
    v_mfma_f32_16x16x32_bf16 v[88:91], a[88:91], a[160:163], v[88:91]
    ds_read_b64_tr_b16 a[88:89], v210 offset:24576
    ds_read_b64_tr_b16 a[90:91], v210 offset:28672
    s_waitcnt lgkmcnt(14)
    v_mfma_f32_16x16x32_bf16 v[28:31], a[92:95], a[152:155], v[28:31]
    v_mfma_f32_16x16x32_bf16 v[60:63], a[92:95], a[156:159], v[60:63]
    v_mfma_f32_16x16x32_bf16 v[92:95], a[92:95], a[160:163], v[92:95]
    ds_read_b64_tr_b16 a[92:93], v211 offset:24576
    ds_read_b64_tr_b16 a[94:95], v211 offset:28672
    s_waitcnt lgkmcnt(14)
    v_mfma_f32_16x16x32_bf16 v[32:35], a[96:99], a[152:155], v[32:35]
    v_mfma_f32_16x16x32_bf16 v[64:67], a[96:99], a[156:159], v[64:67]
    v_mfma_f32_16x16x32_bf16 v[96:99], a[96:99], a[160:163], v[96:99]
    ds_read_b64_tr_b16 a[96:97], v212 offset:24576
    ds_read_b64_tr_b16 a[98:99], v212 offset:28672
    s_waitcnt lgkmcnt(14)
    v_mfma_f32_16x16x32_bf16 v[36:39], a[100:103], a[152:155], v[36:39]
    v_mfma_f32_16x16x32_bf16 v[68:71], a[100:103], a[156:159], v[68:71]
    v_mfma_f32_16x16x32_bf16 v[100:103], a[100:103], a[160:163], v[100:103]
    ds_read_b64_tr_b16 a[100:101], v213 offset:24576
    ds_read_b64_tr_b16 a[102:103], v213 offset:28672
    s_waitcnt lgkmcnt(14)
    v_mfma_f32_16x16x32_bf16 v[40:43], a[104:107], a[152:155], v[40:43]
    v_mfma_f32_16x16x32_bf16 v[72:75], a[104:107], a[156:159], v[72:75]
    v_mfma_f32_16x16x32_bf16 v[104:107], a[104:107], a[160:163], v[104:107]
    ds_read_b64_tr_b16 a[104:105], v214 offset:24576
    ds_read_b64_tr_b16 a[106:107], v214 offset:28672
    s_waitcnt lgkmcnt(14)
    v_mfma_f32_16x16x32_bf16 v[44:47], a[108:111], a[152:155], v[44:47]
    v_mfma_f32_16x16x32_bf16 v[76:79], a[108:111], a[156:159], v[76:79]
    v_mfma_f32_16x16x32_bf16 v[108:111], a[108:111], a[160:163], v[108:111]
    s_waitcnt vmcnt(9)
    s_waitcnt lgkmcnt(12)
    v_mfma_f32_16x16x32_bf16 v[16:19], a[80:83], a[164:167], v[16:19]
    ds_read_b64_tr_b16 a[108:109], v215 offset:24576
    ds_read_b64_tr_b16 a[110:111], v215 offset:28672
    v_mfma_f32_16x16x32_bf16 v[48:51], a[80:83], a[168:171], v[48:51]
    v_mfma_f32_16x16x32_bf16 v[80:83], a[80:83], a[172:175], v[80:83]
    s_waitcnt lgkmcnt(12)
    v_mfma_f32_16x16x32_bf16 v[20:23], a[84:87], a[164:167], v[20:23]
    v_mfma_f32_16x16x32_bf16 v[52:55], a[84:87], a[168:171], v[52:55]
    v_mfma_f32_16x16x32_bf16 v[84:87], a[84:87], a[172:175], v[84:87]
    s_cmp_eq_u32 s92, 1
    s_cbranch_scc0 L_t24
    buffer_load_dwordx4 a[212:215], v244, s[28:31], s54 offen offset:3072 sc1
    buffer_load_dwordx4 a[216:219], v245, s[28:31], s54 offen offset:3072 sc1
    buffer_load_dwordx4 a[220:223], v246, s[28:31], s54 offen offset:3072 sc1
L_t25:
    ds_read_b64_tr_b16 a[80:81], v184 offset:0
    ds_read_b64_tr_b16 a[82:83], v184 offset:4096
    ds_read_b64_tr_b16 a[84:85], v185 offset:0
    ds_read_b64_tr_b16 a[86:87], v185 offset:4096
    s_waitcnt lgkmcnt(14)
    v_mfma_f32_16x16x32_bf16 v[24:27], a[88:91], a[164:167], v[24:27]
    v_mfma_f32_16x16x32_bf16 v[56:59], a[88:91], a[168:171], v[56:59]
    v_mfma_f32_16x16x32_bf16 v[88:91], a[88:91], a[172:175], v[88:91]
    ds_read_b64_tr_b16 a[88:89], v186 offset:0
    ds_read_b64_tr_b16 a[90:91], v186 offset:4096
    s_waitcnt lgkmcnt(14)
    v_mfma_f32_16x16x32_bf16 v[28:31], a[92:95], a[164:167], v[28:31]
    v_mfma_f32_16x16x32_bf16 v[60:63], a[92:95], a[168:171], v[60:63]
    v_mfma_f32_16x16x32_bf16 v[92:95], a[92:95], a[172:175], v[92:95]
    ds_read_b64_tr_b16 a[92:93], v187 offset:0
    ds_read_b64_tr_b16 a[94:95], v187 offset:4096
    s_waitcnt lgkmcnt(14)
    v_mfma_f32_16x16x32_bf16 v[32:35], a[96:99], a[164:167], v[32:35]
    v_mfma_f32_16x16x32_bf16 v[64:67], a[96:99], a[168:171], v[64:67]
    v_mfma_f32_16x16x32_bf16 v[96:99], a[96:99], a[172:175], v[96:99]
    ds_read_b64_tr_b16 a[96:97], v188 offset:0
    ds_read_b64_tr_b16 a[98:99], v188 offset:4096
    s_waitcnt lgkmcnt(14)
    v_mfma_f32_16x16x32_bf16 v[36:39], a[100:103], a[164:167], v[36:39]
    v_mfma_f32_16x16x32_bf16 v[68:71], a[100:103], a[168:171], v[68:71]
    v_mfma_f32_16x16x32_bf16 v[100:103], a[100:103], a[172:175], v[100:103]
    ds_read_b64_tr_b16 a[100:101], v189 offset:0
    ds_read_b64_tr_b16 a[102:103], v189 offset:4096
    s_waitcnt lgkmcnt(14)
    v_mfma_f32_16x16x32_bf16 v[40:43], a[104:107], a[164:167], v[40:43]
    v_mfma_f32_16x16x32_bf16 v[72:75], a[104:107], a[168:171], v[72:75]
    v_mfma_f32_16x16x32_bf16 v[104:107], a[104:107], a[172:175], v[104:107]
    ds_read_b64_tr_b16 a[104:105], v190 offset:0
    ds_read_b64_tr_b16 a[106:107], v190 offset:4096
    s_waitcnt lgkmcnt(14)
    v_mfma_f32_16x16x32_bf16 v[44:47], a[108:111], a[164:167], v[44:47]
    v_mfma_f32_16x16x32_bf16 v[76:79], a[108:111], a[168:171], v[76:79]
    v_mfma_f32_16x16x32_bf16 v[108:111], a[108:111], a[172:175], v[108:111]
    s_cmp_eq_u32 s92, 1
    s_cbranch_scc0 L_t27
L_t28:
    s_mov_b32 s92, 0
    v_cmp_eq_u64 vcc, s[86:87], v[242:243]
    s_nop 1
    s_and_b32 s62, vcc_lo, 0xf
    s_andn2_b32 s62, s62, s90
    s_cbranch_scc0 L_t33
    s_ff1_i32_b32 s63, s62
    s_lshl_b32 s62, 1, s63
    s_or_b32 s90, s90, s62
    s_mul_i32 s55, s63, 36864
    s_sub_u32 s63, s63, s39
    s_and_b32 s63, s63, 3
    s_sub_u32 s63, s63, 1
    s_lshl_b32 s62, s63, 15
    v_add_u32 v208, s62, v192
    v_add_u32 v209, s62, v193
    v_add_u32 v210, s62, v194
    v_add_u32 v211, s62, v195
    v_add_u32 v212, s62, v196
    v_add_u32 v213, s62, v197
    v_add_u32 v214, s62, v198
    v_add_u32 v215, s62, v199
    s_mov_b32 s92, 1
L_t33:
    s_waitcnt vmcnt(9)
    s_waitcnt lgkmcnt(12)
    v_mfma_f32_16x16x32_bf16 v[16:19], a[80:83], a[176:179], v[16:19]
    ds_read_b64_tr_b16 a[108:109], v191 offset:0
    ds_read_b64_tr_b16 a[110:111], v191 offset:4096
    v_mfma_f32_16x16x32_bf16 v[48:51], a[80:83], a[180:183], v[48:51]
    v_mfma_f32_16x16x32_bf16 v[80:83], a[80:83], a[184:187], v[80:83]
    s_waitcnt lgkmcnt(12)
    v_mfma_f32_16x16x32_bf16 v[20:23], a[84:87], a[176:179], v[20:23]
    v_mfma_f32_16x16x32_bf16 v[52:55], a[84:87], a[180:183], v[52:55]
    v_mfma_f32_16x16x32_bf16 v[84:87], a[84:87], a[184:187], v[84:87]
    s_cmp_eq_u32 s92, 1
    s_cbranch_scc0 L_t34
    buffer_load_dwordx4 a[224:227], v244, s[28:31], s55 offen offset:0 sc1
    buffer_load_dwordx4 a[228:231], v245, s[28:31], s55 offen offset:0 sc1
    buffer_load_dwordx4 a[232:235], v246, s[28:31], s55 offen offset:0 sc1
L_t35:
    ds_read_b64_tr_b16 a[80:81], v184 offset:8192
    ds_read_b64_tr_b16 a[82:83], v184 offset:12288
    ds_read_b64_tr_b16 a[84:85], v185 offset:8192
    ds_read_b64_tr_b16 a[86:87], v185 offset:12288
    s_waitcnt lgkmcnt(14)
    v_mfma_f32_16x16x32_bf16 v[24:27], a[88:91], a[176:179], v[24:27]
    v_mfma_f32_16x16x32_bf16 v[56:59], a[88:91], a[180:183], v[56:59]
    v_mfma_f32_16x16x32_bf16 v[88:91], a[88:91], a[184:187], v[88:91]
    ds_read_b64_tr_b16 a[88:89], v186 offset:8192
    ds_read_b64_tr_b16 a[90:91], v186 offset:12288
    s_waitcnt lgkmcnt(14)
    v_mfma_f32_16x16x32_bf16 v[28:31], a[92:95], a[176:179], v[28:31]
    v_mfma_f32_16x16x32_bf16 v[60:63], a[92:95], a[180:183], v[60:63]
    v_mfma_f32_16x16x32_bf16 v[92:95], a[92:95], a[184:187], v[92:95]
    ds_read_b64_tr_b16 a[92:93], v187 offset:8192
    ds_read_b64_tr_b16 a[94:95], v187 offset:12288
    s_waitcnt lgkmcnt(14)
    v_mfma_f32_16x16x32_bf16 v[32:35], a[96:99], a[176:179], v[32:35]
    v_mfma_f32_16x16x32_bf16 v[64:67], a[96:99], a[180:183], v[64:67]
    v_mfma_f32_16x16x32_bf16 v[96:99], a[96:99], a[184:187], v[96:99]
    ds_read_b64_tr_b16 a[96:97], v188 offset:8192
    ds_read_b64_tr_b16 a[98:99], v188 offset:12288
    s_waitcnt lgkmcnt(14)
    v_mfma_f32_16x16x32_bf16 v[36:39], a[100:103], a[176:179], v[36:39]
    v_mfma_f32_16x16x32_bf16 v[68:71], a[100:103], a[180:183], v[68:71]
    v_mfma_f32_16x16x32_bf16 v[100:103], a[100:103], a[184:187], v[100:103]
    ds_read_b64_tr_b16 a[100:101], v189 offset:8192
    ds_read_b64_tr_b16 a[102:103], v189 offset:12288
    s_waitcnt lgkmcnt(14)
    v_mfma_f32_16x16x32_bf16 v[40:43], a[104:107], a[176:179], v[40:43]
    v_mfma_f32_16x16x32_bf16 v[72:75], a[104:107], a[180:183], v[72:75]
    v_mfma_f32_16x16x32_bf16 v[104:107], a[104:107], a[184:187], v[104:107]
    ds_read_b64_tr_b16 a[104:105], v190 offset:8192
    ds_read_b64_tr_b16 a[106:107], v190 offset:12288
    s_waitcnt lgkmcnt(14)
    v_mfma_f32_16x16x32_bf16 v[44:47], a[108:111], a[176:179], v[44:47]
    v_mfma_f32_16x16x32_bf16 v[76:79], a[108:111], a[180:183], v[76:79]
    v_mfma_f32_16x16x32_bf16 v[108:111], a[108:111], a[184:187], v[108:111]
    s_waitcnt vmcnt(9)
    s_waitcnt lgkmcnt(12)
    v_mfma_f32_16x16x32_bf16 v[16:19], a[80:83], a[188:191], v[16:19]
    ds_read_b64_tr_b16 a[108:109], v191 offset:8192
    ds_read_b64_tr_b16 a[110:111], v191 offset:12288
    v_mfma_f32_16x16x32_bf16 v[48:51], a[80:83], a[192:195], v[48:51]
    v_mfma_f32_16x16x32_bf16 v[80:83], a[80:83], a[196:199], v[80:83]
    s_waitcnt lgkmcnt(12)
    v_mfma_f32_16x16x32_bf16 v[20:23], a[84:87], a[188:191], v[20:23]
    v_mfma_f32_16x16x32_bf16 v[52:55], a[84:87], a[192:195], v[52:55]
    v_mfma_f32_16x16x32_bf16 v[84:87], a[84:87], a[196:199], v[84:87]
    s_cmp_eq_u32 s92, 1
    s_cbranch_scc0 L_t36
    buffer_load_dwordx4 a[236:239], v244, s[28:31], s55 offen offset:1024 sc1
    buffer_load_dwordx4 a[240:243], v245, s[28:31], s55 offen offset:1024 sc1
    buffer_load_dwordx4 a[244:247], v246, s[28:31], s55 offen offset:1024 sc1
L_t37:
    ds_read_b64_tr_b16 a[80:81], v184 offset:16384
    ds_read_b64_tr_b16 a[82:83], v184 offset:20480
    ds_read_b64_tr_b16 a[84:85], v185 offset:16384
    ds_read_b64_tr_b16 a[86:87], v185 offset:20480
    s_waitcnt lgkmcnt(14)
    v_mfma_f32_16x16x32_bf16 v[24:27], a[88:91], a[188:191], v[24:27]
    v_mfma_f32_16x16x32_bf16 v[56:59], a[88:91], a[192:195], v[56:59]
    v_mfma_f32_16x16x32_bf16 v[88:91], a[88:91], a[196:199], v[88:91]
    ds_read_b64_tr_b16 a[88:89], v186 offset:16384
    ds_read_b64_tr_b16 a[90:91], v186 offset:20480
    s_waitcnt lgkmcnt(14)
    v_mfma_f32_16x16x32_bf16 v[28:31], a[92:95], a[188:191], v[28:31]
    v_mfma_f32_16x16x32_bf16 v[60:63], a[92:95], a[192:195], v[60:63]
    v_mfma_f32_16x16x32_bf16 v[92:95], a[92:95], a[196:199], v[92:95]
    ds_read_b64_tr_b16 a[92:93], v187 offset:16384
    ds_read_b64_tr_b16 a[94:95], v187 offset:20480
    s_waitcnt lgkmcnt(14)
    v_mfma_f32_16x16x32_bf16 v[32:35], a[96:99], a[188:191], v[32:35]
    v_mfma_f32_16x16x32_bf16 v[64:67], a[96:99], a[192:195], v[64:67]
    v_mfma_f32_16x16x32_bf16 v[96:99], a[96:99], a[196:199], v[96:99]
    ds_read_b64_tr_b16 a[96:97], v188 offset:16384
    ds_read_b64_tr_b16 a[98:99], v188 offset:20480
    s_waitcnt lgkmcnt(14)
    v_mfma_f32_16x16x32_bf16 v[36:39], a[100:103], a[188:191], v[36:39]
    v_mfma_f32_16x16x32_bf16 v[68:71], a[100:103], a[192:195], v[68:71]
    v_mfma_f32_16x16x32_bf16 v[100:103], a[100:103], a[196:199], v[100:103]
    ds_read_b64_tr_b16 a[100:101], v189 offset:16384
    ds_read_b64_tr_b16 a[102:103], v189 offset:20480
    s_waitcnt lgkmcnt(14)
    v_mfma_f32_16x16x32_bf16 v[40:43], a[104:107], a[188:191], v[40:43]
    v_mfma_f32_16x16x32_bf16 v[72:75], a[104:107], a[192:195], v[72:75]
    v_mfma_f32_16x16x32_bf16 v[104:107], a[104:107], a[196:199], v[104:107]
    ds_read_b64_tr_b16 a[104:105], v190 offset:16384
    ds_read_b64_tr_b16 a[106:107], v190 offset:20480
    s_waitcnt lgkmcnt(14)
    v_mfma_f32_16x16x32_bf16 v[44:47], a[108:111], a[188:191], v[44:47]
    v_mfma_f32_16x16x32_bf16 v[76:79], a[108:111], a[192:195], v[76:79]
    v_mfma_f32_16x16x32_bf16 v[108:111], a[108:111], a[196:199], v[108:111]
    s_waitcnt vmcnt(9)
    s_waitcnt lgkmcnt(12)
    v_mfma_f32_16x16x32_bf16 v[16:19], a[80:83], a[200:203], v[16:19]
    ds_read_b64_tr_b16 a[108:109], v191 offset:16384
    ds_read_b64_tr_b16 a[110:111], v191 offset:20480
    v_mfma_f32_16x16x32_bf16 v[48:51], a[80:83], a[204:207], v[48:51]
    v_mfma_f32_16x16x32_bf16 v[80:83], a[80:83], a[208:211], v[80:83]
    s_waitcnt lgkmcnt(12)
    v_mfma_f32_16x16x32_bf16 v[20:23], a[84:87], a[200:203], v[20:23]
    v_mfma_f32_16x16x32_bf16 v[52:55], a[84:87], a[204:207], v[52:55]
    v_mfma_f32_16x16x32_bf16 v[84:87], a[84:87], a[208:211], v[84:87]
    s_cmp_eq_u32 s92, 1
    s_cbranch_scc0 L_t38
    buffer_load_dwordx4 a[248:251], v244, s[28:31], s55 offen offset:2048 sc1
    buffer_load_dwordx4 a[252:255], v245, s[28:31], s55 offen offset:2048 sc1
    buffer_load_dwordx4 v[224:227], v246, s[28:31], s55 offen offset:2048 sc1
L_t39:
    ds_read_b64_tr_b16 a[80:81], v184 offset:24576
    ds_read_b64_tr_b16 a[82:83], v184 offset:28672
    ds_read_b64_tr_b16 a[84:85], v185 offset:24576
    ds_read_b64_tr_b16 a[86:87], v185 offset:28672
    s_waitcnt lgkmcnt(14)
    v_mfma_f32_16x16x32_bf16 v[24:27], a[88:91], a[200:203], v[24:27]
    v_mfma_f32_16x16x32_bf16 v[56:59], a[88:91], a[204:207], v[56:59]
    v_mfma_f32_16x16x32_bf16 v[88:91], a[88:91], a[208:211], v[88:91]
    ds_read_b64_tr_b16 a[88:89], v186 offset:24576
    ds_read_b64_tr_b16 a[90:91], v186 offset:28672
    s_waitcnt lgkmcnt(14)
    v_mfma_f32_16x16x32_bf16 v[28:31], a[92:95], a[200:203], v[28:31]
    v_mfma_f32_16x16x32_bf16 v[60:63], a[92:95], a[204:207], v[60:63]
    v_mfma_f32_16x16x32_bf16 v[92:95], a[92:95], a[208:211], v[92:95]
    ds_read_b64_tr_b16 a[92:93], v187 offset:24576
    ds_read_b64_tr_b16 a[94:95], v187 offset:28672
    s_waitcnt lgkmcnt(14)
    v_mfma_f32_16x16x32_bf16 v[32:35], a[96:99], a[200:203], v[32:35]
    v_mfma_f32_16x16x32_bf16 v[64:67], a[96:99], a[204:207], v[64:67]
    v_mfma_f32_16x16x32_bf16 v[96:99], a[96:99], a[208:211], v[96:99]
    ds_read_b64_tr_b16 a[96:97], v188 offset:24576
    ds_read_b64_tr_b16 a[98:99], v188 offset:28672
    s_waitcnt lgkmcnt(14)
    v_mfma_f32_16x16x32_bf16 v[36:39], a[100:103], a[200:203], v[36:39]
    v_mfma_f32_16x16x32_bf16 v[68:71], a[100:103], a[204:207], v[68:71]
    v_mfma_f32_16x16x32_bf16 v[100:103], a[100:103], a[208:211], v[100:103]
    ds_read_b64_tr_b16 a[100:101], v189 offset:24576
    ds_read_b64_tr_b16 a[102:103], v189 offset:28672
    s_waitcnt lgkmcnt(14)
    v_mfma_f32_16x16x32_bf16 v[40:43], a[104:107], a[200:203], v[40:43]
    v_mfma_f32_16x16x32_bf16 v[72:75], a[104:107], a[204:207], v[72:75]
    v_mfma_f32_16x16x32_bf16 v[104:107], a[104:107], a[208:211], v[104:107]
    ds_read_b64_tr_b16 a[104:105], v190 offset:24576
    ds_read_b64_tr_b16 a[106:107], v190 offset:28672
    s_waitcnt lgkmcnt(14)
    v_mfma_f32_16x16x32_bf16 v[44:47], a[108:111], a[200:203], v[44:47]
    v_mfma_f32_16x16x32_bf16 v[76:79], a[108:111], a[204:207], v[76:79]
    v_mfma_f32_16x16x32_bf16 v[108:111], a[108:111], a[208:211], v[108:111]
    s_waitcnt vmcnt(9)
    s_waitcnt lgkmcnt(12)
    v_mfma_f32_16x16x32_bf16 v[16:19], a[80:83], a[212:215], v[16:19]
    ds_read_b64_tr_b16 a[108:109], v191 offset:24576
    ds_read_b64_tr_b16 a[110:111], v191 offset:28672
    v_mfma_f32_16x16x32_bf16 v[48:51], a[80:83], a[216:219], v[48:51]
    v_mfma_f32_16x16x32_bf16 v[80:83], a[80:83], a[220:223], v[80:83]
    s_waitcnt lgkmcnt(12)
    v_mfma_f32_16x16x32_bf16 v[20:23], a[84:87], a[212:215], v[20:23]
    v_mfma_f32_16x16x32_bf16 v[52:55], a[84:87], a[216:219], v[52:55]
    v_mfma_f32_16x16x32_bf16 v[84:87], a[84:87], a[220:223], v[84:87]
    s_cmp_eq_u32 s92, 1
    s_cbranch_scc0 L_t40
    buffer_load_dwordx4 v[228:231], v244, s[28:31], s55 offen offset:3072 sc1
    buffer_load_dwordx4 v[232:235], v245, s[28:31], s55 offen offset:3072 sc1
    buffer_load_dwordx4 v[236:239], v246, s[28:31], s55 offen offset:3072 sc1
L_t41:
    ds_read_b64_tr_b16 a[80:81], v208 offset:0
    ds_read_b64_tr_b16 a[82:83], v208 offset:4096
    ds_read_b64_tr_b16 a[84:85], v208 offset:8192
    ds_read_b64_tr_b16 a[86:87], v208 offset:12288
    s_waitcnt lgkmcnt(14)
    v_mfma_f32_16x16x32_bf16 v[24:27], a[88:91], a[212:215], v[24:27]
    v_mfma_f32_16x16x32_bf16 v[56:59], a[88:91], a[216:219], v[56:59]
    v_mfma_f32_16x16x32_bf16 v[88:91], a[88:91], a[220:223], v[88:91]
    ds_read_b64_tr_b16 a[88:89], v208 offset:16384
    ds_read_b64_tr_b16 a[90:91], v208 offset:20480
    s_waitcnt lgkmcnt(14)
    v_mfma_f32_16x16x32_bf16 v[28:31], a[92:95], a[212:215], v[28:31]
    v_mfma_f32_16x16x32_bf16 v[60:63], a[92:95], a[216:219], v[60:63]
    v_mfma_f32_16x16x32_bf16 v[92:95], a[92:95], a[220:223], v[92:95]
    ds_read_b64_tr_b16 a[92:93], v208 offset:24576
    ds_read_b64_tr_b16 a[94:95], v208 offset:28672
    s_waitcnt lgkmcnt(14)
    v_mfma_f32_16x16x32_bf16 v[32:35], a[96:99], a[212:215], v[32:35]
    v_mfma_f32_16x16x32_bf16 v[64:67], a[96:99], a[216:219], v[64:67]
    v_mfma_f32_16x16x32_bf16 v[96:99], a[96:99], a[220:223], v[96:99]
    ds_read_b64_tr_b16 a[96:97], v209 offset:0
    ds_read_b64_tr_b16 a[98:99], v209 offset:4096
    s_waitcnt lgkmcnt(14)
    v_mfma_f32_16x16x32_bf16 v[36:39], a[100:103], a[212:215], v[36:39]
    v_mfma_f32_16x16x32_bf16 v[68:71], a[100:103], a[216:219], v[68:71]
    v_mfma_f32_16x16x32_bf16 v[100:103], a[100:103], a[220:223], v[100:103]
    ds_read_b64_tr_b16 a[100:101], v209 offset:8192
    ds_read_b64_tr_b16 a[102:103], v209 offset:12288
    s_waitcnt lgkmcnt(14)
    v_mfma_f32_16x16x32_bf16 v[40:43], a[104:107], a[212:215], v[40:43]
    v_mfma_f32_16x16x32_bf16 v[72:75], a[104:107], a[216:219], v[72:75]
    v_mfma_f32_16x16x32_bf16 v[104:107], a[104:107], a[220:223], v[104:107]
    ds_read_b64_tr_b16 a[104:105], v209 offset:16384
    ds_read_b64_tr_b16 a[106:107], v209 offset:20480
    s_waitcnt lgkmcnt(14)
    v_mfma_f32_16x16x32_bf16 v[44:47], a[108:111], a[212:215], v[44:47]
    v_mfma_f32_16x16x32_bf16 v[76:79], a[108:111], a[216:219], v[76:79]
    v_mfma_f32_16x16x32_bf16 v[108:111], a[108:111], a[220:223], v[108:111]
    s_lshl_b32 s44, s37, 2
    s_add_u32 s44, s44, s39
    s_lshl_b32 s44, s44, 3
    s_add_u32 s45, s44, s40
    s_mul_i32 s45, s45, 36864
    s_mul_i32 s48, s36, 1536
    s_add_u32 s45, s45, s48
    s_add_u32 s45, s45, 9437184
    s_add_u32 s46, s18, s45
    s_addc_u32 s47, s19, 0
    v_lshlrev_b32 v1, 4, v0
    v_lshlrev_b32 v3, 3, v0
    v_add_u32 v3, 1024, v3
    ds_read_b64_tr_b16 a[108:109], v209 offset:24576
    ds_read_b64_tr_b16 a[110:111], v209 offset:28672
    s_cmp_eq_u32 s92, 1
    s_cbranch_scc0 L_t43
L_t44:
    s_waitcnt vmcnt(0)
    s_waitcnt lgkmcnt(14)
    v_mfma_f32_16x16x32_bf16 v[16:19], a[80:83], a[224:227], v[16:19]
    v_mfma_f32_16x16x32_bf16 v[48:51], a[80:83], a[228:231], v[48:51]
    v_mfma_f32_16x16x32_bf16 v[80:83], a[80:83], a[232:235], v[80:83]
    ds_read_b64_tr_b16 a[80:81], v210 offset:0
    ds_read_b64_tr_b16 a[82:83], v210 offset:4096
    s_waitcnt lgkmcnt(14)
    v_mfma_f32_16x16x32_bf16 v[16:19], a[84:87], a[236:239], v[16:19]
    v_mfma_f32_16x16x32_bf16 v[48:51], a[84:87], a[240:243], v[48:51]
    v_mfma_f32_16x16x32_bf16 v[80:83], a[84:87], a[244:247], v[80:83]
    ds_read_b64_tr_b16 a[84:85], v210 offset:8192
    ds_read_b64_tr_b16 a[86:87], v210 offset:12288
    s_waitcnt lgkmcnt(14)
    v_mfma_f32_16x16x32_bf16 v[16:19], a[88:91], a[248:251], v[16:19]
    v_mfma_f32_16x16x32_bf16 v[48:51], a[88:91], a[252:255], v[48:51]
    v_mfma_f32_16x16x32_bf16 v[80:83], a[88:91], v[224:227], v[80:83]
    ds_read_b64_tr_b16 a[88:89], v210 offset:16384
    ds_read_b64_tr_b16 a[90:91], v210 offset:20480
    s_waitcnt lgkmcnt(14)
    v_mfma_f32_16x16x32_bf16 v[16:19], a[92:95], v[228:231], v[16:19]
    v_mfma_f32_16x16x32_bf16 v[48:51], a[92:95], v[232:235], v[48:51]
    v_mfma_f32_16x16x32_bf16 v[80:83], a[92:95], v[236:239], v[80:83]
    ds_read_b64_tr_b16 a[92:93], v210 offset:24576
    ds_read_b64_tr_b16 a[94:95], v210 offset:28672
    s_waitcnt lgkmcnt(14)
    v_mfma_f32_16x16x32_bf16 v[20:23], a[96:99], a[224:227], v[20:23]
    v_mfma_f32_16x16x32_bf16 v[52:55], a[96:99], a[228:231], v[52:55]
    v_mfma_f32_16x16x32_bf16 v[84:87], a[96:99], a[232:235], v[84:87]
    ds_read_b64_tr_b16 a[96:97], v211 offset:0
    ds_read_b64_tr_b16 a[98:99], v211 offset:4096
    s_waitcnt lgkmcnt(14)
    v_mfma_f32_16x16x32_bf16 v[20:23], a[100:103], a[236:239], v[20:23]
    v_mfma_f32_16x16x32_bf16 v[52:55], a[100:103], a[240:243], v[52:55]
    v_mfma_f32_16x16x32_bf16 v[84:87], a[100:103], a[244:247], v[84:87]
    ds_read_b64_tr_b16 a[100:101], v211 offset:8192
    ds_read_b64_tr_b16 a[102:103], v211 offset:12288
    s_waitcnt lgkmcnt(14)
    v_mfma_f32_16x16x32_bf16 v[20:23], a[104:107], a[248:251], v[20:23]
    v_mfma_f32_16x16x32_bf16 v[52:55], a[104:107], a[252:255], v[52:55]
    v_mfma_f32_16x16x32_bf16 v[84:87], a[104:107], v[224:227], v[84:87]
    ds_read_b64_tr_b16 a[104:105], v211 offset:16384
    ds_read_b64_tr_b16 a[106:107], v211 offset:20480
    v_cvt_pk_bf16_f32 v112, v16, v17
    v_cvt_pk_bf16_f32 v113, v18, v19
    v_cvt_pk_bf16_f32 v114, v48, v49
    v_cvt_pk_bf16_f32 v115, v50, v51
    v_cvt_pk_bf16_f32 v116, v80, v81
    v_cvt_pk_bf16_f32 v117, v82, v83
    global_store_dwordx4 v1, v[112:115], s[46:47] sc1
    global_store_dwordx2 v3, v[116:117], s[46:47] sc1
    v_add_u32 v1, 4608, v1
    v_add_u32 v3, 4608, v3
    s_waitcnt lgkmcnt(14)
    v_mfma_f32_16x16x32_bf16 v[20:23], a[108:111], v[228:231], v[20:23]
    v_mfma_f32_16x16x32_bf16 v[52:55], a[108:111], v[232:235], v[52:55]
    v_mfma_f32_16x16x32_bf16 v[84:87], a[108:111], v[236:239], v[84:87]
    ds_read_b64_tr_b16 a[108:109], v211 offset:24576
    ds_read_b64_tr_b16 a[110:111], v211 offset:28672
    s_waitcnt lgkmcnt(14)
    v_mfma_f32_16x16x32_bf16 v[24:27], a[80:83], a[224:227], v[24:27]
    v_mfma_f32_16x16x32_bf16 v[56:59], a[80:83], a[228:231], v[56:59]
    v_mfma_f32_16x16x32_bf16 v[88:91], a[80:83], a[232:235], v[88:91]
    ds_read_b64_tr_b16 a[80:81], v212 offset:0
    ds_read_b64_tr_b16 a[82:83], v212 offset:4096
    s_waitcnt lgkmcnt(14)
    v_mfma_f32_16x16x32_bf16 v[24:27], a[84:87], a[236:239], v[24:27]
    v_mfma_f32_16x16x32_bf16 v[56:59], a[84:87], a[240:243], v[56:59]
    v_mfma_f32_16x16x32_bf16 v[88:91], a[84:87], a[244:247], v[88:91]
    ds_read_b64_tr_b16 a[84:85], v212 offset:8192
    ds_read_b64_tr_b16 a[86:87], v212 offset:12288
    s_waitcnt lgkmcnt(14)
    v_mfma_f32_16x16x32_bf16 v[24:27], a[88:91], a[248:251], v[24:27]
    v_mfma_f32_16x16x32_bf16 v[56:59], a[88:91], a[252:255], v[56:59]
    v_mfma_f32_16x16x32_bf16 v[88:91], a[88:91], v[224:227], v[88:91]
    ds_read_b64_tr_b16 a[88:89], v212 offset:16384
    ds_read_b64_tr_b16 a[90:91], v212 offset:20480
    v_cvt_pk_bf16_f32 v120, v20, v21
    v_cvt_pk_bf16_f32 v121, v22, v23
    v_cvt_pk_bf16_f32 v122, v52, v53
    v_cvt_pk_bf16_f32 v123, v54, v55
    v_cvt_pk_bf16_f32 v124, v84, v85
    v_cvt_pk_bf16_f32 v125, v86, v87
    global_store_dwordx4 v1, v[120:123], s[46:47] sc1
    global_store_dwordx2 v3, v[124:125], s[46:47] sc1
    v_add_u32 v1, 4608, v1
    v_add_u32 v3, 4608, v3
    s_waitcnt lgkmcnt(14)
    v_mfma_f32_16x16x32_bf16 v[24:27], a[92:95], v[228:231], v[24:27]
    v_mfma_f32_16x16x32_bf16 v[56:59], a[92:95], v[232:235], v[56:59]
    v_mfma_f32_16x16x32_bf16 v[88:91], a[92:95], v[236:239], v[88:91]
    ds_read_b64_tr_b16 a[92:93], v212 offset:24576
    ds_read_b64_tr_b16 a[94:95], v212 offset:28672
    s_waitcnt lgkmcnt(14)
    v_mfma_f32_16x16x32_bf16 v[28:31], a[96:99], a[224:227], v[28:31]
    v_mfma_f32_16x16x32_bf16 v[60:63], a[96:99], a[228:231], v[60:63]
    v_mfma_f32_16x16x32_bf16 v[92:95], a[96:99], a[232:235], v[92:95]
    ds_read_b64_tr_b16 a[96:97], v213 offset:0
    ds_read_b64_tr_b16 a[98:99], v213 offset:4096
    s_waitcnt lgkmcnt(14)
    v_mfma_f32_16x16x32_bf16 v[28:31], a[100:103], a[236:239], v[28:31]
    v_mfma_f32_16x16x32_bf16 v[60:63], a[100:103], a[240:243], v[60:63]
    v_mfma_f32_16x16x32_bf16 v[92:95], a[100:103], a[244:247], v[92:95]
    ds_read_b64_tr_b16 a[100:101], v213 offset:8192
    ds_read_b64_tr_b16 a[102:103], v213 offset:12288
    s_waitcnt lgkmcnt(14)
    v_mfma_f32_16x16x32_bf16 v[28:31], a[104:107], a[248:251], v[28:31]
    v_mfma_f32_16x16x32_bf16 v[60:63], a[104:107], a[252:255], v[60:63]
    v_mfma_f32_16x16x32_bf16 v[92:95], a[104:107], v[224:227], v[92:95]
    ds_read_b64_tr_b16 a[104:105], v213 offset:16384
    ds_read_b64_tr_b16 a[106:107], v213 offset:20480
    v_cvt_pk_bf16_f32 v112, v24, v25
    v_cvt_pk_bf16_f32 v113, v26, v27
    v_cvt_pk_bf16_f32 v114, v56, v57
    v_cvt_pk_bf16_f32 v115, v58, v59
    v_cvt_pk_bf16_f32 v116, v88, v89
    v_cvt_pk_bf16_f32 v117, v90, v91
    global_store_dwordx4 v1, v[112:115], s[46:47] sc1
    global_store_dwordx2 v3, v[116:117], s[46:47] sc1
    v_add_u32 v1, 4608, v1
    v_add_u32 v3, 4608, v3
    s_waitcnt lgkmcnt(14)
    v_mfma_f32_16x16x32_bf16 v[28:31], a[108:111], v[228:231], v[28:31]
    v_mfma_f32_16x16x32_bf16 v[60:63], a[108:111], v[232:235], v[60:63]
    v_mfma_f32_16x16x32_bf16 v[92:95], a[108:111], v[236:239], v[92:95]
    ds_read_b64_tr_b16 a[108:109], v213 offset:24576
    ds_read_b64_tr_b16 a[110:111], v213 offset:28672
    s_waitcnt lgkmcnt(14)
    v_mfma_f32_16x16x32_bf16 v[32:35], a[80:83], a[224:227], v[32:35]
    v_mfma_f32_16x16x32_bf16 v[64:67], a[80:83], a[228:231], v[64:67]
    v_mfma_f32_16x16x32_bf16 v[96:99], a[80:83], a[232:235], v[96:99]
    ds_read_b64_tr_b16 a[80:81], v214 offset:0
    ds_read_b64_tr_b16 a[82:83], v214 offset:4096
    s_waitcnt lgkmcnt(14)
    v_mfma_f32_16x16x32_bf16 v[32:35], a[84:87], a[236:239], v[32:35]
    v_mfma_f32_16x16x32_bf16 v[64:67], a[84:87], a[240:243], v[64:67]
    v_mfma_f32_16x16x32_bf16 v[96:99], a[84:87], a[244:247], v[96:99]
    ds_read_b64_tr_b16 a[84:85], v214 offset:8192
    ds_read_b64_tr_b16 a[86:87], v214 offset:12288
    s_waitcnt lgkmcnt(14)
    v_mfma_f32_16x16x32_bf16 v[32:35], a[88:91], a[248:251], v[32:35]
    v_mfma_f32_16x16x32_bf16 v[64:67], a[88:91], a[252:255], v[64:67]
    v_mfma_f32_16x16x32_bf16 v[96:99], a[88:91], v[224:227], v[96:99]
    ds_read_b64_tr_b16 a[88:89], v214 offset:16384
    ds_read_b64_tr_b16 a[90:91], v214 offset:20480
    v_cvt_pk_bf16_f32 v120, v28, v29
    v_cvt_pk_bf16_f32 v121, v30, v31
    v_cvt_pk_bf16_f32 v122, v60, v61
    v_cvt_pk_bf16_f32 v123, v62, v63
    v_cvt_pk_bf16_f32 v124, v92, v93
    v_cvt_pk_bf16_f32 v125, v94, v95
    global_store_dwordx4 v1, v[120:123], s[46:47] sc1
    global_store_dwordx2 v3, v[124:125], s[46:47] sc1
    v_add_u32 v1, 4608, v1
    v_add_u32 v3, 4608, v3
    s_waitcnt lgkmcnt(14)
    v_mfma_f32_16x16x32_bf16 v[32:35], a[92:95], v[228:231], v[32:35]
    v_mfma_f32_16x16x32_bf16 v[64:67], a[92:95], v[232:235], v[64:67]
    v_mfma_f32_16x16x32_bf16 v[96:99], a[92:95], v[236:239], v[96:99]
    ds_read_b64_tr_b16 a[92:93], v214 offset:24576
    ds_read_b64_tr_b16 a[94:95], v214 offset:28672
    s_waitcnt lgkmcnt(14)
    v_mfma_f32_16x16x32_bf16 v[36:39], a[96:99], a[224:227], v[36:39]
    v_mfma_f32_16x16x32_bf16 v[68:71], a[96:99], a[228:231], v[68:71]
    v_mfma_f32_16x16x32_bf16 v[100:103], a[96:99], a[232:235], v[100:103]
    ds_read_b64_tr_b16 a[96:97], v215 offset:0
    ds_read_b64_tr_b16 a[98:99], v215 offset:4096
    s_waitcnt lgkmcnt(14)
    v_mfma_f32_16x16x32_bf16 v[36:39], a[100:103], a[236:239], v[36:39]
    v_mfma_f32_16x16x32_bf16 v[68:71], a[100:103], a[240:243], v[68:71]
    v_mfma_f32_16x16x32_bf16 v[100:103], a[100:103], a[244:247], v[100:103]
    ds_read_b64_tr_b16 a[100:101], v215 offset:8192
    ds_read_b64_tr_b16 a[102:103], v215 offset:12288
    s_waitcnt lgkmcnt(14)
    v_mfma_f32_16x16x32_bf16 v[36:39], a[104:107], a[248:251], v[36:39]
    v_mfma_f32_16x16x32_bf16 v[68:71], a[104:107], a[252:255], v[68:71]
    v_mfma_f32_16x16x32_bf16 v[100:103], a[104:107], v[224:227], v[100:103]
    ds_read_b64_tr_b16 a[104:105], v215 offset:16384
    ds_read_b64_tr_b16 a[106:107], v215 offset:20480
    v_cvt_pk_bf16_f32 v112, v32, v33
    v_cvt_pk_bf16_f32 v113, v34, v35
    v_cvt_pk_bf16_f32 v114, v64, v65
    v_cvt_pk_bf16_f32 v115, v66, v67
    v_cvt_pk_bf16_f32 v116, v96, v97
    v_cvt_pk_bf16_f32 v117, v98, v99
    global_store_dwordx4 v1, v[112:115], s[46:47] sc1
    global_store_dwordx2 v3, v[116:117], s[46:47] sc1
    v_add_u32 v1, 4608, v1
    v_add_u32 v3, 4608, v3
    s_waitcnt lgkmcnt(14)
    v_mfma_f32_16x16x32_bf16 v[36:39], a[108:111], v[228:231], v[36:39]
    v_mfma_f32_16x16x32_bf16 v[68:71], a[108:111], v[232:235], v[68:71]
    v_mfma_f32_16x16x32_bf16 v[100:103], a[108:111], v[236:239], v[100:103]
    ds_read_b64_tr_b16 a[108:109], v215 offset:24576
    ds_read_b64_tr_b16 a[110:111], v215 offset:28672
    s_waitcnt lgkmcnt(14)
    v_mfma_f32_16x16x32_bf16 v[40:43], a[80:83], a[224:227], v[40:43]
    v_mfma_f32_16x16x32_bf16 v[72:75], a[80:83], a[228:231], v[72:75]
    v_mfma_f32_16x16x32_bf16 v[104:107], a[80:83], a[232:235], v[104:107]
    s_waitcnt lgkmcnt(12)
    v_mfma_f32_16x16x32_bf16 v[40:43], a[84:87], a[236:239], v[40:43]
    v_mfma_f32_16x16x32_bf16 v[72:75], a[84:87], a[240:243], v[72:75]
    v_mfma_f32_16x16x32_bf16 v[104:107], a[84:87], a[244:247], v[104:107]
    s_waitcnt lgkmcnt(10)
    v_mfma_f32_16x16x32_bf16 v[40:43], a[88:91], a[248:251], v[40:43]
    v_mfma_f32_16x16x32_bf16 v[72:75], a[88:91], a[252:255], v[72:75]
    v_mfma_f32_16x16x32_bf16 v[104:107], a[88:91], v[224:227], v[104:107]
    v_cvt_pk_bf16_f32 v120, v36, v37
    v_cvt_pk_bf16_f32 v121, v38, v39
    v_cvt_pk_bf16_f32 v122, v68, v69
    v_cvt_pk_bf16_f32 v123, v70, v71
    v_cvt_pk_bf16_f32 v124, v100, v101
    v_cvt_pk_bf16_f32 v125, v102, v103
    global_store_dwordx4 v1, v[120:123], s[46:47] sc1
    global_store_dwordx2 v3, v[124:125], s[46:47] sc1
    v_add_u32 v1, 4608, v1
    v_add_u32 v3, 4608, v3
    s_waitcnt lgkmcnt(8)
    v_mfma_f32_16x16x32_bf16 v[40:43], a[92:95], v[228:231], v[40:43]
    v_mfma_f32_16x16x32_bf16 v[72:75], a[92:95], v[232:235], v[72:75]
    v_mfma_f32_16x16x32_bf16 v[104:107], a[92:95], v[236:239], v[104:107]
    s_waitcnt lgkmcnt(6)
    v_mfma_f32_16x16x32_bf16 v[44:47], a[96:99], a[224:227], v[44:47]
    v_mfma_f32_16x16x32_bf16 v[76:79], a[96:99], a[228:231], v[76:79]
    v_mfma_f32_16x16x32_bf16 v[108:111], a[96:99], a[232:235], v[108:111]
    s_waitcnt lgkmcnt(4)
    v_mfma_f32_16x16x32_bf16 v[44:47], a[100:103], a[236:239], v[44:47]
    v_mfma_f32_16x16x32_bf16 v[76:79], a[100:103], a[240:243], v[76:79]
    v_mfma_f32_16x16x32_bf16 v[108:111], a[100:103], a[244:247], v[108:111]
    s_waitcnt lgkmcnt(2)
    v_mfma_f32_16x16x32_bf16 v[44:47], a[104:107], a[248:251], v[44:47]
    v_mfma_f32_16x16x32_bf16 v[76:79], a[104:107], a[252:255], v[76:79]
    v_mfma_f32_16x16x32_bf16 v[108:111], a[104:107], v[224:227], v[108:111]
    v_cvt_pk_bf16_f32 v112, v40, v41
    v_cvt_pk_bf16_f32 v113, v42, v43
    v_cvt_pk_bf16_f32 v114, v72, v73
    v_cvt_pk_bf16_f32 v115, v74, v75
    v_cvt_pk_bf16_f32 v116, v104, v105
    v_cvt_pk_bf16_f32 v117, v106, v107
    global_store_dwordx4 v1, v[112:115], s[46:47] sc1
    global_store_dwordx2 v3, v[116:117], s[46:47] sc1
    v_add_u32 v1, 4608, v1
    v_add_u32 v3, 4608, v3
    s_waitcnt lgkmcnt(0)
    v_mfma_f32_16x16x32_bf16 v[44:47], a[108:111], v[228:231], v[44:47]
    v_mfma_f32_16x16x32_bf16 v[76:79], a[108:111], v[232:235], v[76:79]
    v_mfma_f32_16x16x32_bf16 v[108:111], a[108:111], v[236:239], v[108:111]
    s_nop 7
    v_cvt_pk_bf16_f32 v120, v44, v45
    v_cvt_pk_bf16_f32 v121, v46, v47
    v_cvt_pk_bf16_f32 v122, v76, v77
    v_cvt_pk_bf16_f32 v123, v78, v79
    v_cvt_pk_bf16_f32 v124, v108, v109
    v_cvt_pk_bf16_f32 v125, v110, v111
    global_store_dwordx4 v1, v[120:123], s[46:47] sc1
    global_store_dwordx2 v3, v[124:125], s[46:47] sc1
    s_lshl_b32 s45, s37, 5
    s_lshl_b32 s49, s39, 3
    s_add_u32 s45, s45, s49
    s_mul_i32 s45, s45, 768
    s_lshl_b32 s49, s36, 8
    s_add_u32 s45, s45, s49
    s_lshl_b32 s49, s40, 3
    s_add_u32 s45, s45, s49
    s_add_u32 s45, s45, 33554560
    s_mov_b32 s49, 768
    v_mul_lo_u32 v2, s49, v0
    v_add_u32 v2, s45, v2
    s_mul_i32 s44, s44, 36864
    s_mul_i32 s45, s40, 4608
    s_add_u32 s44, s44, s45
    s_add_u32 s44, s44, s48
    s_add_u32 s44, s44, 9437184
    s_add_u32 s20, s18, s44
    s_addc_u32 s21, s19, 0
    s_and_b32 s21, s21, 0xffff
    s_mov_b32 s22, 294912
    s_mov_b32 s23, 0x20000
    v_and_b32 v13, 7, v0
    v_lshlrev_b32 v13, 3, v13
    v_add_u32 v13, 128, v13
    v_lshlrev_b32 v1, 4, v0
    v_lshlrev_b32 v3, 3, v0
    v_add_u32 v3, 1024, v3
    v_lshrrev_b32 v4, 4, v0
    v_bfe_u32 v5, v0, 2, 2
    v_and_b32 v6, 3, v0
    v_cmp_eq_u32 vcc, v4, v5
    v_mov_b32 v7, 0x3f80
    v_and_b32 v8, 1, v6
    v_lshlrev_b32 v8, 4, v8
    v_lshlrev_b32 v7, v8, v7
    v_cndmask_b32 v7, 0, v7, vcc
    v_lshrrev_b32 v8, 1, v6
    v_cmp_eq_u32 vcc, 0, v8
    v_mov_b32 v130, 0
    v_mov_b32 v131, 0
    v_mov_b32 v132, 0
    v_cndmask_b32 v128, 0, v7, vcc
    v_cndmask_b32 v129, v7, 0, vcc
    v_mov_b32 v133, 0
    v_mov_b32 v134, v128
    v_mov_b32 v135, v129
    v_mov_b32 v142, 0
    v_mov_b32 v143, 0
    v_mov_b32 v150, 0
    v_mov_b32 v151, 0
    v_mov_b32 v158, 0
    v_mov_b32 v159, 0
    v_mov_b32 v166, 0
    v_mov_b32 v167, 0
    v_mov_b32 v174, 0
    v_mov_b32 v175, 0
    v_mov_b32 v182, 0
    v_mov_b32 v183, 0
    v_mov_b32 v190, 0
    v_mov_b32 v191, 0
    v_mov_b32 v198, 0
    v_mov_b32 v199, 0
    s_waitcnt vmcnt(0)
    s_mov_b64 exec, 255
    global_store_dwordx2 v2, v[240:241], s[18:19] sc1
    s_mov_b64 exec, -1
    s_mov_b32 s91, 0
    global_load_dwordx2 v[242:243], v13, s[88:89] sc1
L_poll2:
    s_sleep 1
    global_load_dwordx2 v[250:251], v13, s[88:89] sc1
    s_waitcnt vmcnt(1)
    v_cmp_eq_u64 vcc, s[86:87], v[242:243]
    s_nop 1
    s_cmp_eq_u64 vcc, -1
    s_cbranch_scc1 L_poll2_ok
    s_sleep 1
    global_load_dwordx2 v[242:243], v13, s[88:89] sc1
    s_waitcnt vmcnt(1)
    v_cmp_eq_u64 vcc, s[86:87], v[250:251]
    s_nop 1
    s_cmp_eq_u64 vcc, -1
    s_cbranch_scc1 L_poll2_ok
    s_add_u32 s91, s91, 1
    s_cmp_gt_u32 s91, 200000
    s_cbranch_scc0 L_poll2
L_poll2_ok:
    s_mov_b32 s45, 0
    buffer_load_dwordx4 v[136:139], v1, s[20:23], s45 offen sc1
    buffer_load_dwordx2 v[140:141], v3, s[20:23], s45 offen sc1
    s_mov_b32 s45, 36864
    buffer_load_dwordx4 v[144:147], v1, s[20:23], s45 offen sc1
    buffer_load_dwordx2 v[148:149], v3, s[20:23], s45 offen sc1
    s_mov_b32 s45, 73728
    buffer_load_dwordx4 v[152:155], v1, s[20:23], s45 offen sc1
    buffer_load_dwordx2 v[156:157], v3, s[20:23], s45 offen sc1
    s_mov_b32 s45, 110592
    buffer_load_dwordx4 v[160:163], v1, s[20:23], s45 offen sc1
    buffer_load_dwordx2 v[164:165], v3, s[20:23], s45 offen sc1
    s_mov_b32 s45, 147456
    buffer_load_dwordx4 v[168:171], v1, s[20:23], s45 offen sc1
    buffer_load_dwordx2 v[172:173], v3, s[20:23], s45 offen sc1
    s_mov_b32 s45, 184320
    buffer_load_dwordx4 v[176:179], v1, s[20:23], s45 offen sc1
    buffer_load_dwordx2 v[180:181], v3, s[20:23], s45 offen sc1
    s_mov_b32 s45, 221184
    buffer_load_dwordx4 v[184:187], v1, s[20:23], s45 offen sc1
    buffer_load_dwordx2 v[188:189], v3, s[20:23], s45 offen sc1
    s_mov_b32 s45, 258048
    buffer_load_dwordx4 v[192:195], v1, s[20:23], s45 offen sc1
    buffer_load_dwordx2 v[196:197], v3, s[20:23], s45 offen sc1
    s_mul_i32 s44, s37, 144
    s_mul_i32 s45, s36, 48
    s_add_u32 s44, s44, s45
    s_lshl_b32 s44, s44, 10
    s_lshl_b32 s45, s39, 8
    s_add_u32 s44, s44, s45
    s_lshl_b32 s45, s40, 5
    s_add_u32 s44, s44, s45
    v_and_b32 v2, 15, v0
    v_lshrrev_b32 v4, 4, v0
    v_lshlrev_b32 v2, 10, v2
    v_lshl_add_u32 v2, v4, 3, v2
    v_add_u32 v2, s44, v2
    s_waitcnt vmcnt(14)
    v_mfma_f32_16x16x32_bf16 v[16:19], v[128:131], v[136:139], 0
    v_mfma_f32_16x16x32_bf16 v[20:23], v[132:135], v[136:139], 0
    v_mfma_f32_16x16x32_bf16 v[24:27], v[128:131], v[140:143], 0
    s_waitcnt vmcnt(12)
    v_mfma_f32_16x16x32_bf16 v[16:19], v[128:131], v[144:147], v[16:19]
    v_mfma_f32_16x16x32_bf16 v[20:23], v[132:135], v[144:147], v[20:23]
    v_mfma_f32_16x16x32_bf16 v[24:27], v[128:131], v[148:151], v[24:27]
    s_waitcnt vmcnt(10)
    v_mfma_f32_16x16x32_bf16 v[16:19], v[128:131], v[152:155], v[16:19]
    v_mfma_f32_16x16x32_bf16 v[20:23], v[132:135], v[152:155], v[20:23]
    v_mfma_f32_16x16x32_bf16 v[24:27], v[128:131], v[156:159], v[24:27]
    s_waitcnt vmcnt(8)
    v_mfma_f32_16x16x32_bf16 v[16:19], v[128:131], v[160:163], v[16:19]
    v_mfma_f32_16x16x32_bf16 v[20:23], v[132:135], v[160:163], v[20:23]
    v_mfma_f32_16x16x32_bf16 v[24:27], v[128:131], v[164:167], v[24:27]
    s_waitcnt vmcnt(6)
    v_mfma_f32_16x16x32_bf16 v[16:19], v[128:131], v[168:171], v[16:19]
    v_mfma_f32_16x16x32_bf16 v[20:23], v[132:135], v[168:171], v[20:23]
    v_mfma_f32_16x16x32_bf16 v[24:27], v[128:131], v[172:175], v[24:27]
    s_waitcnt vmcnt(4)
    v_mfma_f32_16x16x32_bf16 v[16:19], v[128:131], v[176:179], v[16:19]
    v_mfma_f32_16x16x32_bf16 v[20:23], v[132:135], v[176:179], v[20:23]
    v_mfma_f32_16x16x32_bf16 v[24:27], v[128:131], v[180:183], v[24:27]
    s_waitcnt vmcnt(2)
    v_mfma_f32_16x16x32_bf16 v[16:19], v[128:131], v[184:187], v[16:19]
    v_mfma_f32_16x16x32_bf16 v[20:23], v[132:135], v[184:187], v[20:23]
    v_mfma_f32_16x16x32_bf16 v[24:27], v[128:131], v[188:191], v[24:27]
    s_waitcnt vmcnt(0)
    v_mfma_f32_16x16x32_bf16 v[16:19], v[128:131], v[192:195], v[16:19]
    v_mfma_f32_16x16x32_bf16 v[20:23], v[132:135], v[192:195], v[20:23]
    v_mfma_f32_16x16x32_bf16 v[24:27], v[128:131], v[196:199], v[24:27]
    s_nop 7
    v_cvt_pk_bf16_f32 v4, v16, v17
    v_cvt_pk_bf16_f32 v5, v18, v19
    v_cvt_pk_bf16_f32 v6, v20, v21
    v_cvt_pk_bf16_f32 v7, v22, v23
    v_cvt_pk_bf16_f32 v8, v24, v25
    v_cvt_pk_bf16_f32 v9, v26, v27
    global_store_dwordx2 v2, v[4:5], s[14:15]
    v_add_u32 v2, 16384, v2
    global_store_dwordx2 v2, v[6:7], s[14:15]
    v_add_u32 v2, 16384, v2
    global_store_dwordx2 v2, v[8:9], s[14:15]
    s_endpgm
L_slow:
    s_mov_b32 s60, 1
    s_lshl_b32 s61, s36, 13
    s_add_u32 s61, s61, 98304
    v_lshrrev_b32 v1, 4, v0
    v_and_b32 v2, 15, v0
    v_xor_b32 v3, v2, v1
    v_lshlrev_b32 v3, 4, v3
    v_lshl_add_u32 v148, v1, 8, v3
    v_xor_b32 v149, 64, v148
    v_xor_b32 v150, 128, v148
    v_xor_b32 v151, 192, v148
    v_lshlrev_b32 v3, 1, v1
    v_xor_b32 v3, v2, v3
    v_lshlrev_b32 v3, 4, v3
    v_lshl_add_u32 v152, v1, 8, v3
    v_xor_b32 v153, 128, v152
    v_add_u32 v136, s61, v184
    v_add_u32 v137, s61, v185
    v_add_u32 v138, s61, v186
    v_add_u32 v139, s61, v187
    v_add_u32 v140, s61, v192
    v_add_u32 v141, s61, v193
    v_add_u32 v142, s61, v194
    v_add_u32 v143, s61, v195
    v_add_u32 v144, s61, v196
    v_add_u32 v145, s61, v197
    v_add_u32 v146, s61, v198
    v_add_u32 v147, s61, v199
    s_add_u32 s62, s61, 4096
    v_mov_b32 v4, 0xff800000
    v_mov_b32 v5, 0xff800000
    v_mov_b32 v6, 0xff800000
    s_mov_b32 s63, 0
L_slow1:
    s_mov_b32 m0, s61
    s_add_u32 s64, s63, 0
    buffer_load_dwordx4 v148, s[20:23], s64 offen offset:0 lds
    buffer_load_dwordx4 v149, s[20:23], s64 offen offset:1024 lds
    buffer_load_dwordx4 v150, s[20:23], s64 offen offset:2048 lds
    buffer_load_dwordx4 v151, s[20:23], s64 offen offset:3072 lds
    s_mov_b32 m0, s62
    s_add_u32 s64, s63, 4096
    buffer_load_dwordx4 v148, s[20:23], s64 offen offset:0 lds
    buffer_load_dwordx4 v149, s[20:23], s64 offen offset:1024 lds
    buffer_load_dwordx4 v150, s[20:23], s64 offen offset:2048 lds
    buffer_load_dwordx4 v151, s[20:23], s64 offen offset:3072 lds
    s_waitcnt vmcnt(0)
    ds_read_b128 a[48:51], v136 offset:0
    ds_read_b128 a[52:55], v136 offset:4096
    ds_read_b128 a[56:59], v137 offset:0
    ds_read_b128 a[60:63], v137 offset:4096
    ds_read_b128 a[64:67], v138 offset:0
    ds_read_b128 a[68:71], v138 offset:4096
    ds_read_b128 a[72:75], v139 offset:0
    ds_read_b128 a[76:79], v139 offset:4096
    s_waitcnt lgkmcnt(0)
    v_mfma_f32_16x16x32_bf16 v[112:115], a[48:51], a[0:3], 0
    v_mfma_f32_16x16x32_bf16 v[116:119], a[52:55], a[0:3], 0
    v_mfma_f32_16x16x32_bf16 v[112:115], a[56:59], a[4:7], v[112:115]
    v_mfma_f32_16x16x32_bf16 v[116:119], a[60:63], a[4:7], v[116:119]
    v_mfma_f32_16x16x32_bf16 v[112:115], a[64:67], a[8:11], v[112:115]
    v_mfma_f32_16x16x32_bf16 v[116:119], a[68:71], a[8:11], v[116:119]
    v_mfma_f32_16x16x32_bf16 v[112:115], a[72:75], a[12:15], v[112:115]
    v_mfma_f32_16x16x32_bf16 v[116:119], a[76:79], a[12:15], v[116:119]
    v_mfma_f32_16x16x32_bf16 v[120:123], a[48:51], a[16:19], 0
    v_mfma_f32_16x16x32_bf16 v[124:127], a[52:55], a[16:19], 0
    v_mfma_f32_16x16x32_bf16 v[120:123], a[56:59], a[20:23], v[120:123]
    v_mfma_f32_16x16x32_bf16 v[124:127], a[60:63], a[20:23], v[124:127]
    v_mfma_f32_16x16x32_bf16 v[120:123], a[64:67], a[24:27], v[120:123]
    v_mfma_f32_16x16x32_bf16 v[124:127], a[68:71], a[24:27], v[124:127]
    v_mfma_f32_16x16x32_bf16 v[120:123], a[72:75], a[28:31], v[120:123]
    v_mfma_f32_16x16x32_bf16 v[124:127], a[76:79], a[28:31], v[124:127]
    v_mfma_f32_16x16x32_bf16 v[128:131], a[48:51], a[32:35], 0
    v_mfma_f32_16x16x32_bf16 v[132:135], a[52:55], a[32:35], 0
    v_mfma_f32_16x16x32_bf16 v[128:131], a[56:59], a[36:39], v[128:131]
    v_mfma_f32_16x16x32_bf16 v[132:135], a[60:63], a[36:39], v[132:135]
    v_mfma_f32_16x16x32_bf16 v[128:131], a[64:67], a[40:43], v[128:131]
    v_mfma_f32_16x16x32_bf16 v[132:135], a[68:71], a[40:43], v[132:135]
    v_mfma_f32_16x16x32_bf16 v[128:131], a[72:75], a[44:47], v[128:131]
    v_mfma_f32_16x16x32_bf16 v[132:135], a[76:79], a[44:47], v[132:135]
    s_nop 7
    v_max3_f32 v4, v4, v112, v113
    v_max3_f32 v4, v4, v114, v115
    v_max3_f32 v4, v4, v116, v117
    v_max3_f32 v4, v4, v118, v119
    v_max3_f32 v5, v5, v120, v121
    v_max3_f32 v5, v5, v122, v123
    v_max3_f32 v5, v5, v124, v125
    v_max3_f32 v5, v5, v126, v127
    v_max3_f32 v6, v6, v128, v129
    v_max3_f32 v6, v6, v130, v131
    v_max3_f32 v6, v6, v132, v133
    v_max3_f32 v6, v6, v134, v135
    s_add_u32 s63, s63, 8192
    s_cmp_lt_u32 s63, 0x80000
    s_cbranch_scc1 L_slow1
    v_lshlrev_b32 v1, 2, v0
    v_xor_b32 v2, 64, v1
    v_xor_b32 v3, 128, v1
    ds_bpermute_b32 v8, v2, v4
    ds_bpermute_b32 v9, v2, v5
    ds_bpermute_b32 v10, v2, v6
    s_waitcnt lgkmcnt(0)
    v_max_f32 v4, v4, v8
    v_max_f32 v5, v5, v9
    v_max_f32 v6, v6, v10
    ds_bpermute_b32 v8, v3, v4
    ds_bpermute_b32 v9, v3, v5
    ds_bpermute_b32 v10, v3, v6
    s_waitcnt lgkmcnt(0)
    v_max_f32 v4, v4, v8
    v_max_f32 v5, v5, v9
    v_max_f32 v6, v6, v10
    v_sub_f32 v172, 0, v4
    v_sub_f32 v173, 0, v4
    v_sub_f32 v174, 0, v4
    v_sub_f32 v175, 0, v4
    v_sub_f32 v176, 0, v5
    v_sub_f32 v177, 0, v5
    v_sub_f32 v178, 0, v5
    v_sub_f32 v179, 0, v5
    v_sub_f32 v180, 0, v6
    v_sub_f32 v181, 0, v6
    v_sub_f32 v182, 0, v6
    v_sub_f32 v183, 0, v6
    v_mov_b32 v16, 0
    v_mov_b32 v17, 0
    v_mov_b32 v18, 0
    v_mov_b32 v19, 0
    v_mov_b32 v20, 0
    v_mov_b32 v21, 0
    v_mov_b32 v22, 0
    v_mov_b32 v23, 0
    v_mov_b32 v24, 0
    v_mov_b32 v25, 0
    v_mov_b32 v26, 0
    v_mov_b32 v27, 0
    v_mov_b32 v28, 0
    v_mov_b32 v29, 0
    v_mov_b32 v30, 0
    v_mov_b32 v31, 0
    v_mov_b32 v32, 0
    v_mov_b32 v33, 0
    v_mov_b32 v34, 0
    v_mov_b32 v35, 0
    v_mov_b32 v36, 0
    v_mov_b32 v37, 0
    v_mov_b32 v38, 0
    v_mov_b32 v39, 0
    v_mov_b32 v40, 0
    v_mov_b32 v41, 0
    v_mov_b32 v42, 0
    v_mov_b32 v43, 0
    v_mov_b32 v44, 0
    v_mov_b32 v45, 0
    v_mov_b32 v46, 0
    v_mov_b32 v47, 0
    v_mov_b32 v48, 0
    v_mov_b32 v49, 0
    v_mov_b32 v50, 0
    v_mov_b32 v51, 0
    v_mov_b32 v52, 0
    v_mov_b32 v53, 0
    v_mov_b32 v54, 0
    v_mov_b32 v55, 0
    v_mov_b32 v56, 0
    v_mov_b32 v57, 0
    v_mov_b32 v58, 0
    v_mov_b32 v59, 0
    v_mov_b32 v60, 0
    v_mov_b32 v61, 0
    v_mov_b32 v62, 0
    v_mov_b32 v63, 0
    v_mov_b32 v64, 0
    v_mov_b32 v65, 0
    v_mov_b32 v66, 0
    v_mov_b32 v67, 0
    v_mov_b32 v68, 0
    v_mov_b32 v69, 0
    v_mov_b32 v70, 0
    v_mov_b32 v71, 0
    v_mov_b32 v72, 0
    v_mov_b32 v73, 0
    v_mov_b32 v74, 0
    v_mov_b32 v75, 0
    v_mov_b32 v76, 0
    v_mov_b32 v77, 0
    v_mov_b32 v78, 0
    v_mov_b32 v79, 0
    v_mov_b32 v80, 0
    v_mov_b32 v81, 0
    v_mov_b32 v82, 0
    v_mov_b32 v83, 0
    v_mov_b32 v84, 0
    v_mov_b32 v85, 0
    v_mov_b32 v86, 0
    v_mov_b32 v87, 0
    v_mov_b32 v88, 0
    v_mov_b32 v89, 0
    v_mov_b32 v90, 0
    v_mov_b32 v91, 0
    v_mov_b32 v92, 0
    v_mov_b32 v93, 0
    v_mov_b32 v94, 0
    v_mov_b32 v95, 0
    v_mov_b32 v96, 0
    v_mov_b32 v97, 0
    v_mov_b32 v98, 0
    v_mov_b32 v99, 0
    v_mov_b32 v100, 0
    v_mov_b32 v101, 0
    v_mov_b32 v102, 0
    v_mov_b32 v103, 0
    v_mov_b32 v104, 0
    v_mov_b32 v105, 0
    v_mov_b32 v106, 0
    v_mov_b32 v107, 0
    v_mov_b32 v108, 0
    v_mov_b32 v109, 0
    v_mov_b32 v110, 0
    v_mov_b32 v111, 0
    v_accvgpr_write_b32 a112, 0
    v_accvgpr_write_b32 a113, 0
    v_accvgpr_write_b32 a114, 0
    v_accvgpr_write_b32 a115, 0
    v_accvgpr_write_b32 a116, 0
    v_accvgpr_write_b32 a117, 0
    v_accvgpr_write_b32 a118, 0
    v_accvgpr_write_b32 a119, 0
    v_accvgpr_write_b32 a120, 0
    v_accvgpr_write_b32 a121, 0
    v_accvgpr_write_b32 a122, 0
    v_accvgpr_write_b32 a123, 0
    s_mov_b32 s63, 0
L_slow2:
    s_mov_b32 m0, s61
    s_add_u32 s64, s63, 0
    buffer_load_dwordx4 v148, s[20:23], s64 offen offset:0 lds
    buffer_load_dwordx4 v149, s[20:23], s64 offen offset:1024 lds
    buffer_load_dwordx4 v150, s[20:23], s64 offen offset:2048 lds
    buffer_load_dwordx4 v151, s[20:23], s64 offen offset:3072 lds
    s_mov_b32 m0, s62
    s_add_u32 s64, s63, 4096
    buffer_load_dwordx4 v148, s[20:23], s64 offen offset:0 lds
    buffer_load_dwordx4 v149, s[20:23], s64 offen offset:1024 lds
    buffer_load_dwordx4 v150, s[20:23], s64 offen offset:2048 lds
    buffer_load_dwordx4 v151, s[20:23], s64 offen offset:3072 lds
    s_waitcnt vmcnt(0)
    ds_read_b128 a[48:51], v136 offset:0
    ds_read_b128 a[52:55], v136 offset:4096
    ds_read_b128 a[56:59], v137 offset:0
    ds_read_b128 a[60:63], v137 offset:4096
    ds_read_b128 a[64:67], v138 offset:0
    ds_read_b128 a[68:71], v138 offset:4096
    ds_read_b128 a[72:75], v139 offset:0
    ds_read_b128 a[76:79], v139 offset:4096
    s_waitcnt lgkmcnt(0)
    v_mfma_f32_16x16x32_bf16 v[112:115], a[48:51], a[0:3], v[172:175]
    v_mfma_f32_16x16x32_bf16 v[116:119], a[52:55], a[0:3], v[172:175]
    v_mfma_f32_16x16x32_bf16 v[112:115], a[56:59], a[4:7], v[112:115]
    v_mfma_f32_16x16x32_bf16 v[116:119], a[60:63], a[4:7], v[116:119]
    v_mfma_f32_16x16x32_bf16 v[112:115], a[64:67], a[8:11], v[112:115]
    v_mfma_f32_16x16x32_bf16 v[116:119], a[68:71], a[8:11], v[116:119]
    v_mfma_f32_16x16x32_bf16 v[112:115], a[72:75], a[12:15], v[112:115]
    v_mfma_f32_16x16x32_bf16 v[116:119], a[76:79], a[12:15], v[116:119]
    v_mfma_f32_16x16x32_bf16 v[120:123], a[48:51], a[16:19], v[176:179]
    v_mfma_f32_16x16x32_bf16 v[124:127], a[52:55], a[16:19], v[176:179]
    v_mfma_f32_16x16x32_bf16 v[120:123], a[56:59], a[20:23], v[120:123]
    v_mfma_f32_16x16x32_bf16 v[124:127], a[60:63], a[20:23], v[124:127]
    v_mfma_f32_16x16x32_bf16 v[120:123], a[64:67], a[24:27], v[120:123]
    v_mfma_f32_16x16x32_bf16 v[124:127], a[68:71], a[24:27], v[124:127]
    v_mfma_f32_16x16x32_bf16 v[120:123], a[72:75], a[28:31], v[120:123]
    v_mfma_f32_16x16x32_bf16 v[124:127], a[76:79], a[28:31], v[124:127]
    v_mfma_f32_16x16x32_bf16 v[128:131], a[48:51], a[32:35], v[180:183]
    v_mfma_f32_16x16x32_bf16 v[132:135], a[52:55], a[32:35], v[180:183]
    v_mfma_f32_16x16x32_bf16 v[128:131], a[56:59], a[36:39], v[128:131]
    v_mfma_f32_16x16x32_bf16 v[132:135], a[60:63], a[36:39], v[132:135]
    v_mfma_f32_16x16x32_bf16 v[128:131], a[64:67], a[40:43], v[128:131]
    v_mfma_f32_16x16x32_bf16 v[132:135], a[68:71], a[40:43], v[132:135]
    v_mfma_f32_16x16x32_bf16 v[128:131], a[72:75], a[44:47], v[128:131]
    v_mfma_f32_16x16x32_bf16 v[132:135], a[76:79], a[44:47], v[132:135]
    s_mov_b32 m0, s61
    s_add_u32 s64, s63, 0
    buffer_load_dwordx4 v152, s[24:27], s64 offen offset:0 lds
    buffer_load_dwordx4 v153, s[24:27], s64 offen offset:1024 lds
    buffer_load_dwordx4 v152, s[24:27], s64 offen offset:2048 lds
    buffer_load_dwordx4 v153, s[24:27], s64 offen offset:3072 lds
    s_mov_b32 m0, s62
    s_add_u32 s64, s63, 4096
    buffer_load_dwordx4 v152, s[24:27], s64 offen offset:0 lds
    buffer_load_dwordx4 v153, s[24:27], s64 offen offset:1024 lds
    buffer_load_dwordx4 v152, s[24:27], s64 offen offset:2048 lds
    buffer_load_dwordx4 v153, s[24:27], s64 offen offset:3072 lds
    s_nop 7
    v_exp_f32 v112, v112
    s_nop 0
    v_exp_f32 v113, v113
    s_nop 0
    v_exp_f32 v114, v114
    s_nop 0
    v_exp_f32 v115, v115
    s_nop 0
    v_exp_f32 v116, v116
    s_nop 0
    v_exp_f32 v117, v117
    s_nop 0
    v_exp_f32 v118, v118
    s_nop 0
    v_exp_f32 v119, v119
    s_nop 0
    v_cvt_pk_bf16_f32 v160, v112, v113
    v_cvt_pk_bf16_f32 v161, v114, v115
    v_cvt_pk_bf16_f32 v162, v116, v117
    v_cvt_pk_bf16_f32 v163, v118, v119
    v_exp_f32 v120, v120
    s_nop 0
    v_exp_f32 v121, v121
    s_nop 0
    v_exp_f32 v122, v122
    s_nop 0
    v_exp_f32 v123, v123
    s_nop 0
    v_exp_f32 v124, v124
    s_nop 0
    v_exp_f32 v125, v125
    s_nop 0
    v_exp_f32 v126, v126
    s_nop 0
    v_exp_f32 v127, v127
    s_nop 0
    v_cvt_pk_bf16_f32 v164, v120, v121
    v_cvt_pk_bf16_f32 v165, v122, v123
    v_cvt_pk_bf16_f32 v166, v124, v125
    v_cvt_pk_bf16_f32 v167, v126, v127
    v_exp_f32 v128, v128
    s_nop 0
    v_exp_f32 v129, v129
    s_nop 0
    v_exp_f32 v130, v130
    s_nop 0
    v_exp_f32 v131, v131
    s_nop 0
    v_exp_f32 v132, v132
    s_nop 0
    v_exp_f32 v133, v133
    s_nop 0
    v_exp_f32 v134, v134
    s_nop 0
    v_exp_f32 v135, v135
    s_nop 0
    v_cvt_pk_bf16_f32 v168, v128, v129
    v_cvt_pk_bf16_f32 v169, v130, v131
    v_cvt_pk_bf16_f32 v170, v132, v133
    v_cvt_pk_bf16_f32 v171, v134, v135
    s_waitcnt vmcnt(0)
    ds_read_b64_tr_b16 a[80:81], v140 offset:0
    ds_read_b64_tr_b16 a[82:83], v140 offset:4096
    ds_read_b64_tr_b16 a[84:85], v141 offset:0
    ds_read_b64_tr_b16 a[86:87], v141 offset:4096
    ds_read_b64_tr_b16 a[88:89], v142 offset:0
    ds_read_b64_tr_b16 a[90:91], v142 offset:4096
    ds_read_b64_tr_b16 a[92:93], v143 offset:0
    ds_read_b64_tr_b16 a[94:95], v143 offset:4096
    ds_read_b64_tr_b16 a[96:97], v144 offset:0
    ds_read_b64_tr_b16 a[98:99], v144 offset:4096
    ds_read_b64_tr_b16 a[100:101], v145 offset:0
    ds_read_b64_tr_b16 a[102:103], v145 offset:4096
    ds_read_b64_tr_b16 a[104:105], v146 offset:0
    ds_read_b64_tr_b16 a[106:107], v146 offset:4096
    ds_read_b64_tr_b16 a[108:109], v147 offset:0
    ds_read_b64_tr_b16 a[110:111], v147 offset:4096
    s_waitcnt lgkmcnt(0)
    v_mfma_f32_16x16x32_bf16 v[16:19], a[80:83], v[160:163], v[16:19]
    v_mfma_f32_16x16x32_bf16 v[20:23], a[84:87], v[160:163], v[20:23]
    v_mfma_f32_16x16x32_bf16 v[24:27], a[88:91], v[160:163], v[24:27]
    v_mfma_f32_16x16x32_bf16 v[28:31], a[92:95], v[160:163], v[28:31]
    v_mfma_f32_16x16x32_bf16 v[32:35], a[96:99], v[160:163], v[32:35]
    v_mfma_f32_16x16x32_bf16 v[36:39], a[100:103], v[160:163], v[36:39]
    v_mfma_f32_16x16x32_bf16 v[40:43], a[104:107], v[160:163], v[40:43]
    v_mfma_f32_16x16x32_bf16 v[44:47], a[108:111], v[160:163], v[44:47]
    v_mfma_f32_16x16x32_bf16 a[112:115], a[124:127], v[160:163], a[112:115]
    v_mfma_f32_16x16x32_bf16 v[48:51], a[80:83], v[164:167], v[48:51]
    v_mfma_f32_16x16x32_bf16 v[52:55], a[84:87], v[164:167], v[52:55]
    v_mfma_f32_16x16x32_bf16 v[56:59], a[88:91], v[164:167], v[56:59]
    v_mfma_f32_16x16x32_bf16 v[60:63], a[92:95], v[164:167], v[60:63]
    v_mfma_f32_16x16x32_bf16 v[64:67], a[96:99], v[164:167], v[64:67]
    v_mfma_f32_16x16x32_bf16 v[68:71], a[100:103], v[164:167], v[68:71]
    v_mfma_f32_16x16x32_bf16 v[72:75], a[104:107], v[164:167], v[72:75]
    v_mfma_f32_16x16x32_bf16 v[76:79], a[108:111], v[164:167], v[76:79]
    v_mfma_f32_16x16x32_bf16 a[116:119], a[124:127], v[164:167], a[116:119]
    v_mfma_f32_16x16x32_bf16 v[80:83], a[80:83], v[168:171], v[80:83]
    v_mfma_f32_16x16x32_bf16 v[84:87], a[84:87], v[168:171], v[84:87]
    v_mfma_f32_16x16x32_bf16 v[88:91], a[88:91], v[168:171], v[88:91]
    v_mfma_f32_16x16x32_bf16 v[92:95], a[92:95], v[168:171], v[92:95]
    v_mfma_f32_16x16x32_bf16 v[96:99], a[96:99], v[168:171], v[96:99]
    v_mfma_f32_16x16x32_bf16 v[100:103], a[100:103], v[168:171], v[100:103]
    v_mfma_f32_16x16x32_bf16 v[104:107], a[104:107], v[168:171], v[104:107]
    v_mfma_f32_16x16x32_bf16 v[108:111], a[108:111], v[168:171], v[108:111]
    v_mfma_f32_16x16x32_bf16 a[120:123], a[124:127], v[168:171], a[120:123]
    s_add_u32 s63, s63, 8192
    s_cmp_lt_u32 s63, 0x80000
    s_cbranch_scc1 L_slow2
    s_branch L_norm
L_t2:
    global_load_dwordx2 v[242:243], v247, s[88:89] sc1
    global_load_dwordx2 v[242:243], v247, s[88:89] sc1
    global_load_dwordx2 v[242:243], v247, s[88:89] sc1
    s_branch L_t3
L_t4:
    global_load_dwordx2 v[242:243], v247, s[88:89] sc1
    global_load_dwordx2 v[242:243], v247, s[88:89] sc1
    global_load_dwordx2 v[242:243], v247, s[88:89] sc1
    s_branch L_t5
L_t6:
    global_load_dwordx2 v[242:243], v247, s[88:89] sc1
    global_load_dwordx2 v[242:243], v247, s[88:89] sc1
    global_load_dwordx2 v[242:243], v247, s[88:89] sc1
    s_branch L_t7
L_t8:
    s_waitcnt vmcnt(0)
    v_cmp_eq_u64 vcc, s[86:87], v[242:243]
    s_nop 1
    s_and_b32 s62, vcc_lo, 0xf
    s_andn2_b32 s62, s62, s90
    s_cbranch_scc0 L_t10
    s_ff1_i32_b32 s63, s62
    s_lshl_b32 s62, 1, s63
    s_or_b32 s90, s90, s62
    s_mul_i32 s53, s63, 36864
    s_sub_u32 s63, s63, s39
    s_and_b32 s63, s63, 3
    s_sub_u32 s63, s63, 1
    s_lshl_b32 s62, s63, 15
    v_add_u32 v208, s62, v192
    v_add_u32 v209, s62, v193
    v_add_u32 v210, s62, v194
    v_add_u32 v211, s62, v195
    v_add_u32 v212, s62, v196
    v_add_u32 v213, s62, v197
    v_add_u32 v214, s62, v198
    v_add_u32 v215, s62, v199
    s_mov_b32 s92, 1
    buffer_load_dwordx4 a[128:131], v244, s[28:31], s53 offen offset:0 sc1
    buffer_load_dwordx4 a[132:135], v245, s[28:31], s53 offen offset:0 sc1
    buffer_load_dwordx4 a[136:139], v246, s[28:31], s53 offen offset:0 sc1
    buffer_load_dwordx4 a[140:143], v244, s[28:31], s53 offen offset:1024 sc1
    buffer_load_dwordx4 a[144:147], v245, s[28:31], s53 offen offset:1024 sc1
    buffer_load_dwordx4 a[148:151], v246, s[28:31], s53 offen offset:1024 sc1
    buffer_load_dwordx4 a[152:155], v244, s[28:31], s53 offen offset:2048 sc1
    buffer_load_dwordx4 a[156:159], v245, s[28:31], s53 offen offset:2048 sc1
    buffer_load_dwordx4 a[160:163], v246, s[28:31], s53 offen offset:2048 sc1
    buffer_load_dwordx4 a[164:167], v244, s[28:31], s53 offen offset:3072 sc1
    buffer_load_dwordx4 a[168:171], v245, s[28:31], s53 offen offset:3072 sc1
    buffer_load_dwordx4 a[172:175], v246, s[28:31], s53 offen offset:3072 sc1
    s_branch L_t9
L_t10:
    global_load_dwordx2 v[242:243], v247, s[88:89] sc1
    global_load_dwordx2 v[242:243], v247, s[88:89] sc1
    global_load_dwordx2 v[242:243], v247, s[88:89] sc1
    s_branch L_t9
L_t11:
    s_waitcnt vmcnt(0)
    s_mov_b32 s91, 0
    global_load_dwordx2 v[242:243], v247, s[88:89] sc1
L_t13:
    s_sleep 1
    global_load_dwordx2 v[250:251], v247, s[88:89] sc1
    s_waitcnt vmcnt(1)
    v_cmp_eq_u64 vcc, s[86:87], v[242:243]
    s_nop 1
    s_and_b32 s62, vcc_lo, 0xf
    s_andn2_b32 s62, s62, s90
    s_cbranch_scc0 L_t14
    s_ff1_i32_b32 s63, s62
    s_lshl_b32 s62, 1, s63
    s_or_b32 s90, s90, s62
    s_mul_i32 s53, s63, 36864
    s_sub_u32 s63, s63, s39
    s_and_b32 s63, s63, 3
    s_sub_u32 s63, s63, 1
    s_lshl_b32 s62, s63, 15
    v_add_u32 v208, s62, v192
    v_add_u32 v209, s62, v193
    v_add_u32 v210, s62, v194
    v_add_u32 v211, s62, v195
    v_add_u32 v212, s62, v196
    v_add_u32 v213, s62, v197
    v_add_u32 v214, s62, v198
    v_add_u32 v215, s62, v199
    s_mov_b32 s92, 1
    s_branch L_t16
L_t14:
    s_sleep 1
    global_load_dwordx2 v[242:243], v247, s[88:89] sc1
    s_waitcnt vmcnt(1)
    v_cmp_eq_u64 vcc, s[86:87], v[250:251]
    s_nop 1
    s_and_b32 s62, vcc_lo, 0xf
    s_andn2_b32 s62, s62, s90
    s_cbranch_scc0 L_t15
    s_ff1_i32_b32 s63, s62
    s_lshl_b32 s62, 1, s63
    s_or_b32 s90, s90, s62
    s_mul_i32 s53, s63, 36864
    s_sub_u32 s63, s63, s39
    s_and_b32 s63, s63, 3
    s_sub_u32 s63, s63, 1
    s_lshl_b32 s62, s63, 15
    v_add_u32 v208, s62, v192
    v_add_u32 v209, s62, v193
    v_add_u32 v210, s62, v194
    v_add_u32 v211, s62, v195
    v_add_u32 v212, s62, v196
    v_add_u32 v213, s62, v197
    v_add_u32 v214, s62, v198
    v_add_u32 v215, s62, v199
    s_mov_b32 s92, 1
    s_branch L_t16
L_t15:
    s_add_u32 s91, s91, 1
    s_cmp_gt_u32 s91, 200000
    s_cbranch_scc0 L_t13
L_t16:
    s_waitcnt vmcnt(0)
    buffer_load_dwordx4 a[128:131], v244, s[28:31], s53 offen offset:0 sc1
    buffer_load_dwordx4 a[132:135], v245, s[28:31], s53 offen offset:0 sc1
    buffer_load_dwordx4 a[136:139], v246, s[28:31], s53 offen offset:0 sc1
    buffer_load_dwordx4 a[140:143], v244, s[28:31], s53 offen offset:1024 sc1
    buffer_load_dwordx4 a[144:147], v245, s[28:31], s53 offen offset:1024 sc1
    buffer_load_dwordx4 a[148:151], v246, s[28:31], s53 offen offset:1024 sc1
    buffer_load_dwordx4 a[152:155], v244, s[28:31], s53 offen offset:2048 sc1
    buffer_load_dwordx4 a[156:159], v245, s[28:31], s53 offen offset:2048 sc1
    buffer_load_dwordx4 a[160:163], v246, s[28:31], s53 offen offset:2048 sc1
    buffer_load_dwordx4 a[164:167], v244, s[28:31], s53 offen offset:3072 sc1
    buffer_load_dwordx4 a[168:171], v245, s[28:31], s53 offen offset:3072 sc1
    buffer_load_dwordx4 a[172:175], v246, s[28:31], s53 offen offset:3072 sc1
    s_waitcnt lgkmcnt(0)
    ds_read_b64_tr_b16 a[80:81], v208 offset:0
    ds_read_b64_tr_b16 a[82:83], v208 offset:4096
    ds_read_b64_tr_b16 a[84:85], v209 offset:0
    ds_read_b64_tr_b16 a[86:87], v209 offset:4096
    ds_read_b64_tr_b16 a[88:89], v210 offset:0
    ds_read_b64_tr_b16 a[90:91], v210 offset:4096
    ds_read_b64_tr_b16 a[92:93], v211 offset:0
    ds_read_b64_tr_b16 a[94:95], v211 offset:4096
    ds_read_b64_tr_b16 a[96:97], v212 offset:0
    ds_read_b64_tr_b16 a[98:99], v212 offset:4096
    ds_read_b64_tr_b16 a[100:101], v213 offset:0
    ds_read_b64_tr_b16 a[102:103], v213 offset:4096
    ds_read_b64_tr_b16 a[104:105], v214 offset:0
    ds_read_b64_tr_b16 a[106:107], v214 offset:4096
    s_waitcnt lgkmcnt(0)
    s_branch L_t12
L_t18:
    global_load_dwordx2 v[242:243], v247, s[88:89] sc1
    global_load_dwordx2 v[242:243], v247, s[88:89] sc1
    global_load_dwordx2 v[242:243], v247, s[88:89] sc1
    s_branch L_t19
L_t20:
    global_load_dwordx2 v[242:243], v247, s[88:89] sc1
    global_load_dwordx2 v[242:243], v247, s[88:89] sc1
    global_load_dwordx2 v[242:243], v247, s[88:89] sc1
    s_branch L_t21
L_t22:
    global_load_dwordx2 v[242:243], v247, s[88:89] sc1
    global_load_dwordx2 v[242:243], v247, s[88:89] sc1
    global_load_dwordx2 v[242:243], v247, s[88:89] sc1
    s_branch L_t23
L_t24:
    s_waitcnt vmcnt(0)
    v_cmp_eq_u64 vcc, s[86:87], v[242:243]
    s_nop 1
    s_and_b32 s62, vcc_lo, 0xf
    s_andn2_b32 s62, s62, s90
    s_cbranch_scc0 L_t26
    s_ff1_i32_b32 s63, s62
    s_lshl_b32 s62, 1, s63
    s_or_b32 s90, s90, s62
    s_mul_i32 s54, s63, 36864
    s_sub_u32 s63, s63, s39
    s_and_b32 s63, s63, 3
    s_sub_u32 s63, s63, 1
    s_lshl_b32 s62, s63, 15
    v_add_u32 v184, s62, v192
    v_add_u32 v185, s62, v193
    v_add_u32 v186, s62, v194
    v_add_u32 v187, s62, v195
    v_add_u32 v188, s62, v196
    v_add_u32 v189, s62, v197
    v_add_u32 v190, s62, v198
    v_add_u32 v191, s62, v199
    s_mov_b32 s92, 1
    buffer_load_dwordx4 a[176:179], v244, s[28:31], s54 offen offset:0 sc1
    buffer_load_dwordx4 a[180:183], v245, s[28:31], s54 offen offset:0 sc1
    buffer_load_dwordx4 a[184:187], v246, s[28:31], s54 offen offset:0 sc1
    buffer_load_dwordx4 a[188:191], v244, s[28:31], s54 offen offset:1024 sc1
    buffer_load_dwordx4 a[192:195], v245, s[28:31], s54 offen offset:1024 sc1
    buffer_load_dwordx4 a[196:199], v246, s[28:31], s54 offen offset:1024 sc1
    buffer_load_dwordx4 a[200:203], v244, s[28:31], s54 offen offset:2048 sc1
    buffer_load_dwordx4 a[204:207], v245, s[28:31], s54 offen offset:2048 sc1
    buffer_load_dwordx4 a[208:211], v246, s[28:31], s54 offen offset:2048 sc1
    buffer_load_dwordx4 a[212:215], v244, s[28:31], s54 offen offset:3072 sc1
    buffer_load_dwordx4 a[216:219], v245, s[28:31], s54 offen offset:3072 sc1
    buffer_load_dwordx4 a[220:223], v246, s[28:31], s54 offen offset:3072 sc1
    s_branch L_t25
L_t26:
    global_load_dwordx2 v[242:243], v247, s[88:89] sc1
    global_load_dwordx2 v[242:243], v247, s[88:89] sc1
    global_load_dwordx2 v[242:243], v247, s[88:89] sc1
    s_branch L_t25
L_t27:
    s_waitcnt vmcnt(0)
    s_mov_b32 s91, 0
    global_load_dwordx2 v[242:243], v247, s[88:89] sc1
L_t29:
    s_sleep 1
    global_load_dwordx2 v[250:251], v247, s[88:89] sc1
    s_waitcnt vmcnt(1)
    v_cmp_eq_u64 vcc, s[86:87], v[242:243]
    s_nop 1
    s_and_b32 s62, vcc_lo, 0xf
    s_andn2_b32 s62, s62, s90
    s_cbranch_scc0 L_t30
    s_ff1_i32_b32 s63, s62
    s_lshl_b32 s62, 1, s63
    s_or_b32 s90, s90, s62
    s_mul_i32 s54, s63, 36864
    s_sub_u32 s63, s63, s39
    s_and_b32 s63, s63, 3
    s_sub_u32 s63, s63, 1
    s_lshl_b32 s62, s63, 15
    v_add_u32 v184, s62, v192
    v_add_u32 v185, s62, v193
    v_add_u32 v186, s62, v194
    v_add_u32 v187, s62, v195
    v_add_u32 v188, s62, v196
    v_add_u32 v189, s62, v197
    v_add_u32 v190, s62, v198
    v_add_u32 v191, s62, v199
    s_mov_b32 s92, 1
    s_branch L_t32
L_t30:
    s_sleep 1
    global_load_dwordx2 v[242:243], v247, s[88:89] sc1
    s_waitcnt vmcnt(1)
    v_cmp_eq_u64 vcc, s[86:87], v[250:251]
    s_nop 1
    s_and_b32 s62, vcc_lo, 0xf
    s_andn2_b32 s62, s62, s90
    s_cbranch_scc0 L_t31
    s_ff1_i32_b32 s63, s62
    s_lshl_b32 s62, 1, s63
    s_or_b32 s90, s90, s62
    s_mul_i32 s54, s63, 36864
    s_sub_u32 s63, s63, s39
    s_and_b32 s63, s63, 3
    s_sub_u32 s63, s63, 1
    s_lshl_b32 s62, s63, 15
    v_add_u32 v184, s62, v192
    v_add_u32 v185, s62, v193
    v_add_u32 v186, s62, v194
    v_add_u32 v187, s62, v195
    v_add_u32 v188, s62, v196
    v_add_u32 v189, s62, v197
    v_add_u32 v190, s62, v198
    v_add_u32 v191, s62, v199
    s_mov_b32 s92, 1
    s_branch L_t32
L_t31:
    s_add_u32 s91, s91, 1
    s_cmp_gt_u32 s91, 200000
    s_cbranch_scc0 L_t29
L_t32:
    s_waitcnt vmcnt(0)
    buffer_load_dwordx4 a[176:179], v244, s[28:31], s54 offen offset:0 sc1
    buffer_load_dwordx4 a[180:183], v245, s[28:31], s54 offen offset:0 sc1
    buffer_load_dwordx4 a[184:187], v246, s[28:31], s54 offen offset:0 sc1
    buffer_load_dwordx4 a[188:191], v244, s[28:31], s54 offen offset:1024 sc1
    buffer_load_dwordx4 a[192:195], v245, s[28:31], s54 offen offset:1024 sc1
    buffer_load_dwordx4 a[196:199], v246, s[28:31], s54 offen offset:1024 sc1
    buffer_load_dwordx4 a[200:203], v244, s[28:31], s54 offen offset:2048 sc1
    buffer_load_dwordx4 a[204:207], v245, s[28:31], s54 offen offset:2048 sc1
    buffer_load_dwordx4 a[208:211], v246, s[28:31], s54 offen offset:2048 sc1
    buffer_load_dwordx4 a[212:215], v244, s[28:31], s54 offen offset:3072 sc1
    buffer_load_dwordx4 a[216:219], v245, s[28:31], s54 offen offset:3072 sc1
    buffer_load_dwordx4 a[220:223], v246, s[28:31], s54 offen offset:3072 sc1
    s_waitcnt lgkmcnt(0)
    ds_read_b64_tr_b16 a[80:81], v184 offset:0
    ds_read_b64_tr_b16 a[82:83], v184 offset:4096
    ds_read_b64_tr_b16 a[84:85], v185 offset:0
    ds_read_b64_tr_b16 a[86:87], v185 offset:4096
    ds_read_b64_tr_b16 a[88:89], v186 offset:0
    ds_read_b64_tr_b16 a[90:91], v186 offset:4096
    ds_read_b64_tr_b16 a[92:93], v187 offset:0
    ds_read_b64_tr_b16 a[94:95], v187 offset:4096
    ds_read_b64_tr_b16 a[96:97], v188 offset:0
    ds_read_b64_tr_b16 a[98:99], v188 offset:4096
    ds_read_b64_tr_b16 a[100:101], v189 offset:0
    ds_read_b64_tr_b16 a[102:103], v189 offset:4096
    ds_read_b64_tr_b16 a[104:105], v190 offset:0
    ds_read_b64_tr_b16 a[106:107], v190 offset:4096
    s_waitcnt lgkmcnt(0)
    s_branch L_t28
L_t34:
    global_load_dwordx2 v[242:243], v247, s[88:89] sc1
    global_load_dwordx2 v[242:243], v247, s[88:89] sc1
    global_load_dwordx2 v[242:243], v247, s[88:89] sc1
    s_branch L_t35
L_t36:
    global_load_dwordx2 v[242:243], v247, s[88:89] sc1
    global_load_dwordx2 v[242:243], v247, s[88:89] sc1
    global_load_dwordx2 v[242:243], v247, s[88:89] sc1
    s_branch L_t37
L_t38:
    global_load_dwordx2 v[242:243], v247, s[88:89] sc1
    global_load_dwordx2 v[242:243], v247, s[88:89] sc1
    global_load_dwordx2 v[242:243], v247, s[88:89] sc1
    s_branch L_t39
L_t40:
    s_waitcnt vmcnt(0)
    v_cmp_eq_u64 vcc, s[86:87], v[242:243]
    s_nop 1
    s_and_b32 s62, vcc_lo, 0xf
    s_andn2_b32 s62, s62, s90
    s_cbranch_scc0 L_t42
    s_ff1_i32_b32 s63, s62
    s_lshl_b32 s62, 1, s63
    s_or_b32 s90, s90, s62
    s_mul_i32 s55, s63, 36864
    s_sub_u32 s63, s63, s39
    s_and_b32 s63, s63, 3
    s_sub_u32 s63, s63, 1
    s_lshl_b32 s62, s63, 15
    v_add_u32 v208, s62, v192
    v_add_u32 v209, s62, v193
    v_add_u32 v210, s62, v194
    v_add_u32 v211, s62, v195
    v_add_u32 v212, s62, v196
    v_add_u32 v213, s62, v197
    v_add_u32 v214, s62, v198
    v_add_u32 v215, s62, v199
    s_mov_b32 s92, 1
    buffer_load_dwordx4 a[224:227], v244, s[28:31], s55 offen offset:0 sc1
    buffer_load_dwordx4 a[228:231], v245, s[28:31], s55 offen offset:0 sc1
    buffer_load_dwordx4 a[232:235], v246, s[28:31], s55 offen offset:0 sc1
    buffer_load_dwordx4 a[236:239], v244, s[28:31], s55 offen offset:1024 sc1
    buffer_load_dwordx4 a[240:243], v245, s[28:31], s55 offen offset:1024 sc1
    buffer_load_dwordx4 a[244:247], v246, s[28:31], s55 offen offset:1024 sc1
    buffer_load_dwordx4 a[248:251], v244, s[28:31], s55 offen offset:2048 sc1
    buffer_load_dwordx4 a[252:255], v245, s[28:31], s55 offen offset:2048 sc1
    buffer_load_dwordx4 v[224:227], v246, s[28:31], s55 offen offset:2048 sc1
    buffer_load_dwordx4 v[228:231], v244, s[28:31], s55 offen offset:3072 sc1
    buffer_load_dwordx4 v[232:235], v245, s[28:31], s55 offen offset:3072 sc1
    buffer_load_dwordx4 v[236:239], v246, s[28:31], s55 offen offset:3072 sc1
    s_branch L_t41
L_t42:
    global_load_dwordx2 v[242:243], v247, s[88:89] sc1
    global_load_dwordx2 v[242:243], v247, s[88:89] sc1
    global_load_dwordx2 v[242:243], v247, s[88:89] sc1
    s_branch L_t41
L_t43:
    s_waitcnt vmcnt(0)
    s_mov_b32 s91, 0
    global_load_dwordx2 v[242:243], v247, s[88:89] sc1
L_t45:
    s_sleep 1
    global_load_dwordx2 v[250:251], v247, s[88:89] sc1
    s_waitcnt vmcnt(1)
    v_cmp_eq_u64 vcc, s[86:87], v[242:243]
    s_nop 1
    s_and_b32 s62, vcc_lo, 0xf
    s_andn2_b32 s62, s62, s90
    s_cbranch_scc0 L_t46
    s_ff1_i32_b32 s63, s62
    s_lshl_b32 s62, 1, s63
    s_or_b32 s90, s90, s62
    s_mul_i32 s55, s63, 36864
    s_sub_u32 s63, s63, s39
    s_and_b32 s63, s63, 3
    s_sub_u32 s63, s63, 1
    s_lshl_b32 s62, s63, 15
    v_add_u32 v208, s62, v192
    v_add_u32 v209, s62, v193
    v_add_u32 v210, s62, v194
    v_add_u32 v211, s62, v195
    v_add_u32 v212, s62, v196
    v_add_u32 v213, s62, v197
    v_add_u32 v214, s62, v198
    v_add_u32 v215, s62, v199
    s_mov_b32 s92, 1
    s_branch L_t48
L_t46:
    s_sleep 1
    global_load_dwordx2 v[242:243], v247, s[88:89] sc1
    s_waitcnt vmcnt(1)
    v_cmp_eq_u64 vcc, s[86:87], v[250:251]
    s_nop 1
    s_and_b32 s62, vcc_lo, 0xf
    s_andn2_b32 s62, s62, s90
    s_cbranch_scc0 L_t47
    s_ff1_i32_b32 s63, s62
    s_lshl_b32 s62, 1, s63
    s_or_b32 s90, s90, s62
    s_mul_i32 s55, s63, 36864
    s_sub_u32 s63, s63, s39
    s_and_b32 s63, s63, 3
    s_sub_u32 s63, s63, 1
    s_lshl_b32 s62, s63, 15
    v_add_u32 v208, s62, v192
    v_add_u32 v209, s62, v193
    v_add_u32 v210, s62, v194
    v_add_u32 v211, s62, v195
    v_add_u32 v212, s62, v196
    v_add_u32 v213, s62, v197
    v_add_u32 v214, s62, v198
    v_add_u32 v215, s62, v199
    s_mov_b32 s92, 1
    s_branch L_t48
L_t47:
    s_add_u32 s91, s91, 1
    s_cmp_gt_u32 s91, 200000
    s_cbranch_scc0 L_t45
L_t48:
    s_waitcnt vmcnt(0)
    buffer_load_dwordx4 a[224:227], v244, s[28:31], s55 offen offset:0 sc1
    buffer_load_dwordx4 a[228:231], v245, s[28:31], s55 offen offset:0 sc1
    buffer_load_dwordx4 a[232:235], v246, s[28:31], s55 offen offset:0 sc1
    buffer_load_dwordx4 a[236:239], v244, s[28:31], s55 offen offset:1024 sc1
    buffer_load_dwordx4 a[240:243], v245, s[28:31], s55 offen offset:1024 sc1
    buffer_load_dwordx4 a[244:247], v246, s[28:31], s55 offen offset:1024 sc1
    buffer_load_dwordx4 a[248:251], v244, s[28:31], s55 offen offset:2048 sc1
    buffer_load_dwordx4 a[252:255], v245, s[28:31], s55 offen offset:2048 sc1
    buffer_load_dwordx4 v[224:227], v246, s[28:31], s55 offen offset:2048 sc1
    buffer_load_dwordx4 v[228:231], v244, s[28:31], s55 offen offset:3072 sc1
    buffer_load_dwordx4 v[232:235], v245, s[28:31], s55 offen offset:3072 sc1
    buffer_load_dwordx4 v[236:239], v246, s[28:31], s55 offen offset:3072 sc1
    s_waitcnt lgkmcnt(0)
    ds_read_b64_tr_b16 a[80:81], v208 offset:0
    ds_read_b64_tr_b16 a[82:83], v208 offset:4096
    ds_read_b64_tr_b16 a[84:85], v208 offset:8192
    ds_read_b64_tr_b16 a[86:87], v208 offset:12288
    ds_read_b64_tr_b16 a[88:89], v208 offset:16384
    ds_read_b64_tr_b16 a[90:91], v208 offset:20480
    ds_read_b64_tr_b16 a[92:93], v208 offset:24576
    ds_read_b64_tr_b16 a[94:95], v208 offset:28672
    ds_read_b64_tr_b16 a[96:97], v209 offset:0
    ds_read_b64_tr_b16 a[98:99], v209 offset:4096
    ds_read_b64_tr_b16 a[100:101], v209 offset:8192
    ds_read_b64_tr_b16 a[102:103], v209 offset:12288
    ds_read_b64_tr_b16 a[104:105], v209 offset:16384
    ds_read_b64_tr_b16 a[106:107], v209 offset:20480
    ds_read_b64_tr_b16 a[108:109], v209 offset:24576
    ds_read_b64_tr_b16 a[110:111], v209 offset:28672
    s_waitcnt lgkmcnt(0)
    s_branch L_t44
L_end:
    s_endpgm
L_codeend:
.section .rodata,"a"
.p2align 6
.amdhsa_kernel standalone__gqa_block_cached__near_ridge_kernel
  .amdhsa_next_free_vgpr 512
  .amdhsa_next_free_sgpr 102
  .amdhsa_accum_offset 256
  .amdhsa_group_segment_fixed_size 0
  .amdhsa_kernarg_size 64
  .amdhsa_user_sgpr_count 2
  .amdhsa_user_sgpr_kernarg_segment_ptr 1
  .amdhsa_system_sgpr_workgroup_id_x 1
.end_amdhsa_kernel
```
